```python
import torch

def _softmax(x, axis=-1):
    return torch.softmax(x, dim=axis)
def _gelu(x):
    return torch.nn.functional.gelu(x, approximate="tanh")
def _silu(x):
    return torch.nn.functional.silu(x)
def _sigmoid(x):
    return torch.sigmoid(x)
def _layernorm(x, axis=-1, eps=1e-5):
    m = x.mean(dim=axis, keepdim=True)
    v = x.var(dim=axis, keepdim=True, unbiased=False)
    return (x - m) / torch.sqrt(v + eps)
def _scatter_add(tgt, idx, src, axis=0):
    return tgt.clone().index_add_(axis, idx, src)
def _segment_sum(src, seg, n):
    out = torch.zeros((n,) + src.shape[1:], dtype=src.dtype)
    return out.index_add_(0, seg, src)
def _pad(x, pw):
    flat = tuple(v for pair in reversed(pw) for v in pair)
    return torch.nn.functional.pad(x, flat)

kernel_name = 'concat_heads__linear_kernel_hedgehog__ssm_conv_s4__prompt'

def setup_inputs():

    _w = (lambda a: (lambda t: t.to(torch.bfloat16) if t.is_floating_point() else t)(torch.as_tensor(a)))
    def _A_setup():
        B, S, D, H = 1, 2048, 1024, 32
        Dh = D // H
        return {
            "x": _w((lambda *s: torch.randn(*s, dtype=torch.bfloat16) * 0.4)(B, S, D)),
            "wqkv": _w((lambda *s: torch.randn(*s, dtype=torch.bfloat16) * 0.4)(D, 3 * D)),
            "w_phi": _w((lambda *s: torch.randn(*s, dtype=torch.bfloat16) * 0.4)(H, Dh, Dh) * (Dh ** -0.5)),
            "wo": _w((lambda *s: torch.randn(*s, dtype=torch.bfloat16) * 0.05)(D, D)),
        }
    _A_in = _A_setup()

    def _B_setup():
        B, L, D, N = 1, 2048, 1024, 128
        A_re = -(lambda _x: torch.exp(torch.as_tensor(_x)))((lambda *s: torch.randn(*s, dtype=torch.bfloat16) * 3.2)(D, N))
        A_im = torch.pi * (lambda *s: torch.randn(*s, dtype=torch.bfloat16) * 0.2)(D, N)
        B_re = (lambda *s: torch.randn(*s, dtype=torch.bfloat16) * 0.8)(D, N)
        B_im = (lambda *s: torch.randn(*s, dtype=torch.bfloat16) * 0.8)(D, N)
        C_re = (lambda *s: torch.randn(*s, dtype=torch.bfloat16) * 0.8)(D, N)
        C_im = (lambda *s: torch.randn(*s, dtype=torch.bfloat16) * 0.8)(D, N)
        log_dt = (lambda *s: torch.randn(*s, dtype=torch.bfloat16) * 0.2)(D) * 0.5 - 4.0
        Dskip = (lambda *s: torch.randn(*s, dtype=torch.bfloat16) * 1.6)(D)
        return {
            "u": _w((lambda *s: torch.randn(*s, dtype=torch.bfloat16) * 0.05)(B, L, D)),
            "A_re": _w(A_re),
            "A_im": _w(A_im),
            "B_re": _w(B_re),
            "B_im": _w(B_im),
            "C_re": _w(C_re),
            "C_im": _w(C_im),
            "log_dt": _w(log_dt),
            "Dskip": _w(Dskip),
        }
    _B_in = _B_setup()

    return {
        "A_x": _A_in["x"],
        "A_wqkv": _A_in["wqkv"],
        "A_w_phi": _A_in["w_phi"],
        "A_wo": _A_in["wo"],
        "B_u": _B_in["u"],
        "B_A_re": _B_in["A_re"],
        "B_A_im": _B_in["A_im"],
        "B_B_re": _B_in["B_re"],
        "B_B_im": _B_in["B_im"],
        "B_C_re": _B_in["C_re"],
        "B_C_im": _B_in["C_im"],
        "B_log_dt": _B_in["log_dt"],
        "B_Dskip": _B_in["Dskip"],
    }

def reference(A_x, A_wqkv, A_w_phi, A_wo, B_u, B_A_re, B_A_im, B_B_re, B_B_im, B_C_re, B_C_im, B_log_dt, B_Dskip):
    def _A_ref(x, wqkv, w_phi, wo):
        B, S, D = x.shape
        H = 32; Dh = D // H
        qkv = (lambda x, *d: x.permute(*d))((x @ wqkv).reshape(B, S, 3, H, Dh), 2, 0, 3, 1, 4)
        q, k, v = qkv[0], qkv[1], qkv[2]
        pq = torch.einsum("bhsd,hdf->bhsf", q, w_phi)
        pk = torch.einsum("bhsd,hdf->bhsf", k, w_phi)
        phi_q = torch.concatenate([_softmax(pq, axis=-1), _softmax(-pq, axis=-1)], axis=-1)
        phi_k = torch.concatenate([_softmax(pk, axis=-1), _softmax(-pk, axis=-1)], axis=-1)
        kv = torch.einsum("bhsf,bhsd->bhfd", phi_k, v)
        z  = torch.einsum("bhsf->bhf", phi_k)
        num = torch.einsum("bhqf,bhfd->bhqd", phi_q, kv)
        den = torch.einsum("bhqf,bhf->bhq", phi_q, z)[..., None] + 1e-6
        o = num / den
        return (lambda x, *d: x.permute(*d))(o, 0, 2, 1, 3).reshape(B, S, D) @ wo

    def _B_ref(u, A_re, A_im, B_re, B_im, C_re, C_im, log_dt, Dskip):
        Bsz, L, D = u.shape
        dt = torch.exp(log_dt)[:, None]
        A = A_re + 1j * A_im
        Bc = B_re + 1j * B_im
        Cc = C_re + 1j * C_im
        logdA = dt * A
        dB = dt * Bc
        l = (lambda x, dt: x.to(dt))(torch.arange(L), A_re.dtype)
        P = torch.exp(logdA[:, :, None] * l[None, None, :])
        K = torch.einsum("dn,dnl,dn->dl", Cc, P, dB).real
        L2 = 2 * L
        Kp = _pad(K, ((0, 0), (0, L)))
        up = (lambda x, *d: x.permute(*d))(u, 0, 2, 1)
        up = _pad(up, ((0, 0), (0, 0), (0, L)))
        Kf = (lambda x, axes=(-2,-1): torch.fft.rfft2(x.float(), dim=axes))(Kp[:, None, :], axes=(-2, -1))
        Uf = (lambda x, axes=(-2,-1): torch.fft.rfft2(x.float(), dim=axes))(up[:, :, None, :], axes=(-2, -1))
        Yf = Uf * Kf[None, :, :, :]
        y = (lambda x, s, axes=(-2,-1): torch.fft.irfft2(x, s=s, dim=axes).to(torch.bfloat16))(Yf, (1, L2), axes=(-2, -1))[:, :, 0, :L]
        y = (lambda x, *d: x.permute(*d))(y, 0, 2, 1) + u * Dskip[None, None, :]
        return y

    a = _A_ref(A_x, A_wqkv, A_w_phi, A_wo)
    b = _B_ref(B_u, B_A_re, B_A_im, B_B_re, B_B_im, B_C_re, B_C_im, B_log_dt, B_Dskip)
    return torch.concatenate([a, b], axis=-1)
```

```asm
; @launch grid=(256,1,1) block=(512,1,1) lds=163840
.amdgcn_target "amdgcn-amd-amdhsa--gfx950"
.text
.globl concat_heads__linear_kernel_hedgehog__ssm_conv_s4__prompt_kernel
.p2align 8
.type concat_heads__linear_kernel_hedgehog__ssm_conv_s4__prompt_kernel,@function
concat_heads__linear_kernel_hedgehog__ssm_conv_s4__prompt_kernel:
    s_cmp_ge_u32 s2, 256
    s_cbranch_scc1 L_end
    s_load_dwordx16 s[4:19], s[0:1], 0
    s_load_dwordx16 s[20:35], s[0:1], 64
    v_lshrrev_b32 v2, 6, v0
    v_and_b32 v1, 63, v0
    s_and_b32 s64, s2, 7
    s_lshr_b32 s65, s2, 3
    v_readfirstlane_b32 s70, v2
    s_nop 1
    s_cmp_ge_u32 s70, 4
    s_cbranch_scc1 L_P
    s_and_b32 s72, s64, 1
    s_lshl_b32 s72, s72, 3
    s_and_b32 s66, s65, 7
    s_add_u32 s66, s66, s72
    s_lshr_b32 s72, s64, 1
    s_lshl_b32 s72, s72, 2
    s_lshr_b32 s67, s65, 3
    s_add_u32 s67, s67, s72
    s_lshl_b32 s72, s64, 1
    s_lshr_b32 s68, s65, 4
    s_add_u32 s68, s68, s72
    s_and_b32 s69, s65, 15
    s_mul_i32 s71, s66, 2
    s_mul_i32 s72, s67, 0
    s_add_u32 s71, s71, s72
    s_lshr_b32 s72, s67, 2
    s_mul_i32 s72, s72, 4
    s_add_u32 s71, s71, s72
    s_mov_b32 s87, 0x3fb8aa3b
    s_lshl_b32 s86, s67, 6
    s_lshl_b32 s72, s66, 2
    s_add_u32 s86, s86, s72
    s_add_u32 s86, s86, s70
    s_lshl_b32 s72, s86, 8
    v_lshl_add_u32 v46, v1, 2, s72
    s_lshl_b32 s72, s86, 1
    v_mov_b32 v47, s72
    s_waitcnt lgkmcnt(0)
    s_setprio 2
    global_load_ushort v134, v47, s[26:27]
    global_load_dword v128, v46, s[14:15]
    global_load_dword v129, v46, s[16:17]
    global_load_dword v130, v46, s[18:19]
    global_load_dword v131, v46, s[20:21]
    global_load_dword v132, v46, s[22:23]
    global_load_dword v133, v46, s[24:25]
    s_mov_b32 s44, s34
    s_mov_b32 s45, s35
    s_mov_b32 s46, 0x2000000
    s_mov_b32 s47, 0x20000
    s_mov_b32 s60, s32
    s_mov_b32 s61, s33
    s_mov_b32 s62, 0x100
    s_mov_b32 s63, 0x20000
    s_mov_b32 s48, s30
    s_mov_b32 s49, s31
    s_mov_b32 s50, 0x800000
    s_mov_b32 s51, 0x20000
    s_mov_b32 s52, s10
    s_mov_b32 s53, s11
    s_mov_b32 s54, 0x200000
    s_mov_b32 s55, 0x20000
    s_lshr_b32 s72, s70, 1
    s_lshl_b32 s73, s67, 1
    s_add_u32 s73, s72, s73
    s_lshl_b32 s73, s73, 11
    v_and_b32 v48, 31, v1
    v_lshl_add_u32 v48, v48, 1, s73
    v_lshrrev_b32 v49, 5, v1
    v_lshl_add_u32 v48, v49, 8, v48
    global_load_ushort v12, v48, s[8:9] offset:0
    global_load_ushort v192, v48, s[8:9] offset:64
    global_load_ushort v13, v48, s[8:9] offset:128
    global_load_ushort v193, v48, s[8:9] offset:192
    global_load_ushort v14, v48, s[8:9] offset:512
    global_load_ushort v194, v48, s[8:9] offset:576
    global_load_ushort v15, v48, s[8:9] offset:640
    global_load_ushort v195, v48, s[8:9] offset:704
    global_load_ushort v16, v48, s[8:9] offset:1024
    global_load_ushort v196, v48, s[8:9] offset:1088
    global_load_ushort v17, v48, s[8:9] offset:1152
    global_load_ushort v197, v48, s[8:9] offset:1216
    global_load_ushort v18, v48, s[8:9] offset:1536
    global_load_ushort v198, v48, s[8:9] offset:1600
    global_load_ushort v19, v48, s[8:9] offset:1664
    global_load_ushort v199, v48, s[8:9] offset:1728
    s_getpc_b64 s[90:91]
L_pc0:
    s_add_u32 s90, s90, concat_heads__linear_kernel_hedgehog__ssm_conv_s4__prompt_kernel-L_pc0
    s_addc_u32 s91, s91, -1
    s_lshl_b32 s73, s65, 2
    s_add_u32 s73, s73, s70
    s_lshl_b32 s73, s73, 9
    v_and_b32 v50, 3, v1
    v_lshl_add_u32 v50, v50, 7, s73
    v_min_u32 v50, L_box+6144-128-concat_heads__linear_kernel_hedgehog__ssm_conv_s4__prompt_kernel, v50
    global_load_dword v37, v50, s[90:91]
    s_cmp_eq_u32 s2, 0
    s_cselect_b32 s72, 16777216, 0x40000000
    v_lshl_add_u32 v52, v0, 8, s72
    v_mov_b32 v53, 0
    buffer_store_dword v53, v52, s[44:47], 0 offen sc1
    s_lshl_b32 s72, s70, 2
    s_add_u32 s72, s72, 163584
    v_mov_b32 v60, s72
    s_xor_b32 s72, s72, 4
    v_mov_b32 v59, s72
    v_add_u32 v55, 176, v60
    v_cmp_gt_u32 vcc, 32, v1
    s_nop 1
    v_cndmask_b32 v55, v55, v59, vcc
    v_mov_b32 v61, 0
    ds_write_b32 v60, v61
    ds_write_b32 v60, v61 offset:16
    ds_write_b32 v60, v61 offset:32
    ds_write_b32 v60, v61 offset:48
    ds_write_b32 v60, v61 offset:64
    ds_write_b32 v60, v61 offset:80
    ds_write_b32 v60, v61 offset:96
    ds_write_b32 v60, v61 offset:112
    ds_write_b32 v60, v61 offset:128
    ds_write_b32 v60, v61 offset:144
    ds_write_b32 v60, v61 offset:160
    ds_write_b32 v60, v61 offset:176
    ds_write_b32 v60, v61 offset:192
    v_mov_b32 v61, 1
    s_lshl_b32 s72, s67, 2
    s_add_u32 s72, s72, s70
    s_lshl_b32 s72, s72, 8
    s_add_u32 s72, s72, 16777216
    v_mov_b32 v56, 0x40000000
    v_mov_b32 v57, 0x40000000
    v_writelane_b32 v56, s72, 0
    s_lshl_b32 s72, s66, 2
    s_lshr_b32 s73, s67, 2
    s_add_u32 s72, s72, s73
    s_lshl_b32 s72, s72, 8
    s_add_u32 s72, s72, 16793600
    v_writelane_b32 v57, s72, 0
    s_and_b32 s72, s70, 1
    s_lshl_b32 s72, s72, 13
    v_and_b32 v30, 31, v1
    v_lshl_add_u32 v30, v30, 7, s72
    v_lshrrev_b32 v31, 5, v1
    v_bfe_u32 v32, v1, 1, 3
    v_xor_b32 v32, v32, v31
    v_lshl_add_u32 v2, v32, 4, v30
    v_xor_b32 v3, 32, v2
    v_xor_b32 v4, 64, v2
    v_xor_b32 v5, 96, v2
    v_add_u32 v6, 81920, v2
    v_add_u32 v7, 81920, v3
    v_add_u32 v8, 81920, v4
    v_add_u32 v9, 81920, v5
    v_bfe_u32 v30, v1, 2, 2
    v_lshl_add_u32 v30, v31, 3, v30
    v_lshlrev_b32 v30, 7, v30
    v_bfe_u32 v32, v1, 3, 1
    s_lshr_b32 s72, s70, 1
    v_xor_b32 v32, s72, v32
    v_lshl_add_u32 v30, v32, 6, v30
    v_bfe_u32 v32, v1, 4, 1
    v_lshl_add_u32 v30, v32, 5, v30
    v_and_b32 v32, 3, v1
    v_lshl_add_u32 v30, v32, 3, v30
    v_add_u32 v10, 16384, v30
    v_add_u32 v11, 98304, v30
    v_lshrrev_b32 v44, 5, v1
    v_bfe_u32 v45, v1, 2, 1
    v_bfe_u32 v46, v1, 3, 1
    v_bfe_u32 v47, v1, 1, 1
    v_lshl_or_b32 v46, v46, 1, v47
    v_cmp_eq_u32 vcc, v44, v45
    v_and_b32 v47, 1, v1
    v_lshlrev_b32 v47, 4, v47
    v_mov_b32 v48, 0x3f80
    v_lshlrev_b32 v47, v47, v48
    v_cndmask_b32 v47, 0, v47, vcc
    v_bfe_u32 v45, v1, 4, 1
    v_lshl_or_b32 v46, v45, 2, v46
    v_cmp_eq_u32 vcc, 0, v46
    s_nop 1
    v_cndmask_b32 v28, 0, v47, vcc
    v_cmp_eq_u32 vcc, 1, v46
    s_nop 1
    v_cndmask_b32 v29, 0, v47, vcc
    v_cmp_eq_u32 vcc, 2, v46
    s_nop 1
    v_cndmask_b32 v30, 0, v47, vcc
    v_cmp_eq_u32 vcc, 3, v46
    s_nop 1
    v_cndmask_b32 v31, 0, v47, vcc
    v_cmp_eq_u32 vcc, 4, v46
    s_nop 1
    v_cndmask_b32 v32, 0, v47, vcc
    v_cmp_eq_u32 vcc, 5, v46
    s_nop 1
    v_cndmask_b32 v33, 0, v47, vcc
    v_cmp_eq_u32 vcc, 6, v46
    s_nop 1
    v_cndmask_b32 v34, 0, v47, vcc
    v_cmp_eq_u32 vcc, 7, v46
    s_nop 1
    v_cndmask_b32 v35, 0, v47, vcc
    s_lshl_b32 s72, s70, 12
    s_add_u32 s72, s72, 106496
    s_xor_b32 s73, s72, 4096
    v_lshlrev_b32 v40, 4, v1
    v_add_u32 v41, s72, v40
    v_add_u32 v42, s73, v40
    v_and_b32 v43, 31, v1
    v_lshlrev_b32 v43, 2, v43
    s_lshl_b32 s72, s70, 8
    s_xor_b32 s73, s72, 256
    s_add_u32 s72, s72, 161024
    s_add_u32 s73, s73, 161152
    v_lshl_add_u32 v44, v1, 2, s72
    v_add_u32 v45, s73, v43
    v_mov_b32 v62, s87
    v_mov_b32 v63, s87
    v_mov_b32 v39, 0x3f803f80
    s_lshl_b32 s77, s67, 4
    s_add_u32 s77, s77, s66
    s_lshl_b32 s77, s77, 2
    s_add_u32 s77, s77, s70
    s_mul_i32 s77, s77, 2176
    s_add_u32 s77, s77, 12582912
    s_lshl_b32 s96, s66, 4
    s_add_u32 s96, s96, s67
    s_lshl_b32 s96, s96, 14
    s_lshr_b32 s72, s70, 1
    s_lshl_b32 s72, s72, 11
    s_add_u32 s96, s96, s72
    s_and_b32 s72, s70, 1
    s_lshl_b32 s72, s72, 13
    s_add_u32 s96, s96, s72
    s_add_u32 s96, s96, 8388608
    s_add_u32 s99, s96, 4096
    s_mul_i32 s98, s70, 8704
    s_add_u32 s98, s98, 122880
    s_mov_b32 m0, s98
    v_and_b32 v126, 15, v1
    v_mul_u32_u24 v126, 544, v126
    v_lshrrev_b32 v125, 4, v1
    v_lshl_add_u32 v126, v125, 4, v126
    v_add_u32 v126, s98, v126
    s_and_b32 s76, s70, 1
    s_mul_i32 s76, s76, 0x80008000
    s_waitcnt vmcnt(18)
    v_lshlrev_b32 v134, 16, v134
    v_mul_f32 v135, s87, v134
    v_fma_f32 v136, v134, s87, -v135
    v_mov_b32 v137, 0x32a57060
    v_fmac_f32 v136, v134, v137
    v_exp_f32 v135, v135
    v_mul_f32 v136, 0x3f317218, v136
    v_fmac_f32 v135, v135, v136
    v_cvt_pk_bf16_f32 v135, v135, v135
    v_and_b32 v134, 0xffff0000, v135
    v_lshlrev_b32 v64, 16, v128
    v_and_b32 v65, 0xffff0000, v128
    v_lshlrev_b32 v66, 16, v129
    v_and_b32 v67, 0xffff0000, v129
    v_lshlrev_b32 v68, 16, v130
    v_and_b32 v69, 0xffff0000, v130
    v_lshlrev_b32 v70, 16, v131
    v_and_b32 v71, 0xffff0000, v131
    v_lshlrev_b32 v72, 16, v132
    v_and_b32 v73, 0xffff0000, v132
    v_lshlrev_b32 v74, 16, v133
    v_and_b32 v75, 0xffff0000, v133
    v_pk_mul_f32 v[64:65], v[64:65], v[134:135] op_sel_hi:[1,0]
    v_pk_mul_f32 v[66:67], v[66:67], v[134:135] op_sel_hi:[1,0]
    v_pk_mul_f32 v[68:69], v[68:69], v[134:135] op_sel_hi:[1,0]
    v_pk_mul_f32 v[70:71], v[70:71], v[134:135] op_sel_hi:[1,0]
    v_pk_mul_f32 v[46:47], v[74:75], v[70:71]
    v_pk_mul_f32 v[48:49], v[72:73], v[70:71]
    v_pk_fma_f32 v[76:77], v[72:73], v[68:69], v[46:47] neg_lo:[0,0,1] neg_hi:[0,0,1]
    v_pk_fma_f32 v[78:79], v[74:75], v[68:69], v[48:49]
    v_mul_f32 v64, s87, v64
    v_mul_f32 v65, s87, v65
    v_mul_f32 v66, 0x3e22f983, v66
    v_mul_f32 v67, 0x3e22f983, v67
    v_mul_f32 v50, 0x41000000, v64
    v_mul_f32 v51, 0x41000000, v65
    v_mul_f32 v52, 0x41000000, v66
    v_mul_f32 v53, 0x41000000, v67
    v_exp_f32 v50, v50
    v_exp_f32 v51, v51
    v_fract_f32 v52, v52
    v_fract_f32 v53, v53
    v_cos_f32 v92, v52
    v_cos_f32 v93, v53
    v_sin_f32 v94, v52
    v_sin_f32 v95, v53
    v_pk_mul_f32 v[92:93], v[92:93], v[50:51]
    v_pk_mul_f32 v[94:95], v[94:95], v[50:51]
    v_exp_f32 v50, v64
    v_exp_f32 v51, v65
    v_fract_f32 v52, v66
    v_fract_f32 v53, v67
    v_cos_f32 v80, v52
    v_cos_f32 v81, v53
    v_sin_f32 v82, v52
    v_sin_f32 v83, v53
    v_pk_mul_f32 v[80:81], v[80:81], v[50:51]
    v_pk_mul_f32 v[82:83], v[82:83], v[50:51]
    v_mul_f32 v50, 0x43000000, v64
    v_mul_f32 v51, 0x43000000, v65
    v_mul_f32 v52, 0x43000000, v66
    v_mul_f32 v53, 0x43000000, v67
    v_exp_f32 v50, v50
    v_exp_f32 v51, v51
    v_fract_f32 v52, v52
    v_fract_f32 v53, v53
    v_cos_f32 v100, v52
    v_cos_f32 v101, v53
    v_sin_f32 v102, v52
    v_sin_f32 v103, v53
    v_pk_mul_f32 v[100:101], v[100:101], v[50:51]
    v_pk_mul_f32 v[102:103], v[102:103], v[50:51]
    v_pk_mul_f32 v[46:47], v[94:95], v[94:95]
    v_pk_mul_f32 v[48:49], v[92:93], v[94:95]
    v_pk_fma_f32 v[96:97], v[92:93], v[92:93], v[46:47] neg_lo:[0,0,1] neg_hi:[0,0,1]
    v_pk_fma_f32 v[98:99], v[94:95], v[92:93], v[48:49]
    v_pk_mul_f32 v[50:51], v[82:83], v[82:83]
    v_pk_mul_f32 v[52:53], v[80:81], v[82:83]
    v_pk_fma_f32 v[84:85], v[80:81], v[80:81], v[50:51] neg_lo:[0,0,1] neg_hi:[0,0,1]
    v_pk_fma_f32 v[86:87], v[82:83], v[80:81], v[52:53]
    v_pk_mul_f32 v[46:47], v[86:87], v[86:87]
    v_pk_mul_f32 v[48:49], v[84:85], v[86:87]
    v_pk_fma_f32 v[88:89], v[84:85], v[84:85], v[46:47] neg_lo:[0,0,1] neg_hi:[0,0,1]
    v_pk_fma_f32 v[90:91], v[86:87], v[84:85], v[48:49]
    s_waitcnt vmcnt(2)
    v_lshl_or_b32 v12, v192, 16, v12
    v_lshl_or_b32 v13, v193, 16, v13
    v_lshl_or_b32 v14, v194, 16, v14
    v_lshl_or_b32 v15, v195, 16, v15
    v_lshl_or_b32 v16, v196, 16, v16
    v_lshl_or_b32 v17, v197, 16, v17
    v_lshl_or_b32 v18, v198, 16, v18
    v_lshl_or_b32 v19, v199, 16, v19
    v_mov_b32 v20, 0x3f80
    ds_write_addtid_b32 v20
    ds_write_addtid_b32 v20 offset:256
    v_cvt_pk_bf16_f32 v22, v92, -v94
    v_cvt_pk_bf16_f32 v23, v93, -v95
    ds_write_addtid_b32 v22 offset:544
    ds_write_addtid_b32 v23 offset:800
    v_cvt_pk_bf16_f32 v24, v96, -v98
    v_cvt_pk_bf16_f32 v25, v97, -v99
    ds_write_addtid_b32 v24 offset:1088
    ds_write_addtid_b32 v25 offset:1344
    v_pk_mul_f32 v[46:47], v[94:95], v[98:99]
    v_pk_mul_f32 v[48:49], v[92:93], v[98:99]
    v_pk_fma_f32 v[104:105], v[92:93], v[96:97], v[46:47] neg_lo:[0,0,1] neg_hi:[0,0,1]
    v_pk_fma_f32 v[106:107], v[94:95], v[96:97], v[48:49]
    v_cvt_pk_bf16_f32 v20, v104, -v106
    v_cvt_pk_bf16_f32 v21, v105, -v107
    ds_write_addtid_b32 v20 offset:1632
    ds_write_addtid_b32 v21 offset:1888
    v_pk_mul_f32 v[46:47], v[98:99], v[98:99]
    v_pk_mul_f32 v[48:49], v[96:97], v[98:99]
    v_pk_fma_f32 v[108:109], v[96:97], v[96:97], v[46:47] neg_lo:[0,0,1] neg_hi:[0,0,1]
    v_pk_fma_f32 v[110:111], v[98:99], v[96:97], v[48:49]
    v_cvt_pk_bf16_f32 v22, v108, -v110
    v_cvt_pk_bf16_f32 v23, v109, -v111
    ds_write_addtid_b32 v22 offset:2176
    ds_write_addtid_b32 v23 offset:2432
    v_pk_mul_f32 v[46:47], v[106:107], v[98:99]
    v_pk_mul_f32 v[48:49], v[104:105], v[98:99]
    v_pk_fma_f32 v[104:105], v[104:105], v[96:97], v[46:47] neg_lo:[0,0,1] neg_hi:[0,0,1]
    v_pk_fma_f32 v[106:107], v[106:107], v[96:97], v[48:49]
    v_cvt_pk_bf16_f32 v20, v104, -v106
    v_cvt_pk_bf16_f32 v21, v105, -v107
    ds_write_addtid_b32 v20 offset:2720
    ds_write_addtid_b32 v21 offset:2976
    v_pk_mul_f32 v[46:47], v[110:111], v[98:99]
    v_pk_mul_f32 v[48:49], v[108:109], v[98:99]
    v_pk_fma_f32 v[108:109], v[108:109], v[96:97], v[46:47] neg_lo:[0,0,1] neg_hi:[0,0,1]
    v_pk_fma_f32 v[110:111], v[110:111], v[96:97], v[48:49]
    v_cvt_pk_bf16_f32 v22, v108, -v110
    v_cvt_pk_bf16_f32 v23, v109, -v111
    ds_write_addtid_b32 v22 offset:3264
    ds_write_addtid_b32 v23 offset:3520
    v_pk_mul_f32 v[46:47], v[106:107], v[98:99]
    v_pk_mul_f32 v[48:49], v[104:105], v[98:99]
    v_pk_fma_f32 v[104:105], v[104:105], v[96:97], v[46:47] neg_lo:[0,0,1] neg_hi:[0,0,1]
    v_pk_fma_f32 v[106:107], v[106:107], v[96:97], v[48:49]
    v_cvt_pk_bf16_f32 v20, v104, -v106
    v_cvt_pk_bf16_f32 v21, v105, -v107
    ds_write_addtid_b32 v20 offset:3808
    ds_write_addtid_b32 v21 offset:4064
    v_pk_mul_f32 v[46:47], v[110:111], v[98:99]
    v_pk_mul_f32 v[48:49], v[108:109], v[98:99]
    v_pk_fma_f32 v[108:109], v[108:109], v[96:97], v[46:47] neg_lo:[0,0,1] neg_hi:[0,0,1]
    v_pk_fma_f32 v[110:111], v[110:111], v[96:97], v[48:49]
    v_cvt_pk_bf16_f32 v22, v108, -v110
    v_cvt_pk_bf16_f32 v23, v109, -v111
    ds_write_addtid_b32 v22 offset:4352
    ds_write_addtid_b32 v23 offset:4608
    v_pk_mul_f32 v[46:47], v[106:107], v[98:99]
    v_pk_mul_f32 v[48:49], v[104:105], v[98:99]
    v_pk_fma_f32 v[104:105], v[104:105], v[96:97], v[46:47] neg_lo:[0,0,1] neg_hi:[0,0,1]
    v_pk_fma_f32 v[106:107], v[106:107], v[96:97], v[48:49]
    v_cvt_pk_bf16_f32 v20, v104, -v106
    v_cvt_pk_bf16_f32 v21, v105, -v107
    ds_write_addtid_b32 v20 offset:4896
    ds_write_addtid_b32 v21 offset:5152
    v_pk_mul_f32 v[46:47], v[110:111], v[98:99]
    v_pk_mul_f32 v[48:49], v[108:109], v[98:99]
    v_pk_fma_f32 v[108:109], v[108:109], v[96:97], v[46:47] neg_lo:[0,0,1] neg_hi:[0,0,1]
    v_pk_fma_f32 v[110:111], v[110:111], v[96:97], v[48:49]
    v_cvt_pk_bf16_f32 v22, v108, -v110
    v_cvt_pk_bf16_f32 v23, v109, -v111
    ds_write_addtid_b32 v22 offset:5440
    ds_write_addtid_b32 v23 offset:5696
    v_pk_mul_f32 v[46:47], v[106:107], v[98:99]
    v_pk_mul_f32 v[48:49], v[104:105], v[98:99]
    v_pk_fma_f32 v[104:105], v[104:105], v[96:97], v[46:47] neg_lo:[0,0,1] neg_hi:[0,0,1]
    v_pk_fma_f32 v[106:107], v[106:107], v[96:97], v[48:49]
    v_cvt_pk_bf16_f32 v20, v104, -v106
    v_cvt_pk_bf16_f32 v21, v105, -v107
    ds_write_addtid_b32 v20 offset:5984
    ds_write_addtid_b32 v21 offset:6240
    v_pk_mul_f32 v[46:47], v[110:111], v[98:99]
    v_pk_mul_f32 v[48:49], v[108:109], v[98:99]
    v_pk_fma_f32 v[108:109], v[108:109], v[96:97], v[46:47] neg_lo:[0,0,1] neg_hi:[0,0,1]
    v_pk_fma_f32 v[110:111], v[110:111], v[96:97], v[48:49]
    v_cvt_pk_bf16_f32 v22, v108, -v110
    v_cvt_pk_bf16_f32 v23, v109, -v111
    ds_write_addtid_b32 v22 offset:6528
    ds_write_addtid_b32 v23 offset:6784
    v_pk_mul_f32 v[46:47], v[106:107], v[98:99]
    v_pk_mul_f32 v[48:49], v[104:105], v[98:99]
    v_pk_fma_f32 v[104:105], v[104:105], v[96:97], v[46:47] neg_lo:[0,0,1] neg_hi:[0,0,1]
    v_pk_fma_f32 v[106:107], v[106:107], v[96:97], v[48:49]
    v_cvt_pk_bf16_f32 v20, v104, -v106
    v_cvt_pk_bf16_f32 v21, v105, -v107
    ds_write_addtid_b32 v20 offset:7072
    ds_write_addtid_b32 v21 offset:7328
    v_pk_mul_f32 v[46:47], v[110:111], v[98:99]
    v_pk_mul_f32 v[48:49], v[108:109], v[98:99]
    v_pk_fma_f32 v[108:109], v[108:109], v[96:97], v[46:47] neg_lo:[0,0,1] neg_hi:[0,0,1]
    v_pk_fma_f32 v[110:111], v[110:111], v[96:97], v[48:49]
    v_cvt_pk_bf16_f32 v22, v108, -v110
    v_cvt_pk_bf16_f32 v23, v109, -v111
    ds_write_addtid_b32 v22 offset:7616
    ds_write_addtid_b32 v23 offset:7872
    v_pk_mul_f32 v[46:47], v[106:107], v[98:99]
    v_pk_mul_f32 v[48:49], v[104:105], v[98:99]
    v_pk_fma_f32 v[104:105], v[104:105], v[96:97], v[46:47] neg_lo:[0,0,1] neg_hi:[0,0,1]
    v_pk_fma_f32 v[106:107], v[106:107], v[96:97], v[48:49]
    v_cvt_pk_bf16_f32 v20, v104, -v106
    v_cvt_pk_bf16_f32 v21, v105, -v107
    ds_write_addtid_b32 v20 offset:8160
    ds_write_addtid_b32 v21 offset:8416
    ds_read_b128 v[128:131], v126 offset:0
    ds_read_b128 v[132:135], v126 offset:64
    ds_read_b128 v[136:139], v126 offset:128
    ds_read_b128 v[140:143], v126 offset:192
    ds_read_b128 v[144:147], v126 offset:256
    ds_read_b128 v[148:151], v126 offset:320
    ds_read_b128 v[152:155], v126 offset:384
    ds_read_b128 v[156:159], v126 offset:448
    v_pk_mul_f32 v[46:47], v[78:79], v[102:103]
    v_pk_mul_f32 v[48:49], v[76:77], v[102:103]
    v_pk_fma_f32 v[164:165], v[76:77], v[100:101], v[46:47] neg_lo:[0,0,1] neg_hi:[0,0,1]
    v_pk_fma_f32 v[166:167], v[78:79], v[100:101], v[48:49]
    v_cvt_pk_bf16_f32 v20, v76, v78
    v_cvt_pk_bf16_f32 v21, v77, v79
    ds_write_addtid_b32 v20 offset:0
    ds_write_addtid_b32 v21 offset:256
    v_cvt_pk_bf16_f32 v22, v164, v166
    v_cvt_pk_bf16_f32 v23, v165, v167
    ds_write_addtid_b32 v22 offset:4352
    ds_write_addtid_b32 v23 offset:4608
    v_pk_mul_f32 v[46:47], v[78:79], v[82:83]
    v_pk_mul_f32 v[48:49], v[76:77], v[82:83]
    v_pk_fma_f32 v[104:105], v[76:77], v[80:81], v[46:47] neg_lo:[0,0,1] neg_hi:[0,0,1]
    v_pk_fma_f32 v[106:107], v[78:79], v[80:81], v[48:49]
    v_cvt_pk_bf16_f32 v20, v104, v106
    v_cvt_pk_bf16_f32 v21, v105, v107
    ds_write_addtid_b32 v20 offset:544
    ds_write_addtid_b32 v21 offset:800
    v_pk_mul_f32 v[50:51], v[166:167], v[82:83]
    v_pk_mul_f32 v[52:53], v[164:165], v[82:83]
    v_pk_fma_f32 v[108:109], v[164:165], v[80:81], v[50:51] neg_lo:[0,0,1] neg_hi:[0,0,1]
    v_pk_fma_f32 v[110:111], v[166:167], v[80:81], v[52:53]
    v_cvt_pk_bf16_f32 v22, v108, v110
    v_cvt_pk_bf16_f32 v23, v109, v111
    ds_write_addtid_b32 v22 offset:4896
    ds_write_addtid_b32 v23 offset:5152
    v_pk_mul_f32 v[46:47], v[106:107], v[82:83]
    v_pk_mul_f32 v[48:49], v[104:105], v[82:83]
    v_pk_fma_f32 v[104:105], v[104:105], v[80:81], v[46:47] neg_lo:[0,0,1] neg_hi:[0,0,1]
    v_pk_fma_f32 v[106:107], v[106:107], v[80:81], v[48:49]
    v_cvt_pk_bf16_f32 v20, v104, v106
    v_cvt_pk_bf16_f32 v21, v105, v107
    ds_write_addtid_b32 v20 offset:1088
    ds_write_addtid_b32 v21 offset:1344
    v_pk_mul_f32 v[50:51], v[110:111], v[82:83]
    v_pk_mul_f32 v[52:53], v[108:109], v[82:83]
    v_pk_fma_f32 v[108:109], v[108:109], v[80:81], v[50:51] neg_lo:[0,0,1] neg_hi:[0,0,1]
    v_pk_fma_f32 v[110:111], v[110:111], v[80:81], v[52:53]
    v_cvt_pk_bf16_f32 v22, v108, v110
    v_cvt_pk_bf16_f32 v23, v109, v111
    ds_write_addtid_b32 v22 offset:5440
    ds_write_addtid_b32 v23 offset:5696
    v_pk_mul_f32 v[46:47], v[106:107], v[82:83]
    v_pk_mul_f32 v[48:49], v[104:105], v[82:83]
    v_pk_fma_f32 v[104:105], v[104:105], v[80:81], v[46:47] neg_lo:[0,0,1] neg_hi:[0,0,1]
    v_pk_fma_f32 v[106:107], v[106:107], v[80:81], v[48:49]
    v_cvt_pk_bf16_f32 v20, v104, v106
    v_cvt_pk_bf16_f32 v21, v105, v107
    ds_write_addtid_b32 v20 offset:1632
    ds_write_addtid_b32 v21 offset:1888
    v_pk_mul_f32 v[50:51], v[110:111], v[82:83]
    v_pk_mul_f32 v[52:53], v[108:109], v[82:83]
    v_pk_fma_f32 v[108:109], v[108:109], v[80:81], v[50:51] neg_lo:[0,0,1] neg_hi:[0,0,1]
    v_pk_fma_f32 v[110:111], v[110:111], v[80:81], v[52:53]
    v_cvt_pk_bf16_f32 v22, v108, v110
    v_cvt_pk_bf16_f32 v23, v109, v111
    ds_write_addtid_b32 v22 offset:5984
    ds_write_addtid_b32 v23 offset:6240
    v_pk_mul_f32 v[46:47], v[106:107], v[82:83]
    v_pk_mul_f32 v[48:49], v[104:105], v[82:83]
    v_pk_fma_f32 v[104:105], v[104:105], v[80:81], v[46:47] neg_lo:[0,0,1] neg_hi:[0,0,1]
    v_pk_fma_f32 v[106:107], v[106:107], v[80:81], v[48:49]
    v_cvt_pk_bf16_f32 v20, v104, v106
    v_cvt_pk_bf16_f32 v21, v105, v107
    ds_write_addtid_b32 v20 offset:2176
    ds_write_addtid_b32 v21 offset:2432
    v_pk_mul_f32 v[50:51], v[110:111], v[82:83]
    v_pk_mul_f32 v[52:53], v[108:109], v[82:83]
    v_pk_fma_f32 v[108:109], v[108:109], v[80:81], v[50:51] neg_lo:[0,0,1] neg_hi:[0,0,1]
    v_pk_fma_f32 v[110:111], v[110:111], v[80:81], v[52:53]
    v_cvt_pk_bf16_f32 v22, v108, v110
    v_cvt_pk_bf16_f32 v23, v109, v111
    ds_write_addtid_b32 v22 offset:6528
    ds_write_addtid_b32 v23 offset:6784
    v_pk_mul_f32 v[46:47], v[106:107], v[82:83]
    v_pk_mul_f32 v[48:49], v[104:105], v[82:83]
    v_pk_fma_f32 v[104:105], v[104:105], v[80:81], v[46:47] neg_lo:[0,0,1] neg_hi:[0,0,1]
    v_pk_fma_f32 v[106:107], v[106:107], v[80:81], v[48:49]
    v_cvt_pk_bf16_f32 v20, v104, v106
    v_cvt_pk_bf16_f32 v21, v105, v107
    ds_write_addtid_b32 v20 offset:2720
    ds_write_addtid_b32 v21 offset:2976
    v_pk_mul_f32 v[50:51], v[110:111], v[82:83]
    v_pk_mul_f32 v[52:53], v[108:109], v[82:83]
    v_pk_fma_f32 v[108:109], v[108:109], v[80:81], v[50:51] neg_lo:[0,0,1] neg_hi:[0,0,1]
    v_pk_fma_f32 v[110:111], v[110:111], v[80:81], v[52:53]
    v_cvt_pk_bf16_f32 v22, v108, v110
    v_cvt_pk_bf16_f32 v23, v109, v111
    ds_write_addtid_b32 v22 offset:7072
    ds_write_addtid_b32 v23 offset:7328
    v_pk_mul_f32 v[46:47], v[106:107], v[82:83]
    v_pk_mul_f32 v[48:49], v[104:105], v[82:83]
    v_pk_fma_f32 v[104:105], v[104:105], v[80:81], v[46:47] neg_lo:[0,0,1] neg_hi:[0,0,1]
    v_pk_fma_f32 v[106:107], v[106:107], v[80:81], v[48:49]
    v_cvt_pk_bf16_f32 v20, v104, v106
    v_cvt_pk_bf16_f32 v21, v105, v107
    ds_write_addtid_b32 v20 offset:3264
    ds_write_addtid_b32 v21 offset:3520
    v_pk_mul_f32 v[50:51], v[110:111], v[82:83]
    v_pk_mul_f32 v[52:53], v[108:109], v[82:83]
    v_pk_fma_f32 v[108:109], v[108:109], v[80:81], v[50:51] neg_lo:[0,0,1] neg_hi:[0,0,1]
    v_pk_fma_f32 v[110:111], v[110:111], v[80:81], v[52:53]
    v_cvt_pk_bf16_f32 v22, v108, v110
    v_cvt_pk_bf16_f32 v23, v109, v111
    ds_write_addtid_b32 v22 offset:7616
    ds_write_addtid_b32 v23 offset:7872
    v_pk_mul_f32 v[46:47], v[106:107], v[82:83]
    v_pk_mul_f32 v[48:49], v[104:105], v[82:83]
    v_pk_fma_f32 v[104:105], v[104:105], v[80:81], v[46:47] neg_lo:[0,0,1] neg_hi:[0,0,1]
    v_pk_fma_f32 v[106:107], v[106:107], v[80:81], v[48:49]
    v_cvt_pk_bf16_f32 v20, v104, v106
    v_cvt_pk_bf16_f32 v21, v105, v107
    ds_write_addtid_b32 v20 offset:3808
    ds_write_addtid_b32 v21 offset:4064
    v_pk_mul_f32 v[50:51], v[110:111], v[82:83]
    v_pk_mul_f32 v[52:53], v[108:109], v[82:83]
    v_pk_fma_f32 v[108:109], v[108:109], v[80:81], v[50:51] neg_lo:[0,0,1] neg_hi:[0,0,1]
    v_pk_fma_f32 v[110:111], v[110:111], v[80:81], v[52:53]
    v_cvt_pk_bf16_f32 v22, v108, v110
    v_cvt_pk_bf16_f32 v23, v109, v111
    ds_write_addtid_b32 v22 offset:8160
    ds_write_addtid_b32 v23 offset:8416
    ds_read_b128 v[192:195], v126 offset:0
    ds_read_b128 v[196:199], v126 offset:64
    ds_read_b128 v[200:203], v126 offset:128
    ds_read_b128 v[204:207], v126 offset:192
    ds_read_b128 v[208:211], v126 offset:256
    ds_read_b128 v[212:215], v126 offset:320
    ds_read_b128 v[216:219], v126 offset:384
    ds_read_b128 v[220:223], v126 offset:448
    v_pk_mul_f32 v[46:47], v[166:167], v[102:103]
    v_pk_mul_f32 v[48:49], v[164:165], v[102:103]
    v_pk_fma_f32 v[168:169], v[164:165], v[100:101], v[46:47] neg_lo:[0,0,1] neg_hi:[0,0,1]
    v_pk_fma_f32 v[170:171], v[166:167], v[100:101], v[48:49]
    v_pk_mul_f32 v[46:47], v[170:171], v[102:103]
    v_pk_mul_f32 v[48:49], v[168:169], v[102:103]
    v_pk_fma_f32 v[172:173], v[168:169], v[100:101], v[46:47] neg_lo:[0,0,1] neg_hi:[0,0,1]
    v_pk_fma_f32 v[174:175], v[170:171], v[100:101], v[48:49]
    v_pk_mul_f32 v[46:47], v[174:175], v[102:103]
    v_pk_mul_f32 v[48:49], v[172:173], v[102:103]
    v_pk_fma_f32 v[176:177], v[172:173], v[100:101], v[46:47] neg_lo:[0,0,1] neg_hi:[0,0,1]
    v_pk_fma_f32 v[178:179], v[174:175], v[100:101], v[48:49]
    v_pk_mul_f32 v[46:47], v[178:179], v[102:103]
    v_pk_mul_f32 v[48:49], v[176:177], v[102:103]
    v_pk_fma_f32 v[180:181], v[176:177], v[100:101], v[46:47] neg_lo:[0,0,1] neg_hi:[0,0,1]
    v_pk_fma_f32 v[182:183], v[178:179], v[100:101], v[48:49]
    v_pk_mul_f32 v[46:47], v[182:183], v[102:103]
    v_pk_mul_f32 v[48:49], v[180:181], v[102:103]
    v_pk_fma_f32 v[184:185], v[180:181], v[100:101], v[46:47] neg_lo:[0,0,1] neg_hi:[0,0,1]
    v_pk_fma_f32 v[186:187], v[182:183], v[100:101], v[48:49]
    v_pk_mul_f32 v[46:47], v[186:187], v[102:103]
    v_pk_mul_f32 v[48:49], v[184:185], v[102:103]
    v_pk_fma_f32 v[188:189], v[184:185], v[100:101], v[46:47] neg_lo:[0,0,1] neg_hi:[0,0,1]
    v_pk_fma_f32 v[190:191], v[186:187], v[100:101], v[48:49]
    v_pk_mul_f32 v[46:47], v[170:171], v[86:87]
    v_pk_mul_f32 v[48:49], v[168:169], v[86:87]
    v_pk_fma_f32 v[224:225], v[168:169], v[84:85], v[46:47] neg_lo:[0,0,1] neg_hi:[0,0,1]
    v_pk_fma_f32 v[226:227], v[170:171], v[84:85], v[48:49]
    v_pk_mul_f32 v[50:51], v[174:175], v[86:87]
    v_pk_mul_f32 v[52:53], v[172:173], v[86:87]
    v_pk_fma_f32 v[236:237], v[172:173], v[84:85], v[50:51] neg_lo:[0,0,1] neg_hi:[0,0,1]
    v_pk_fma_f32 v[238:239], v[174:175], v[84:85], v[52:53]
    v_pk_mul_f32 v[46:47], v[226:227], v[86:87]
    v_pk_mul_f32 v[48:49], v[224:225], v[86:87]
    v_pk_fma_f32 v[228:229], v[224:225], v[84:85], v[46:47] neg_lo:[0,0,1] neg_hi:[0,0,1]
    v_pk_fma_f32 v[230:231], v[226:227], v[84:85], v[48:49]
    v_pk_mul_f32 v[50:51], v[238:239], v[86:87]
    v_pk_mul_f32 v[52:53], v[236:237], v[86:87]
    v_pk_fma_f32 v[240:241], v[236:237], v[84:85], v[50:51] neg_lo:[0,0,1] neg_hi:[0,0,1]
    v_pk_fma_f32 v[242:243], v[238:239], v[84:85], v[52:53]
    v_pk_mul_f32 v[46:47], v[230:231], v[86:87]
    v_pk_mul_f32 v[48:49], v[228:229], v[86:87]
    v_pk_fma_f32 v[232:233], v[228:229], v[84:85], v[46:47] neg_lo:[0,0,1] neg_hi:[0,0,1]
    v_pk_fma_f32 v[234:235], v[230:231], v[84:85], v[48:49]
    v_pk_mul_f32 v[50:51], v[242:243], v[86:87]
    v_pk_mul_f32 v[52:53], v[240:241], v[86:87]
    v_pk_fma_f32 v[244:245], v[240:241], v[84:85], v[50:51] neg_lo:[0,0,1] neg_hi:[0,0,1]
    v_pk_fma_f32 v[246:247], v[242:243], v[84:85], v[52:53]
    v_pk_mul_f32 v[46:47], v[178:179], v[90:91]
    v_pk_mul_f32 v[48:49], v[176:177], v[90:91]
    v_pk_fma_f32 v[248:249], v[176:177], v[88:89], v[46:47] neg_lo:[0,0,1] neg_hi:[0,0,1]
    v_pk_fma_f32 v[250:251], v[178:179], v[88:89], v[48:49]
    v_pk_mul_f32 v[50:51], v[250:251], v[90:91]
    v_pk_mul_f32 v[52:53], v[248:249], v[90:91]
    v_pk_fma_f32 v[104:105], v[248:249], v[88:89], v[50:51] neg_lo:[0,0,1] neg_hi:[0,0,1]
    v_pk_fma_f32 v[106:107], v[250:251], v[88:89], v[52:53]
    v_pk_mul_f32 v[46:47], v[182:183], v[90:91]
    v_pk_mul_f32 v[48:49], v[180:181], v[90:91]
    v_pk_fma_f32 v[108:109], v[180:181], v[88:89], v[46:47] neg_lo:[0,0,1] neg_hi:[0,0,1]
    v_pk_fma_f32 v[110:111], v[182:183], v[88:89], v[48:49]
    v_pk_mul_f32 v[50:51], v[110:111], v[90:91]
    v_pk_mul_f32 v[52:53], v[108:109], v[90:91]
    v_pk_fma_f32 v[64:65], v[108:109], v[88:89], v[50:51] neg_lo:[0,0,1] neg_hi:[0,0,1]
    v_pk_fma_f32 v[66:67], v[110:111], v[88:89], v[52:53]
    v_pk_mul_f32 v[46:47], v[186:187], v[90:91]
    v_pk_mul_f32 v[48:49], v[184:185], v[90:91]
    v_pk_fma_f32 v[68:69], v[184:185], v[88:89], v[46:47] neg_lo:[0,0,1] neg_hi:[0,0,1]
    v_pk_fma_f32 v[70:71], v[186:187], v[88:89], v[48:49]
    v_pk_mul_f32 v[50:51], v[70:71], v[90:91]
    v_pk_mul_f32 v[52:53], v[68:69], v[90:91]
    v_pk_fma_f32 v[72:73], v[68:69], v[88:89], v[50:51] neg_lo:[0,0,1] neg_hi:[0,0,1]
    v_pk_fma_f32 v[74:75], v[70:71], v[88:89], v[52:53]
    v_pk_mul_f32 v[46:47], v[190:191], v[90:91]
    v_pk_mul_f32 v[48:49], v[188:189], v[90:91]
    v_pk_fma_f32 v[92:93], v[188:189], v[88:89], v[46:47] neg_lo:[0,0,1] neg_hi:[0,0,1]
    v_pk_fma_f32 v[94:95], v[190:191], v[88:89], v[48:49]
    v_pk_mul_f32 v[50:51], v[94:95], v[90:91]
    v_pk_mul_f32 v[52:53], v[92:93], v[90:91]
    v_pk_fma_f32 v[96:97], v[92:93], v[88:89], v[50:51] neg_lo:[0,0,1] neg_hi:[0,0,1]
    v_pk_fma_f32 v[98:99], v[94:95], v[88:89], v[52:53]
    s_waitcnt lgkmcnt(0)
    v_mfma_f32_16x16x32_bf16 v[112:115], v[192:195], v[128:131], 0
    v_cvt_pk_bf16_f32 v22, v168, v170
    v_cvt_pk_bf16_f32 v23, v169, v171
    ds_write_addtid_b32 v22 offset:0
    ds_write_addtid_b32 v23 offset:256
    v_cvt_pk_bf16_f32 v20, v224, v226
    v_cvt_pk_bf16_f32 v21, v225, v227
    ds_write_addtid_b32 v20 offset:544
    ds_write_addtid_b32 v21 offset:800
    v_mfma_f32_16x16x32_bf16 v[112:115], v[196:199], v[132:135], v[112:115]
    v_cvt_pk_bf16_f32 v22, v228, v230
    v_cvt_pk_bf16_f32 v23, v229, v231
    ds_write_addtid_b32 v22 offset:1088
    ds_write_addtid_b32 v23 offset:1344
    v_cvt_pk_bf16_f32 v20, v232, v234
    v_cvt_pk_bf16_f32 v21, v233, v235
    ds_write_addtid_b32 v20 offset:1632
    ds_write_addtid_b32 v21 offset:1888
    v_mfma_f32_16x16x32_bf16 v[112:115], v[200:203], v[136:139], v[112:115]
    v_cvt_pk_bf16_f32 v22, v172, v174
    v_cvt_pk_bf16_f32 v23, v173, v175
    ds_write_addtid_b32 v22 offset:2176
    ds_write_addtid_b32 v23 offset:2432
    v_cvt_pk_bf16_f32 v20, v236, v238
    v_cvt_pk_bf16_f32 v21, v237, v239
    ds_write_addtid_b32 v20 offset:2720
    ds_write_addtid_b32 v21 offset:2976
    v_mfma_f32_16x16x32_bf16 v[112:115], v[204:207], v[140:143], v[112:115]
    v_cvt_pk_bf16_f32 v22, v240, v242
    v_cvt_pk_bf16_f32 v23, v241, v243
    ds_write_addtid_b32 v22 offset:3264
    ds_write_addtid_b32 v23 offset:3520
    v_cvt_pk_bf16_f32 v20, v244, v246
    v_cvt_pk_bf16_f32 v21, v245, v247
    ds_write_addtid_b32 v20 offset:3808
    ds_write_addtid_b32 v21 offset:4064
    v_mfma_f32_16x16x32_bf16 v[112:115], v[208:211], v[144:147], v[112:115]
    v_cvt_pk_bf16_f32 v22, v248, v250
    v_cvt_pk_bf16_f32 v23, v249, v251
    ds_write_addtid_b32 v22 offset:4352
    ds_write_addtid_b32 v23 offset:4608
    v_cvt_pk_bf16_f32 v20, v104, v106
    v_cvt_pk_bf16_f32 v21, v105, v107
    ds_write_addtid_b32 v20 offset:4896
    ds_write_addtid_b32 v21 offset:5152
    v_mfma_f32_16x16x32_bf16 v[112:115], v[212:215], v[148:151], v[112:115]
    v_cvt_pk_bf16_f32 v22, v108, v110
    v_cvt_pk_bf16_f32 v23, v109, v111
    ds_write_addtid_b32 v22 offset:5440
    ds_write_addtid_b32 v23 offset:5696
    v_cvt_pk_bf16_f32 v20, v64, v66
    v_cvt_pk_bf16_f32 v21, v65, v67
    ds_write_addtid_b32 v20 offset:5984
    ds_write_addtid_b32 v21 offset:6240
    v_mfma_f32_16x16x32_bf16 v[112:115], v[216:219], v[152:155], v[112:115]
    v_cvt_pk_bf16_f32 v22, v68, v70
    v_cvt_pk_bf16_f32 v23, v69, v71
    ds_write_addtid_b32 v22 offset:6528
    ds_write_addtid_b32 v23 offset:6784
    v_cvt_pk_bf16_f32 v20, v72, v74
    v_cvt_pk_bf16_f32 v21, v73, v75
    ds_write_addtid_b32 v20 offset:7072
    ds_write_addtid_b32 v21 offset:7328
    v_mfma_f32_16x16x32_bf16 v[112:115], v[220:223], v[156:159], v[112:115]
    v_cvt_pk_bf16_f32 v22, v92, v94
    v_cvt_pk_bf16_f32 v23, v93, v95
    ds_write_addtid_b32 v22 offset:7616
    ds_write_addtid_b32 v23 offset:7872
    v_cvt_pk_bf16_f32 v20, v96, v98
    v_cvt_pk_bf16_f32 v21, v97, v99
    ds_write_addtid_b32 v20 offset:8160
    ds_write_addtid_b32 v21 offset:8416
    ds_read_b128 v[192:195], v126 offset:0
    ds_read_b128 v[196:199], v126 offset:64
    ds_read_b128 v[200:203], v126 offset:128
    ds_read_b128 v[204:207], v126 offset:192
    ds_read_b128 v[208:211], v126 offset:256
    ds_read_b128 v[212:215], v126 offset:320
    ds_read_b128 v[216:219], v126 offset:384
    ds_read_b128 v[220:223], v126 offset:448
    v_pk_mul_f32 v[46:47], v[98:99], v[102:103]
    v_pk_mul_f32 v[48:49], v[96:97], v[102:103]
    v_pk_fma_f32 v[224:225], v[96:97], v[100:101], v[46:47] neg_lo:[0,0,1] neg_hi:[0,0,1]
    v_pk_fma_f32 v[226:227], v[98:99], v[100:101], v[48:49]
    v_pk_mul_f32 v[46:47], v[226:227], v[102:103]
    v_pk_mul_f32 v[48:49], v[224:225], v[102:103]
    v_pk_fma_f32 v[228:229], v[224:225], v[100:101], v[46:47] neg_lo:[0,0,1] neg_hi:[0,0,1]
    v_pk_fma_f32 v[230:231], v[226:227], v[100:101], v[48:49]
    v_pk_mul_f32 v[46:47], v[230:231], v[102:103]
    v_pk_mul_f32 v[48:49], v[228:229], v[102:103]
    v_pk_fma_f32 v[232:233], v[228:229], v[100:101], v[46:47] neg_lo:[0,0,1] neg_hi:[0,0,1]
    v_pk_fma_f32 v[234:235], v[230:231], v[100:101], v[48:49]
    v_pk_mul_f32 v[46:47], v[234:235], v[102:103]
    v_pk_mul_f32 v[48:49], v[232:233], v[102:103]
    v_pk_fma_f32 v[236:237], v[232:233], v[100:101], v[46:47] neg_lo:[0,0,1] neg_hi:[0,0,1]
    v_pk_fma_f32 v[238:239], v[234:235], v[100:101], v[48:49]
    v_pk_mul_f32 v[46:47], v[238:239], v[102:103]
    v_pk_mul_f32 v[48:49], v[236:237], v[102:103]
    v_pk_fma_f32 v[240:241], v[236:237], v[100:101], v[46:47] neg_lo:[0,0,1] neg_hi:[0,0,1]
    v_pk_fma_f32 v[242:243], v[238:239], v[100:101], v[48:49]
    v_pk_mul_f32 v[46:47], v[242:243], v[102:103]
    v_pk_mul_f32 v[48:49], v[240:241], v[102:103]
    v_pk_fma_f32 v[244:245], v[240:241], v[100:101], v[46:47] neg_lo:[0,0,1] neg_hi:[0,0,1]
    v_pk_fma_f32 v[246:247], v[242:243], v[100:101], v[48:49]
    v_pk_mul_f32 v[46:47], v[246:247], v[102:103]
    v_pk_mul_f32 v[48:49], v[244:245], v[102:103]
    v_pk_fma_f32 v[248:249], v[244:245], v[100:101], v[46:47] neg_lo:[0,0,1] neg_hi:[0,0,1]
    v_pk_fma_f32 v[250:251], v[246:247], v[100:101], v[48:49]
    v_pk_mul_f32 v[46:47], v[250:251], v[102:103]
    v_pk_mul_f32 v[48:49], v[248:249], v[102:103]
    v_pk_fma_f32 v[104:105], v[248:249], v[100:101], v[46:47] neg_lo:[0,0,1] neg_hi:[0,0,1]
    v_pk_fma_f32 v[106:107], v[250:251], v[100:101], v[48:49]
    s_cmp_eq_u32 s2, 0
    s_cselect_b32 s72, 0, 0x1000
    s_lshl_b32 s73, s70, 2
    s_add_u32 s72, s72, s73
    v_mov_b32 v36, 0x1000
    v_writelane_b32 v36, s72, 0
    s_waitcnt vmcnt(0)
    buffer_store_dword v61, v36, s[60:63], 0 offen sc1
    s_waitcnt lgkmcnt(0)
    v_mfma_f32_16x16x32_bf16 v[116:119], v[192:195], v[128:131], 0
    v_cvt_pk_bf16_f32 v22, v224, v226
    v_cvt_pk_bf16_f32 v23, v225, v227
    ds_write_addtid_b32 v22 offset:0
    ds_write_addtid_b32 v23 offset:256
    v_cvt_pk_bf16_f32 v20, v228, v230
    v_mfma_f32_16x16x32_bf16 v[116:119], v[196:199], v[132:135], v[116:119]
    v_cvt_pk_bf16_f32 v21, v229, v231
    ds_write_addtid_b32 v20 offset:544
    ds_write_addtid_b32 v21 offset:800
    v_cvt_pk_bf16_f32 v22, v232, v234
    v_mfma_f32_16x16x32_bf16 v[116:119], v[200:203], v[136:139], v[116:119]
    v_cvt_pk_bf16_f32 v23, v233, v235
    ds_write_addtid_b32 v22 offset:1088
    ds_write_addtid_b32 v23 offset:1344
    v_cvt_pk_bf16_f32 v20, v236, v238
    v_cvt_pk_bf16_f32 v21, v237, v239
    v_mfma_f32_16x16x32_bf16 v[116:119], v[204:207], v[140:143], v[116:119]
    ds_write_addtid_b32 v20 offset:1632
    ds_write_addtid_b32 v21 offset:1888
    v_cvt_pk_bf16_f32 v22, v240, v242
    v_cvt_pk_bf16_f32 v23, v241, v243
    v_mfma_f32_16x16x32_bf16 v[116:119], v[208:211], v[144:147], v[116:119]
    ds_write_addtid_b32 v22 offset:2176
    ds_write_addtid_b32 v23 offset:2432
    v_cvt_pk_bf16_f32 v20, v244, v246
    v_cvt_pk_bf16_f32 v21, v245, v247
    ds_write_addtid_b32 v20 offset:2720
    v_mfma_f32_16x16x32_bf16 v[116:119], v[212:215], v[148:151], v[116:119]
    ds_write_addtid_b32 v21 offset:2976
    v_cvt_pk_bf16_f32 v22, v248, v250
    v_cvt_pk_bf16_f32 v23, v249, v251
    ds_write_addtid_b32 v22 offset:3264
    v_mfma_f32_16x16x32_bf16 v[116:119], v[216:219], v[152:155], v[116:119]
    ds_write_addtid_b32 v23 offset:3520
    v_cvt_pk_bf16_f32 v20, v104, v106
    v_cvt_pk_bf16_f32 v21, v105, v107
    ds_write_addtid_b32 v20 offset:3808
    ds_write_addtid_b32 v21 offset:4064
    v_mfma_f32_16x16x32_bf16 v[116:119], v[220:223], v[156:159], v[116:119]
    v_cvt_pk_bf16_f32 v24, v176, v178
    v_cvt_pk_bf16_f32 v25, v177, v179
    ds_write_addtid_b32 v24 offset:4352
    ds_write_addtid_b32 v25 offset:4608
    ds_read_b128 v[192:195], v126 offset:0
    ds_read_b128 v[196:199], v126 offset:64
    ds_read_b128 v[200:203], v126 offset:128
    ds_read_b128 v[204:207], v126 offset:192
    ds_read_b128 v[208:211], v126 offset:256
    ds_read_b128 v[212:215], v126 offset:320
    ds_read_b128 v[216:219], v126 offset:384
    ds_read_b128 v[220:223], v126 offset:448
    s_waitcnt lgkmcnt(7)
    v_mfma_f32_16x16x32_bf16 v[120:123], v[192:195], v[128:131], 0
    s_waitcnt lgkmcnt(6)
    v_mfma_f32_16x16x32_bf16 v[120:123], v[196:199], v[132:135], v[120:123]
    s_waitcnt lgkmcnt(5)
    v_mfma_f32_16x16x32_bf16 v[120:123], v[200:203], v[136:139], v[120:123]
    s_waitcnt lgkmcnt(4)
    v_mfma_f32_16x16x32_bf16 v[120:123], v[204:207], v[140:143], v[120:123]
    s_waitcnt lgkmcnt(3)
    v_mfma_f32_16x16x32_bf16 v[120:123], v[208:211], v[144:147], v[120:123]
    s_waitcnt lgkmcnt(2)
    v_mfma_f32_16x16x32_bf16 v[120:123], v[212:215], v[148:151], v[120:123]
    s_waitcnt lgkmcnt(1)
    v_mfma_f32_16x16x32_bf16 v[120:123], v[216:219], v[152:155], v[120:123]
    s_waitcnt lgkmcnt(0)
    v_mfma_f32_16x16x32_bf16 v[120:123], v[220:223], v[156:159], v[120:123]
    v_cvt_pk_bf16_f32 v46, v113, v112
    v_cvt_pk_bf16_f32 v47, v115, v114
    v_cvt_pk_bf16_f32 v48, v116, v117
    v_cvt_pk_bf16_f32 v49, v118, v119
    ds_write_addtid_b32 v46 offset:0
    ds_write_addtid_b32 v47 offset:256
    ds_write_addtid_b32 v48 offset:512
    ds_write_addtid_b32 v49 offset:768
    v_xor_b32 v20, s76, v12
    v_xor_b32 v21, s76, v13
    v_xor_b32 v22, s76, v14
    v_xor_b32 v23, s76, v15
    v_xor_b32 v24, s76, v16
    v_xor_b32 v25, s76, v17
    v_xor_b32 v26, s76, v18
    v_xor_b32 v27, s76, v19
    v_cvt_pk_bf16_f32 v50, v120, v121
    v_cvt_pk_bf16_f32 v51, v122, v123
    ds_write_addtid_b32 v50 offset:1024
    ds_write_addtid_b32 v51 offset:1280
    s_waitcnt lgkmcnt(0)
    s_barrier
    ds_read_b128 v[160:163], v2 offset:0
    ds_read_b64_tr_b16 v[168:169], v10 offset:0
    ds_read_b64_tr_b16 v[170:171], v10 offset:512
    ds_read_b64_tr_b16 v[172:173], v10 offset:8192
    ds_read_b64_tr_b16 v[174:175], v10 offset:8704
    ds_read_b128 v[164:167], v2 offset:4096
    ds_read_b64_tr_b16 v[176:177], v10 offset:16384
    ds_read_b64_tr_b16 v[178:179], v10 offset:16896
    s_waitcnt lgkmcnt(5)
    v_mfma_f32_32x32x16_bf16 v[64:79], v[168:171], v[160:163], 0
    ds_read_b128 v[180:183], v3 offset:0
    ds_read_b64_tr_b16 v[188:189], v10 offset:2048
    s_waitcnt lgkmcnt(5)
    v_mfma_f32_32x32x16_bf16 v[96:111], v[172:175], v[160:163], 0
    ds_read_b64_tr_b16 v[190:191], v10 offset:2560
    ds_read_b64_tr_b16 v[192:193], v10 offset:10240
    s_waitcnt lgkmcnt(6)
    v_mfma_f32_32x32x16_bf16 v[80:95], v[168:171], v[164:167], 0
    ds_read_b64_tr_b16 v[194:195], v10 offset:10752
    ds_read_b128 v[184:187], v3 offset:4096
    v_mfma_f32_32x32x16_bf16 v[112:127], v[172:175], v[164:167], 0
    ds_read_b64_tr_b16 v[196:197], v10 offset:18432
    ds_read_b64_tr_b16 v[198:199], v10 offset:18944
    s_waitcnt lgkmcnt(8)
    v_mfma_f32_32x32x16_bf16 v[128:143], v[160:163], v[176:179], 0
    v_mfma_f32_32x32x16_bf16 v[144:159], v[164:167], v[176:179], 0
    s_waitcnt lgkmcnt(5)
    v_mfma_f32_32x32x16_bf16 v[64:79], v[188:191], v[180:183], v[64:79]
    ds_read_b128 v[160:163], v4 offset:0
    ds_read_b64_tr_b16 v[168:169], v10 offset:4096
    s_waitcnt lgkmcnt(5)
    v_mfma_f32_32x32x16_bf16 v[96:111], v[192:195], v[180:183], v[96:111]
    ds_read_b64_tr_b16 v[170:171], v10 offset:4608
    ds_read_b64_tr_b16 v[172:173], v10 offset:12288
    s_waitcnt lgkmcnt(6)
    v_mfma_f32_32x32x16_bf16 v[80:95], v[188:191], v[184:187], v[80:95]
    ds_read_b64_tr_b16 v[174:175], v10 offset:12800
    ds_read_b128 v[164:167], v4 offset:4096
    v_mfma_f32_32x32x16_bf16 v[112:127], v[192:195], v[184:187], v[112:127]
    ds_read_b64_tr_b16 v[176:177], v10 offset:20480
    ds_read_b64_tr_b16 v[178:179], v10 offset:20992
    s_waitcnt lgkmcnt(8)
    v_mfma_f32_32x32x16_bf16 v[128:143], v[180:183], v[196:199], v[128:143]
    v_mfma_f32_32x32x16_bf16 v[144:159], v[184:187], v[196:199], v[144:159]
    s_waitcnt lgkmcnt(5)
    v_mfma_f32_32x32x16_bf16 v[64:79], v[168:171], v[160:163], v[64:79]
    ds_read_b128 v[180:183], v5 offset:0
    ds_read_b64_tr_b16 v[188:189], v10 offset:6144
    s_waitcnt lgkmcnt(5)
    v_mfma_f32_32x32x16_bf16 v[96:111], v[172:175], v[160:163], v[96:111]
    ds_read_b64_tr_b16 v[190:191], v10 offset:6656
    ds_read_b64_tr_b16 v[192:193], v10 offset:14336
    s_waitcnt lgkmcnt(6)
    v_mfma_f32_32x32x16_bf16 v[80:95], v[168:171], v[164:167], v[80:95]
    ds_read_b64_tr_b16 v[194:195], v10 offset:14848
    ds_read_b128 v[184:187], v5 offset:4096
    v_mfma_f32_32x32x16_bf16 v[112:127], v[172:175], v[164:167], v[112:127]
    ds_read_b64_tr_b16 v[196:197], v10 offset:22528
    ds_read_b64_tr_b16 v[198:199], v10 offset:23040
    s_waitcnt lgkmcnt(8)
    v_mfma_f32_32x32x16_bf16 v[128:143], v[160:163], v[176:179], v[128:143]
    v_mfma_f32_32x32x16_bf16 v[144:159], v[164:167], v[176:179], v[144:159]
    s_waitcnt lgkmcnt(5)
    v_mfma_f32_32x32x16_bf16 v[64:79], v[188:191], v[180:183], v[64:79]
    s_waitcnt lgkmcnt(3)
    v_mfma_f32_32x32x16_bf16 v[96:111], v[192:195], v[180:183], v[96:111]
    s_waitcnt lgkmcnt(0)
    s_barrier
    v_mfma_f32_32x32x16_bf16 v[80:95], v[188:191], v[184:187], v[80:95]
    ds_read_b128 v[160:163], v2 offset:40960
    ds_read_b64_tr_b16 v[168:169], v10 offset:40960
    ds_read_b64_tr_b16 v[170:171], v10 offset:41472
    v_mfma_f32_32x32x16_bf16 v[112:127], v[192:195], v[184:187], v[112:127]
    ds_read_b64_tr_b16 v[172:173], v10 offset:49152
    ds_read_b64_tr_b16 v[174:175], v10 offset:49664
    ds_read_b128 v[164:167], v2 offset:45056
    v_mfma_f32_32x32x16_bf16 v[128:143], v[180:183], v[196:199], v[128:143]
    ds_read_b64_tr_b16 v[176:177], v10 offset:57344
    ds_read_b64_tr_b16 v[178:179], v10 offset:57856
    v_mfma_f32_32x32x16_bf16 v[144:159], v[184:187], v[196:199], v[144:159]
    s_waitcnt lgkmcnt(5)
    v_mfma_f32_32x32x16_bf16 v[64:79], v[168:171], v[160:163], v[64:79]
    ds_read_b128 v[180:183], v3 offset:40960
    ds_read_b64_tr_b16 v[188:189], v10 offset:43008
    s_waitcnt lgkmcnt(5)
    v_mfma_f32_32x32x16_bf16 v[96:111], v[172:175], v[160:163], v[96:111]
    ds_read_b64_tr_b16 v[190:191], v10 offset:43520
    ds_read_b64_tr_b16 v[192:193], v10 offset:51200
    s_waitcnt lgkmcnt(6)
    v_mfma_f32_32x32x16_bf16 v[80:95], v[168:171], v[164:167], v[80:95]
    ds_read_b64_tr_b16 v[194:195], v10 offset:51712
    ds_read_b128 v[184:187], v3 offset:45056
    v_mfma_f32_32x32x16_bf16 v[112:127], v[172:175], v[164:167], v[112:127]
    ds_read_b64_tr_b16 v[196:197], v10 offset:59392
    ds_read_b64_tr_b16 v[198:199], v10 offset:59904
    s_waitcnt lgkmcnt(8)
    v_mfma_f32_32x32x16_bf16 v[128:143], v[160:163], v[176:179], v[128:143]
    v_mfma_f32_32x32x16_bf16 v[144:159], v[164:167], v[176:179], v[144:159]
    s_waitcnt lgkmcnt(5)
    v_mfma_f32_32x32x16_bf16 v[64:79], v[188:191], v[180:183], v[64:79]
    ds_read_b128 v[160:163], v4 offset:40960
    ds_read_b64_tr_b16 v[168:169], v10 offset:45056
    s_waitcnt lgkmcnt(5)
    v_mfma_f32_32x32x16_bf16 v[96:111], v[192:195], v[180:183], v[96:111]
    ds_read_b64_tr_b16 v[170:171], v10 offset:45568
    ds_read_b64_tr_b16 v[172:173], v10 offset:53248
    s_waitcnt lgkmcnt(6)
    v_mfma_f32_32x32x16_bf16 v[80:95], v[188:191], v[184:187], v[80:95]
    ds_read_b64_tr_b16 v[174:175], v10 offset:53760
    ds_read_b128 v[164:167], v4 offset:45056
    v_mfma_f32_32x32x16_bf16 v[112:127], v[192:195], v[184:187], v[112:127]
    ds_read_b64_tr_b16 v[176:177], v10 offset:61440
    ds_read_b64_tr_b16 v[178:179], v10 offset:61952
    s_waitcnt lgkmcnt(8)
    v_mfma_f32_32x32x16_bf16 v[128:143], v[180:183], v[196:199], v[128:143]
    v_mfma_f32_32x32x16_bf16 v[144:159], v[184:187], v[196:199], v[144:159]
    s_waitcnt lgkmcnt(5)
    v_mfma_f32_32x32x16_bf16 v[64:79], v[168:171], v[160:163], v[64:79]
    ds_read_b128 v[180:183], v5 offset:40960
    ds_read_b64_tr_b16 v[188:189], v10 offset:47104
    s_waitcnt lgkmcnt(5)
    v_mfma_f32_32x32x16_bf16 v[96:111], v[172:175], v[160:163], v[96:111]
    ds_read_b64_tr_b16 v[190:191], v10 offset:47616
    ds_read_b64_tr_b16 v[192:193], v10 offset:55296
    s_waitcnt lgkmcnt(6)
    v_mfma_f32_32x32x16_bf16 v[80:95], v[168:171], v[164:167], v[80:95]
    ds_read_b64_tr_b16 v[194:195], v10 offset:55808
    ds_read_b128 v[184:187], v5 offset:45056
    v_mfma_f32_32x32x16_bf16 v[112:127], v[172:175], v[164:167], v[112:127]
    ds_read_b64_tr_b16 v[196:197], v10 offset:63488
    ds_read_b64_tr_b16 v[198:199], v10 offset:64000
    s_waitcnt lgkmcnt(8)
    v_mfma_f32_32x32x16_bf16 v[128:143], v[160:163], v[176:179], v[128:143]
    v_mfma_f32_32x32x16_bf16 v[144:159], v[164:167], v[176:179], v[144:159]
    s_waitcnt lgkmcnt(5)
    v_mfma_f32_32x32x16_bf16 v[64:79], v[188:191], v[180:183], v[64:79]
    s_waitcnt lgkmcnt(3)
    v_mfma_f32_32x32x16_bf16 v[96:111], v[192:195], v[180:183], v[96:111]
    s_waitcnt lgkmcnt(0)
    s_barrier
    v_mfma_f32_32x32x16_bf16 v[80:95], v[188:191], v[184:187], v[80:95]
    ds_read_b128 v[160:163], v6 offset:0
    ds_read_b64_tr_b16 v[168:169], v11 offset:0
    ds_read_b64_tr_b16 v[170:171], v11 offset:512
    v_mfma_f32_32x32x16_bf16 v[112:127], v[192:195], v[184:187], v[112:127]
    ds_read_b64_tr_b16 v[172:173], v11 offset:8192
    ds_read_b64_tr_b16 v[174:175], v11 offset:8704
    ds_read_b128 v[164:167], v6 offset:4096
    v_mfma_f32_32x32x16_bf16 v[128:143], v[180:183], v[196:199], v[128:143]
    ds_read_b64_tr_b16 v[176:177], v11 offset:16384
    ds_read_b64_tr_b16 v[178:179], v11 offset:16896
    v_mfma_f32_32x32x16_bf16 v[144:159], v[184:187], v[196:199], v[144:159]
    s_waitcnt lgkmcnt(5)
    v_mfma_f32_32x32x16_bf16 v[64:79], v[168:171], v[160:163], v[64:79]
    ds_read_b128 v[180:183], v7 offset:0
    ds_read_b64_tr_b16 v[188:189], v11 offset:2048
    s_waitcnt lgkmcnt(5)
    v_mfma_f32_32x32x16_bf16 v[96:111], v[172:175], v[160:163], v[96:111]
    ds_read_b64_tr_b16 v[190:191], v11 offset:2560
    ds_read_b64_tr_b16 v[192:193], v11 offset:10240
    s_waitcnt lgkmcnt(6)
    v_mfma_f32_32x32x16_bf16 v[80:95], v[168:171], v[164:167], v[80:95]
    ds_read_b64_tr_b16 v[194:195], v11 offset:10752
    ds_read_b128 v[184:187], v7 offset:4096
    v_mfma_f32_32x32x16_bf16 v[112:127], v[172:175], v[164:167], v[112:127]
    ds_read_b64_tr_b16 v[196:197], v11 offset:18432
    ds_read_b64_tr_b16 v[198:199], v11 offset:18944
    s_waitcnt lgkmcnt(8)
    v_mfma_f32_32x32x16_bf16 v[128:143], v[160:163], v[176:179], v[128:143]
    v_mfma_f32_32x32x16_bf16 v[144:159], v[164:167], v[176:179], v[144:159]
    s_waitcnt lgkmcnt(5)
    v_mfma_f32_32x32x16_bf16 v[64:79], v[188:191], v[180:183], v[64:79]
    ds_read_b128 v[160:163], v8 offset:0
    ds_read_b64_tr_b16 v[168:169], v11 offset:4096
    s_waitcnt lgkmcnt(5)
    v_mfma_f32_32x32x16_bf16 v[96:111], v[192:195], v[180:183], v[96:111]
    ds_read_b64_tr_b16 v[170:171], v11 offset:4608
    ds_read_b64_tr_b16 v[172:173], v11 offset:12288
    s_waitcnt lgkmcnt(6)
    v_mfma_f32_32x32x16_bf16 v[80:95], v[188:191], v[184:187], v[80:95]
    ds_read_b64_tr_b16 v[174:175], v11 offset:12800
    ds_read_b128 v[164:167], v8 offset:4096
    v_mfma_f32_32x32x16_bf16 v[112:127], v[192:195], v[184:187], v[112:127]
    ds_read_b64_tr_b16 v[176:177], v11 offset:20480
    ds_read_b64_tr_b16 v[178:179], v11 offset:20992
    s_waitcnt lgkmcnt(8)
    v_mfma_f32_32x32x16_bf16 v[128:143], v[180:183], v[196:199], v[128:143]
    v_mfma_f32_32x32x16_bf16 v[144:159], v[184:187], v[196:199], v[144:159]
    s_waitcnt lgkmcnt(5)
    v_mfma_f32_32x32x16_bf16 v[64:79], v[168:171], v[160:163], v[64:79]
    ds_read_b128 v[180:183], v9 offset:0
    ds_read_b64_tr_b16 v[188:189], v11 offset:6144
    s_waitcnt lgkmcnt(5)
    v_mfma_f32_32x32x16_bf16 v[96:111], v[172:175], v[160:163], v[96:111]
    ds_read_b64_tr_b16 v[190:191], v11 offset:6656
    ds_read_b64_tr_b16 v[192:193], v11 offset:14336
    s_waitcnt lgkmcnt(6)
    v_mfma_f32_32x32x16_bf16 v[80:95], v[168:171], v[164:167], v[80:95]
    ds_read_b64_tr_b16 v[194:195], v11 offset:14848
    ds_read_b128 v[184:187], v9 offset:4096
    v_mfma_f32_32x32x16_bf16 v[112:127], v[172:175], v[164:167], v[112:127]
    ds_read_b64_tr_b16 v[196:197], v11 offset:22528
    ds_read_b64_tr_b16 v[198:199], v11 offset:23040
    s_waitcnt lgkmcnt(8)
    v_mfma_f32_32x32x16_bf16 v[128:143], v[160:163], v[176:179], v[128:143]
    v_mfma_f32_32x32x16_bf16 v[144:159], v[164:167], v[176:179], v[144:159]
    s_waitcnt lgkmcnt(5)
    v_mfma_f32_32x32x16_bf16 v[64:79], v[188:191], v[180:183], v[64:79]
    s_waitcnt lgkmcnt(3)
    v_mfma_f32_32x32x16_bf16 v[96:111], v[192:195], v[180:183], v[96:111]
    s_waitcnt lgkmcnt(0)
    s_barrier
    v_mfma_f32_32x32x16_bf16 v[80:95], v[188:191], v[184:187], v[80:95]
    ds_read_b128 v[160:163], v2 offset:0
    ds_read_b64_tr_b16 v[168:169], v10 offset:0
    ds_read_b64_tr_b16 v[170:171], v10 offset:512
    v_mfma_f32_32x32x16_bf16 v[112:127], v[192:195], v[184:187], v[112:127]
    ds_read_b64_tr_b16 v[172:173], v10 offset:8192
    ds_read_b64_tr_b16 v[174:175], v10 offset:8704
    ds_read_b128 v[164:167], v2 offset:4096
    v_mfma_f32_32x32x16_bf16 v[128:143], v[180:183], v[196:199], v[128:143]
    ds_read_b64_tr_b16 v[176:177], v10 offset:16384
    ds_read_b64_tr_b16 v[178:179], v10 offset:16896
    v_mfma_f32_32x32x16_bf16 v[144:159], v[184:187], v[196:199], v[144:159]
    s_waitcnt lgkmcnt(5)
    v_mfma_f32_32x32x16_bf16 v[64:79], v[168:171], v[160:163], v[64:79]
    ds_read_b128 v[180:183], v3 offset:0
    ds_read_b64_tr_b16 v[188:189], v10 offset:2048
    s_waitcnt lgkmcnt(5)
    v_mfma_f32_32x32x16_bf16 v[96:111], v[172:175], v[160:163], v[96:111]
    ds_read_b64_tr_b16 v[190:191], v10 offset:2560
    ds_read_b64_tr_b16 v[192:193], v10 offset:10240
    s_waitcnt lgkmcnt(6)
    v_mfma_f32_32x32x16_bf16 v[80:95], v[168:171], v[164:167], v[80:95]
    ds_read_b64_tr_b16 v[194:195], v10 offset:10752
    ds_read_b128 v[184:187], v3 offset:4096
    v_mfma_f32_32x32x16_bf16 v[112:127], v[172:175], v[164:167], v[112:127]
    ds_read_b64_tr_b16 v[196:197], v10 offset:18432
    ds_read_b64_tr_b16 v[198:199], v10 offset:18944
    s_waitcnt lgkmcnt(8)
    v_mfma_f32_32x32x16_bf16 v[128:143], v[160:163], v[176:179], v[128:143]
    v_mfma_f32_32x32x16_bf16 v[144:159], v[164:167], v[176:179], v[144:159]
    s_waitcnt lgkmcnt(5)
    v_mfma_f32_32x32x16_bf16 v[64:79], v[188:191], v[180:183], v[64:79]
    ds_read_b128 v[160:163], v4 offset:0
    ds_read_b64_tr_b16 v[168:169], v10 offset:4096
    s_waitcnt lgkmcnt(5)
    v_mfma_f32_32x32x16_bf16 v[96:111], v[192:195], v[180:183], v[96:111]
    ds_read_b64_tr_b16 v[170:171], v10 offset:4608
    ds_read_b64_tr_b16 v[172:173], v10 offset:12288
    s_waitcnt lgkmcnt(6)
    v_mfma_f32_32x32x16_bf16 v[80:95], v[188:191], v[184:187], v[80:95]
    ds_read_b64_tr_b16 v[174:175], v10 offset:12800
    ds_read_b128 v[164:167], v4 offset:4096
    v_mfma_f32_32x32x16_bf16 v[112:127], v[192:195], v[184:187], v[112:127]
    ds_read_b64_tr_b16 v[176:177], v10 offset:20480
    ds_read_b64_tr_b16 v[178:179], v10 offset:20992
    s_waitcnt lgkmcnt(8)
    v_mfma_f32_32x32x16_bf16 v[128:143], v[180:183], v[196:199], v[128:143]
    v_mfma_f32_32x32x16_bf16 v[144:159], v[184:187], v[196:199], v[144:159]
    s_waitcnt lgkmcnt(5)
    v_mfma_f32_32x32x16_bf16 v[64:79], v[168:171], v[160:163], v[64:79]
    ds_read_b128 v[180:183], v5 offset:0
    ds_read_b64_tr_b16 v[188:189], v10 offset:6144
    s_waitcnt lgkmcnt(5)
    v_mfma_f32_32x32x16_bf16 v[96:111], v[172:175], v[160:163], v[96:111]
    ds_read_b64_tr_b16 v[190:191], v10 offset:6656
    ds_read_b64_tr_b16 v[192:193], v10 offset:14336
    s_waitcnt lgkmcnt(6)
    v_mfma_f32_32x32x16_bf16 v[80:95], v[168:171], v[164:167], v[80:95]
    ds_read_b64_tr_b16 v[194:195], v10 offset:14848
    ds_read_b128 v[184:187], v5 offset:4096
    v_mfma_f32_32x32x16_bf16 v[112:127], v[172:175], v[164:167], v[112:127]
    ds_read_b64_tr_b16 v[196:197], v10 offset:22528
    ds_read_b64_tr_b16 v[198:199], v10 offset:23040
    s_waitcnt lgkmcnt(8)
    v_mfma_f32_32x32x16_bf16 v[128:143], v[160:163], v[176:179], v[128:143]
    v_mfma_f32_32x32x16_bf16 v[144:159], v[164:167], v[176:179], v[144:159]
    s_waitcnt lgkmcnt(5)
    v_mfma_f32_32x32x16_bf16 v[64:79], v[188:191], v[180:183], v[64:79]
    s_waitcnt lgkmcnt(3)
    v_mfma_f32_32x32x16_bf16 v[96:111], v[192:195], v[180:183], v[96:111]
    s_waitcnt lgkmcnt(0)
    s_barrier
    v_mfma_f32_32x32x16_bf16 v[80:95], v[188:191], v[184:187], v[80:95]
    ds_read_b128 v[160:163], v2 offset:40960
    ds_read_b64_tr_b16 v[168:169], v10 offset:40960
    ds_read_b64_tr_b16 v[170:171], v10 offset:41472
    v_mfma_f32_32x32x16_bf16 v[112:127], v[192:195], v[184:187], v[112:127]
    ds_read_b64_tr_b16 v[172:173], v10 offset:49152
    ds_read_b64_tr_b16 v[174:175], v10 offset:49664
    ds_read_b128 v[164:167], v2 offset:45056
    v_mfma_f32_32x32x16_bf16 v[128:143], v[180:183], v[196:199], v[128:143]
    ds_read_b64_tr_b16 v[176:177], v10 offset:57344
    ds_read_b64_tr_b16 v[178:179], v10 offset:57856
    v_mfma_f32_32x32x16_bf16 v[144:159], v[184:187], v[196:199], v[144:159]
    s_waitcnt lgkmcnt(5)
    v_mfma_f32_32x32x16_bf16 v[64:79], v[168:171], v[160:163], v[64:79]
    ds_read_b128 v[180:183], v3 offset:40960
    ds_read_b64_tr_b16 v[188:189], v10 offset:43008
    s_waitcnt lgkmcnt(5)
    v_mfma_f32_32x32x16_bf16 v[96:111], v[172:175], v[160:163], v[96:111]
    ds_read_b64_tr_b16 v[190:191], v10 offset:43520
    ds_read_b64_tr_b16 v[192:193], v10 offset:51200
    s_waitcnt lgkmcnt(6)
    v_mfma_f32_32x32x16_bf16 v[80:95], v[168:171], v[164:167], v[80:95]
    ds_read_b64_tr_b16 v[194:195], v10 offset:51712
    ds_read_b128 v[184:187], v3 offset:45056
    v_mfma_f32_32x32x16_bf16 v[112:127], v[172:175], v[164:167], v[112:127]
    ds_read_b64_tr_b16 v[196:197], v10 offset:59392
    ds_read_b64_tr_b16 v[198:199], v10 offset:59904
    s_waitcnt lgkmcnt(8)
    v_mfma_f32_32x32x16_bf16 v[128:143], v[160:163], v[176:179], v[128:143]
    v_mfma_f32_32x32x16_bf16 v[144:159], v[164:167], v[176:179], v[144:159]
    s_waitcnt lgkmcnt(5)
    v_mfma_f32_32x32x16_bf16 v[64:79], v[188:191], v[180:183], v[64:79]
    ds_read_b128 v[160:163], v4 offset:40960
    ds_read_b64_tr_b16 v[168:169], v10 offset:45056
    s_waitcnt lgkmcnt(5)
    v_mfma_f32_32x32x16_bf16 v[96:111], v[192:195], v[180:183], v[96:111]
    ds_read_b64_tr_b16 v[170:171], v10 offset:45568
    ds_read_b64_tr_b16 v[172:173], v10 offset:53248
    s_waitcnt lgkmcnt(6)
    v_mfma_f32_32x32x16_bf16 v[80:95], v[188:191], v[184:187], v[80:95]
    ds_read_b64_tr_b16 v[174:175], v10 offset:53760
    ds_read_b128 v[164:167], v4 offset:45056
    v_mfma_f32_32x32x16_bf16 v[112:127], v[192:195], v[184:187], v[112:127]
    ds_read_b64_tr_b16 v[176:177], v10 offset:61440
    ds_read_b64_tr_b16 v[178:179], v10 offset:61952
    s_waitcnt lgkmcnt(8)
    v_mfma_f32_32x32x16_bf16 v[128:143], v[180:183], v[196:199], v[128:143]
    v_mfma_f32_32x32x16_bf16 v[144:159], v[184:187], v[196:199], v[144:159]
    s_waitcnt lgkmcnt(5)
    v_mfma_f32_32x32x16_bf16 v[64:79], v[168:171], v[160:163], v[64:79]
    ds_read_b128 v[180:183], v5 offset:40960
    ds_read_b64_tr_b16 v[188:189], v10 offset:47104
    s_waitcnt lgkmcnt(5)
    v_mfma_f32_32x32x16_bf16 v[96:111], v[172:175], v[160:163], v[96:111]
    ds_read_b64_tr_b16 v[190:191], v10 offset:47616
    ds_read_b64_tr_b16 v[192:193], v10 offset:55296
    s_waitcnt lgkmcnt(6)
    v_mfma_f32_32x32x16_bf16 v[80:95], v[168:171], v[164:167], v[80:95]
    ds_read_b64_tr_b16 v[194:195], v10 offset:55808
    ds_read_b128 v[184:187], v5 offset:45056
    v_mfma_f32_32x32x16_bf16 v[112:127], v[172:175], v[164:167], v[112:127]
    ds_read_b64_tr_b16 v[196:197], v10 offset:63488
    ds_read_b64_tr_b16 v[198:199], v10 offset:64000
    s_waitcnt lgkmcnt(8)
    v_mfma_f32_32x32x16_bf16 v[128:143], v[160:163], v[176:179], v[128:143]
    v_mfma_f32_32x32x16_bf16 v[144:159], v[164:167], v[176:179], v[144:159]
    s_waitcnt lgkmcnt(5)
    v_mfma_f32_32x32x16_bf16 v[64:79], v[188:191], v[180:183], v[64:79]
    s_waitcnt lgkmcnt(3)
    v_mfma_f32_32x32x16_bf16 v[96:111], v[192:195], v[180:183], v[96:111]
    s_waitcnt lgkmcnt(0)
    s_barrier
    v_mfma_f32_32x32x16_bf16 v[80:95], v[188:191], v[184:187], v[80:95]
    ds_read_b128 v[160:163], v6 offset:0
    ds_read_b64_tr_b16 v[168:169], v11 offset:0
    ds_read_b64_tr_b16 v[170:171], v11 offset:512
    v_mfma_f32_32x32x16_bf16 v[112:127], v[192:195], v[184:187], v[112:127]
    ds_read_b64_tr_b16 v[172:173], v11 offset:8192
    ds_read_b64_tr_b16 v[174:175], v11 offset:8704
    ds_read_b128 v[164:167], v6 offset:4096
    v_mfma_f32_32x32x16_bf16 v[128:143], v[180:183], v[196:199], v[128:143]
    ds_read_b64_tr_b16 v[176:177], v11 offset:16384
    ds_read_b64_tr_b16 v[178:179], v11 offset:16896
    v_mfma_f32_32x32x16_bf16 v[144:159], v[184:187], v[196:199], v[144:159]
    s_waitcnt lgkmcnt(5)
    v_mfma_f32_32x32x16_bf16 v[64:79], v[168:171], v[160:163], v[64:79]
    ds_read_b128 v[180:183], v7 offset:0
    ds_read_b64_tr_b16 v[188:189], v11 offset:2048
    s_waitcnt lgkmcnt(5)
    v_mfma_f32_32x32x16_bf16 v[96:111], v[172:175], v[160:163], v[96:111]
    ds_read_b64_tr_b16 v[190:191], v11 offset:2560
    ds_read_b64_tr_b16 v[192:193], v11 offset:10240
    s_waitcnt lgkmcnt(6)
    v_mfma_f32_32x32x16_bf16 v[80:95], v[168:171], v[164:167], v[80:95]
    ds_read_b64_tr_b16 v[194:195], v11 offset:10752
    ds_read_b128 v[184:187], v7 offset:4096
    v_mfma_f32_32x32x16_bf16 v[112:127], v[172:175], v[164:167], v[112:127]
    ds_read_b64_tr_b16 v[196:197], v11 offset:18432
    ds_read_b64_tr_b16 v[198:199], v11 offset:18944
    s_waitcnt lgkmcnt(8)
    v_mfma_f32_32x32x16_bf16 v[128:143], v[160:163], v[176:179], v[128:143]
    v_mfma_f32_32x32x16_bf16 v[144:159], v[164:167], v[176:179], v[144:159]
    s_waitcnt lgkmcnt(5)
    v_mfma_f32_32x32x16_bf16 v[64:79], v[188:191], v[180:183], v[64:79]
    ds_read_b128 v[160:163], v8 offset:0
    ds_read_b64_tr_b16 v[168:169], v11 offset:4096
    s_waitcnt lgkmcnt(5)
    v_mfma_f32_32x32x16_bf16 v[96:111], v[192:195], v[180:183], v[96:111]
    ds_read_b64_tr_b16 v[170:171], v11 offset:4608
    ds_read_b64_tr_b16 v[172:173], v11 offset:12288
    s_waitcnt lgkmcnt(6)
    v_mfma_f32_32x32x16_bf16 v[80:95], v[188:191], v[184:187], v[80:95]
    ds_read_b64_tr_b16 v[174:175], v11 offset:12800
    ds_read_b128 v[164:167], v8 offset:4096
    v_mfma_f32_32x32x16_bf16 v[112:127], v[192:195], v[184:187], v[112:127]
    ds_read_b64_tr_b16 v[176:177], v11 offset:20480
    ds_read_b64_tr_b16 v[178:179], v11 offset:20992
    s_waitcnt lgkmcnt(8)
    v_mfma_f32_32x32x16_bf16 v[128:143], v[180:183], v[196:199], v[128:143]
    v_mfma_f32_32x32x16_bf16 v[144:159], v[184:187], v[196:199], v[144:159]
    s_waitcnt lgkmcnt(5)
    v_mfma_f32_32x32x16_bf16 v[64:79], v[168:171], v[160:163], v[64:79]
    ds_read_b128 v[180:183], v9 offset:0
    ds_read_b64_tr_b16 v[188:189], v11 offset:6144
    s_waitcnt lgkmcnt(5)
    v_mfma_f32_32x32x16_bf16 v[96:111], v[172:175], v[160:163], v[96:111]
    ds_read_b64_tr_b16 v[190:191], v11 offset:6656
    ds_read_b64_tr_b16 v[192:193], v11 offset:14336
    s_waitcnt lgkmcnt(6)
    v_mfma_f32_32x32x16_bf16 v[80:95], v[168:171], v[164:167], v[80:95]
    ds_read_b64_tr_b16 v[194:195], v11 offset:14848
    ds_read_b128 v[184:187], v9 offset:4096
    v_mfma_f32_32x32x16_bf16 v[112:127], v[172:175], v[164:167], v[112:127]
    ds_read_b64_tr_b16 v[196:197], v11 offset:22528
    ds_read_b64_tr_b16 v[198:199], v11 offset:23040
    s_waitcnt lgkmcnt(8)
    v_mfma_f32_32x32x16_bf16 v[128:143], v[160:163], v[176:179], v[128:143]
    v_mfma_f32_32x32x16_bf16 v[144:159], v[164:167], v[176:179], v[144:159]
    s_waitcnt lgkmcnt(5)
    v_mfma_f32_32x32x16_bf16 v[64:79], v[188:191], v[180:183], v[64:79]
    s_waitcnt lgkmcnt(3)
    v_mfma_f32_32x32x16_bf16 v[96:111], v[192:195], v[180:183], v[96:111]
    s_waitcnt lgkmcnt(0)
    s_barrier
    v_mfma_f32_32x32x16_bf16 v[80:95], v[188:191], v[184:187], v[80:95]
    ds_read_b128 v[160:163], v2 offset:0
    ds_read_b64_tr_b16 v[168:169], v10 offset:0
    ds_read_b64_tr_b16 v[170:171], v10 offset:512
    v_mfma_f32_32x32x16_bf16 v[112:127], v[192:195], v[184:187], v[112:127]
    ds_read_b64_tr_b16 v[172:173], v10 offset:8192
    ds_read_b64_tr_b16 v[174:175], v10 offset:8704
    ds_read_b128 v[164:167], v2 offset:4096
    v_mfma_f32_32x32x16_bf16 v[128:143], v[180:183], v[196:199], v[128:143]
    ds_read_b64_tr_b16 v[176:177], v10 offset:16384
    ds_read_b64_tr_b16 v[178:179], v10 offset:16896
    v_mfma_f32_32x32x16_bf16 v[144:159], v[184:187], v[196:199], v[144:159]
    s_waitcnt lgkmcnt(5)
    v_mfma_f32_32x32x16_bf16 v[64:79], v[168:171], v[160:163], v[64:79]
    ds_read_b128 v[180:183], v3 offset:0
    ds_read_b64_tr_b16 v[188:189], v10 offset:2048
    s_waitcnt lgkmcnt(5)
    v_mfma_f32_32x32x16_bf16 v[96:111], v[172:175], v[160:163], v[96:111]
    ds_read_b64_tr_b16 v[190:191], v10 offset:2560
    ds_read_b64_tr_b16 v[192:193], v10 offset:10240
    s_waitcnt lgkmcnt(6)
    v_mfma_f32_32x32x16_bf16 v[80:95], v[168:171], v[164:167], v[80:95]
    ds_read_b64_tr_b16 v[194:195], v10 offset:10752
    ds_read_b128 v[184:187], v3 offset:4096
    v_mfma_f32_32x32x16_bf16 v[112:127], v[172:175], v[164:167], v[112:127]
    ds_read_b64_tr_b16 v[196:197], v10 offset:18432
    ds_read_b64_tr_b16 v[198:199], v10 offset:18944
    s_waitcnt lgkmcnt(8)
    v_mfma_f32_32x32x16_bf16 v[128:143], v[160:163], v[176:179], v[128:143]
    v_mfma_f32_32x32x16_bf16 v[144:159], v[164:167], v[176:179], v[144:159]
    s_waitcnt lgkmcnt(5)
    v_mfma_f32_32x32x16_bf16 v[64:79], v[188:191], v[180:183], v[64:79]
    ds_read_b128 v[160:163], v4 offset:0
    ds_read_b64_tr_b16 v[168:169], v10 offset:4096
    s_waitcnt lgkmcnt(5)
    v_mfma_f32_32x32x16_bf16 v[96:111], v[192:195], v[180:183], v[96:111]
    ds_read_b64_tr_b16 v[170:171], v10 offset:4608
    ds_read_b64_tr_b16 v[172:173], v10 offset:12288
    s_waitcnt lgkmcnt(6)
    v_mfma_f32_32x32x16_bf16 v[80:95], v[188:191], v[184:187], v[80:95]
    ds_read_b64_tr_b16 v[174:175], v10 offset:12800
    ds_read_b128 v[164:167], v4 offset:4096
    v_mfma_f32_32x32x16_bf16 v[112:127], v[192:195], v[184:187], v[112:127]
    ds_read_b64_tr_b16 v[176:177], v10 offset:20480
    ds_read_b64_tr_b16 v[178:179], v10 offset:20992
    s_waitcnt lgkmcnt(8)
    v_mfma_f32_32x32x16_bf16 v[128:143], v[180:183], v[196:199], v[128:143]
    v_mfma_f32_32x32x16_bf16 v[144:159], v[184:187], v[196:199], v[144:159]
    s_waitcnt lgkmcnt(5)
    v_mfma_f32_32x32x16_bf16 v[64:79], v[168:171], v[160:163], v[64:79]
    ds_read_b128 v[180:183], v5 offset:0
    ds_read_b64_tr_b16 v[188:189], v10 offset:6144
    s_waitcnt lgkmcnt(5)
    v_mfma_f32_32x32x16_bf16 v[96:111], v[172:175], v[160:163], v[96:111]
    ds_read_b64_tr_b16 v[190:191], v10 offset:6656
    ds_read_b64_tr_b16 v[192:193], v10 offset:14336
    s_waitcnt lgkmcnt(6)
    v_mfma_f32_32x32x16_bf16 v[80:95], v[168:171], v[164:167], v[80:95]
    ds_read_b64_tr_b16 v[194:195], v10 offset:14848
    ds_read_b128 v[184:187], v5 offset:4096
    v_mfma_f32_32x32x16_bf16 v[112:127], v[172:175], v[164:167], v[112:127]
    ds_read_b64_tr_b16 v[196:197], v10 offset:22528
    ds_read_b64_tr_b16 v[198:199], v10 offset:23040
    s_waitcnt lgkmcnt(8)
    v_mfma_f32_32x32x16_bf16 v[128:143], v[160:163], v[176:179], v[128:143]
    v_mfma_f32_32x32x16_bf16 v[144:159], v[164:167], v[176:179], v[144:159]
    s_waitcnt lgkmcnt(5)
    v_mfma_f32_32x32x16_bf16 v[64:79], v[188:191], v[180:183], v[64:79]
    s_waitcnt lgkmcnt(3)
    v_mfma_f32_32x32x16_bf16 v[96:111], v[192:195], v[180:183], v[96:111]
    s_waitcnt lgkmcnt(0)
    s_barrier
    v_mfma_f32_32x32x16_bf16 v[80:95], v[188:191], v[184:187], v[80:95]
    ds_read_b128 v[160:163], v2 offset:40960
    ds_read_b64_tr_b16 v[168:169], v10 offset:40960
    ds_read_b64_tr_b16 v[170:171], v10 offset:41472
    v_mfma_f32_32x32x16_bf16 v[112:127], v[192:195], v[184:187], v[112:127]
    ds_read_b64_tr_b16 v[172:173], v10 offset:49152
    ds_read_b64_tr_b16 v[174:175], v10 offset:49664
    ds_read_b128 v[164:167], v2 offset:45056
    v_mfma_f32_32x32x16_bf16 v[128:143], v[180:183], v[196:199], v[128:143]
    ds_read_b64_tr_b16 v[176:177], v10 offset:57344
    ds_read_b64_tr_b16 v[178:179], v10 offset:57856
    v_mfma_f32_32x32x16_bf16 v[144:159], v[184:187], v[196:199], v[144:159]
    s_waitcnt lgkmcnt(5)
    v_mfma_f32_32x32x16_bf16 v[64:79], v[168:171], v[160:163], v[64:79]
    ds_read_b128 v[180:183], v3 offset:40960
    ds_read_b64_tr_b16 v[188:189], v10 offset:43008
    s_waitcnt lgkmcnt(5)
    v_mfma_f32_32x32x16_bf16 v[96:111], v[172:175], v[160:163], v[96:111]
    ds_read_b64_tr_b16 v[190:191], v10 offset:43520
    ds_read_b64_tr_b16 v[192:193], v10 offset:51200
    s_waitcnt lgkmcnt(6)
    v_mfma_f32_32x32x16_bf16 v[80:95], v[168:171], v[164:167], v[80:95]
    ds_read_b64_tr_b16 v[194:195], v10 offset:51712
    ds_read_b128 v[184:187], v3 offset:45056
    v_mfma_f32_32x32x16_bf16 v[112:127], v[172:175], v[164:167], v[112:127]
    ds_read_b64_tr_b16 v[196:197], v10 offset:59392
    ds_read_b64_tr_b16 v[198:199], v10 offset:59904
    s_waitcnt lgkmcnt(8)
    v_mfma_f32_32x32x16_bf16 v[128:143], v[160:163], v[176:179], v[128:143]
    v_mfma_f32_32x32x16_bf16 v[144:159], v[164:167], v[176:179], v[144:159]
    s_waitcnt lgkmcnt(5)
    v_mfma_f32_32x32x16_bf16 v[64:79], v[188:191], v[180:183], v[64:79]
    ds_read_b128 v[160:163], v4 offset:40960
    ds_read_b64_tr_b16 v[168:169], v10 offset:45056
    s_waitcnt lgkmcnt(5)
    v_mfma_f32_32x32x16_bf16 v[96:111], v[192:195], v[180:183], v[96:111]
    ds_read_b64_tr_b16 v[170:171], v10 offset:45568
    ds_read_b64_tr_b16 v[172:173], v10 offset:53248
    s_waitcnt lgkmcnt(6)
    v_mfma_f32_32x32x16_bf16 v[80:95], v[188:191], v[184:187], v[80:95]
    ds_read_b64_tr_b16 v[174:175], v10 offset:53760
    ds_read_b128 v[164:167], v4 offset:45056
    v_mfma_f32_32x32x16_bf16 v[112:127], v[192:195], v[184:187], v[112:127]
    ds_read_b64_tr_b16 v[176:177], v10 offset:61440
    ds_read_b64_tr_b16 v[178:179], v10 offset:61952
    s_waitcnt lgkmcnt(8)
    v_mfma_f32_32x32x16_bf16 v[128:143], v[180:183], v[196:199], v[128:143]
    v_mfma_f32_32x32x16_bf16 v[144:159], v[184:187], v[196:199], v[144:159]
    s_waitcnt lgkmcnt(5)
    v_mfma_f32_32x32x16_bf16 v[64:79], v[168:171], v[160:163], v[64:79]
    ds_read_b128 v[180:183], v5 offset:40960
    ds_read_b64_tr_b16 v[188:189], v10 offset:47104
    s_waitcnt lgkmcnt(5)
    v_mfma_f32_32x32x16_bf16 v[96:111], v[172:175], v[160:163], v[96:111]
    ds_read_b64_tr_b16 v[190:191], v10 offset:47616
    ds_read_b64_tr_b16 v[192:193], v10 offset:55296
    s_waitcnt lgkmcnt(6)
    v_mfma_f32_32x32x16_bf16 v[80:95], v[168:171], v[164:167], v[80:95]
    ds_read_b64_tr_b16 v[194:195], v10 offset:55808
    ds_read_b128 v[184:187], v5 offset:45056
    v_mfma_f32_32x32x16_bf16 v[112:127], v[172:175], v[164:167], v[112:127]
    ds_read_b64_tr_b16 v[196:197], v10 offset:63488
    ds_read_b64_tr_b16 v[198:199], v10 offset:64000
    s_waitcnt lgkmcnt(8)
    v_mfma_f32_32x32x16_bf16 v[128:143], v[160:163], v[176:179], v[128:143]
    v_mfma_f32_32x32x16_bf16 v[144:159], v[164:167], v[176:179], v[144:159]
    s_waitcnt lgkmcnt(5)
    v_mfma_f32_32x32x16_bf16 v[64:79], v[188:191], v[180:183], v[64:79]
    s_waitcnt lgkmcnt(3)
    v_mfma_f32_32x32x16_bf16 v[96:111], v[192:195], v[180:183], v[96:111]
    s_waitcnt lgkmcnt(0)
    s_barrier
    v_mfma_f32_32x32x16_bf16 v[80:95], v[188:191], v[184:187], v[80:95]
    ds_read_b128 v[160:163], v6 offset:0
    ds_read_b64_tr_b16 v[168:169], v11 offset:0
    ds_read_b64_tr_b16 v[170:171], v11 offset:512
    v_mfma_f32_32x32x16_bf16 v[112:127], v[192:195], v[184:187], v[112:127]
    ds_read_b64_tr_b16 v[172:173], v11 offset:8192
    ds_read_b64_tr_b16 v[174:175], v11 offset:8704
    ds_read_b128 v[164:167], v6 offset:4096
    v_mfma_f32_32x32x16_bf16 v[128:143], v[180:183], v[196:199], v[128:143]
    ds_read_b64_tr_b16 v[176:177], v11 offset:16384
    ds_read_b64_tr_b16 v[178:179], v11 offset:16896
    v_mfma_f32_32x32x16_bf16 v[144:159], v[184:187], v[196:199], v[144:159]
    s_waitcnt lgkmcnt(5)
    v_mfma_f32_32x32x16_bf16 v[64:79], v[168:171], v[160:163], v[64:79]
    ds_read_b128 v[180:183], v7 offset:0
    ds_read_b64_tr_b16 v[188:189], v11 offset:2048
    s_waitcnt lgkmcnt(5)
    v_mfma_f32_32x32x16_bf16 v[96:111], v[172:175], v[160:163], v[96:111]
    ds_read_b64_tr_b16 v[190:191], v11 offset:2560
    ds_read_b64_tr_b16 v[192:193], v11 offset:10240
    s_waitcnt lgkmcnt(6)
    v_mfma_f32_32x32x16_bf16 v[80:95], v[168:171], v[164:167], v[80:95]
    ds_read_b64_tr_b16 v[194:195], v11 offset:10752
    ds_read_b128 v[184:187], v7 offset:4096
    v_mfma_f32_32x32x16_bf16 v[112:127], v[172:175], v[164:167], v[112:127]
    ds_read_b64_tr_b16 v[196:197], v11 offset:18432
    ds_read_b64_tr_b16 v[198:199], v11 offset:18944
    s_waitcnt lgkmcnt(8)
    v_mfma_f32_32x32x16_bf16 v[128:143], v[160:163], v[176:179], v[128:143]
    v_mfma_f32_32x32x16_bf16 v[144:159], v[164:167], v[176:179], v[144:159]
    s_waitcnt lgkmcnt(5)
    v_mfma_f32_32x32x16_bf16 v[64:79], v[188:191], v[180:183], v[64:79]
    ds_read_b128 v[160:163], v8 offset:0
    ds_read_b64_tr_b16 v[168:169], v11 offset:4096
    s_waitcnt lgkmcnt(5)
    v_mfma_f32_32x32x16_bf16 v[96:111], v[192:195], v[180:183], v[96:111]
    ds_read_b64_tr_b16 v[170:171], v11 offset:4608
    ds_read_b64_tr_b16 v[172:173], v11 offset:12288
    s_waitcnt lgkmcnt(6)
    v_mfma_f32_32x32x16_bf16 v[80:95], v[188:191], v[184:187], v[80:95]
    ds_read_b64_tr_b16 v[174:175], v11 offset:12800
    ds_read_b128 v[164:167], v8 offset:4096
    v_mfma_f32_32x32x16_bf16 v[112:127], v[192:195], v[184:187], v[112:127]
    ds_read_b64_tr_b16 v[176:177], v11 offset:20480
    ds_read_b64_tr_b16 v[178:179], v11 offset:20992
    s_waitcnt lgkmcnt(8)
    v_mfma_f32_32x32x16_bf16 v[128:143], v[180:183], v[196:199], v[128:143]
    v_mfma_f32_32x32x16_bf16 v[144:159], v[184:187], v[196:199], v[144:159]
    s_waitcnt lgkmcnt(5)
    v_mfma_f32_32x32x16_bf16 v[64:79], v[168:171], v[160:163], v[64:79]
    ds_read_b128 v[180:183], v9 offset:0
    ds_read_b64_tr_b16 v[188:189], v11 offset:6144
    s_waitcnt lgkmcnt(5)
    v_mfma_f32_32x32x16_bf16 v[96:111], v[172:175], v[160:163], v[96:111]
    ds_read_b64_tr_b16 v[190:191], v11 offset:6656
    ds_read_b64_tr_b16 v[192:193], v11 offset:14336
    s_waitcnt lgkmcnt(6)
    v_mfma_f32_32x32x16_bf16 v[80:95], v[168:171], v[164:167], v[80:95]
    ds_read_b64_tr_b16 v[194:195], v11 offset:14848
    ds_read_b128 v[184:187], v9 offset:4096
    v_mfma_f32_32x32x16_bf16 v[112:127], v[172:175], v[164:167], v[112:127]
    ds_read_b64_tr_b16 v[196:197], v11 offset:22528
    ds_read_b64_tr_b16 v[198:199], v11 offset:23040
    s_waitcnt lgkmcnt(8)
    v_mfma_f32_32x32x16_bf16 v[128:143], v[160:163], v[176:179], v[128:143]
    v_mfma_f32_32x32x16_bf16 v[144:159], v[164:167], v[176:179], v[144:159]
    s_waitcnt lgkmcnt(5)
    v_mfma_f32_32x32x16_bf16 v[64:79], v[188:191], v[180:183], v[64:79]
    s_waitcnt lgkmcnt(3)
    v_mfma_f32_32x32x16_bf16 v[96:111], v[192:195], v[180:183], v[96:111]
    s_waitcnt lgkmcnt(0)
    s_barrier
    v_mfma_f32_32x32x16_bf16 v[80:95], v[188:191], v[184:187], v[80:95]
    ds_read_b128 v[160:163], v2 offset:0
    ds_read_b64_tr_b16 v[168:169], v10 offset:0
    ds_read_b64_tr_b16 v[170:171], v10 offset:512
    v_mfma_f32_32x32x16_bf16 v[112:127], v[192:195], v[184:187], v[112:127]
    ds_read_b64_tr_b16 v[172:173], v10 offset:8192
    ds_read_b64_tr_b16 v[174:175], v10 offset:8704
    ds_read_b128 v[164:167], v2 offset:4096
    v_mfma_f32_32x32x16_bf16 v[128:143], v[180:183], v[196:199], v[128:143]
    ds_read_b64_tr_b16 v[176:177], v10 offset:16384
    ds_read_b64_tr_b16 v[178:179], v10 offset:16896
    v_mfma_f32_32x32x16_bf16 v[144:159], v[184:187], v[196:199], v[144:159]
    s_waitcnt lgkmcnt(5)
    v_mfma_f32_32x32x16_bf16 v[64:79], v[168:171], v[160:163], v[64:79]
    ds_read_b128 v[180:183], v3 offset:0
    ds_read_b64_tr_b16 v[188:189], v10 offset:2048
    s_waitcnt lgkmcnt(5)
    v_mfma_f32_32x32x16_bf16 v[96:111], v[172:175], v[160:163], v[96:111]
    ds_read_b64_tr_b16 v[190:191], v10 offset:2560
    ds_read_b64_tr_b16 v[192:193], v10 offset:10240
    s_waitcnt lgkmcnt(6)
    v_mfma_f32_32x32x16_bf16 v[80:95], v[168:171], v[164:167], v[80:95]
    ds_read_b64_tr_b16 v[194:195], v10 offset:10752
    ds_read_b128 v[184:187], v3 offset:4096
    v_mfma_f32_32x32x16_bf16 v[112:127], v[172:175], v[164:167], v[112:127]
    ds_read_b64_tr_b16 v[196:197], v10 offset:18432
    ds_read_b64_tr_b16 v[198:199], v10 offset:18944
    s_waitcnt lgkmcnt(8)
    v_mfma_f32_32x32x16_bf16 v[128:143], v[160:163], v[176:179], v[128:143]
    v_mfma_f32_32x32x16_bf16 v[144:159], v[164:167], v[176:179], v[144:159]
    s_waitcnt lgkmcnt(5)
    v_mfma_f32_32x32x16_bf16 v[64:79], v[188:191], v[180:183], v[64:79]
    ds_read_b128 v[160:163], v4 offset:0
    ds_read_b64_tr_b16 v[168:169], v10 offset:4096
    s_waitcnt lgkmcnt(5)
    v_mfma_f32_32x32x16_bf16 v[96:111], v[192:195], v[180:183], v[96:111]
    ds_read_b64_tr_b16 v[170:171], v10 offset:4608
    ds_read_b64_tr_b16 v[172:173], v10 offset:12288
    s_waitcnt lgkmcnt(6)
    v_mfma_f32_32x32x16_bf16 v[80:95], v[188:191], v[184:187], v[80:95]
    ds_read_b64_tr_b16 v[174:175], v10 offset:12800
    ds_read_b128 v[164:167], v4 offset:4096
    v_mfma_f32_32x32x16_bf16 v[112:127], v[192:195], v[184:187], v[112:127]
    ds_read_b64_tr_b16 v[176:177], v10 offset:20480
    ds_read_b64_tr_b16 v[178:179], v10 offset:20992
    s_waitcnt lgkmcnt(8)
    v_mfma_f32_32x32x16_bf16 v[128:143], v[180:183], v[196:199], v[128:143]
    v_mfma_f32_32x32x16_bf16 v[144:159], v[184:187], v[196:199], v[144:159]
    s_waitcnt lgkmcnt(5)
    v_mfma_f32_32x32x16_bf16 v[64:79], v[168:171], v[160:163], v[64:79]
    ds_read_b128 v[180:183], v5 offset:0
    ds_read_b64_tr_b16 v[188:189], v10 offset:6144
    s_waitcnt lgkmcnt(5)
    v_mfma_f32_32x32x16_bf16 v[96:111], v[172:175], v[160:163], v[96:111]
    ds_read_b64_tr_b16 v[190:191], v10 offset:6656
    ds_read_b64_tr_b16 v[192:193], v10 offset:14336
    s_waitcnt lgkmcnt(6)
    v_mfma_f32_32x32x16_bf16 v[80:95], v[168:171], v[164:167], v[80:95]
    ds_read_b64_tr_b16 v[194:195], v10 offset:14848
    ds_read_b128 v[184:187], v5 offset:4096
    v_mfma_f32_32x32x16_bf16 v[112:127], v[172:175], v[164:167], v[112:127]
    ds_read_b64_tr_b16 v[196:197], v10 offset:22528
    ds_read_b64_tr_b16 v[198:199], v10 offset:23040
    s_waitcnt lgkmcnt(8)
    v_mfma_f32_32x32x16_bf16 v[128:143], v[160:163], v[176:179], v[128:143]
    v_mfma_f32_32x32x16_bf16 v[144:159], v[164:167], v[176:179], v[144:159]
    s_waitcnt lgkmcnt(5)
    v_mfma_f32_32x32x16_bf16 v[64:79], v[188:191], v[180:183], v[64:79]
    s_waitcnt lgkmcnt(3)
    v_mfma_f32_32x32x16_bf16 v[96:111], v[192:195], v[180:183], v[96:111]
    s_waitcnt lgkmcnt(0)
    s_barrier
    v_mfma_f32_32x32x16_bf16 v[80:95], v[188:191], v[184:187], v[80:95]
    ds_read_b128 v[160:163], v2 offset:40960
    ds_read_b64_tr_b16 v[168:169], v10 offset:40960
    ds_read_b64_tr_b16 v[170:171], v10 offset:41472
    v_mfma_f32_32x32x16_bf16 v[112:127], v[192:195], v[184:187], v[112:127]
    ds_read_b64_tr_b16 v[172:173], v10 offset:49152
    ds_read_b64_tr_b16 v[174:175], v10 offset:49664
    ds_read_b128 v[164:167], v2 offset:45056
    v_mfma_f32_32x32x16_bf16 v[128:143], v[180:183], v[196:199], v[128:143]
    ds_read_b64_tr_b16 v[176:177], v10 offset:57344
    ds_read_b64_tr_b16 v[178:179], v10 offset:57856
    v_mfma_f32_32x32x16_bf16 v[144:159], v[184:187], v[196:199], v[144:159]
    s_waitcnt lgkmcnt(5)
    v_mfma_f32_32x32x16_bf16 v[64:79], v[168:171], v[160:163], v[64:79]
    ds_read_b128 v[180:183], v3 offset:40960
    ds_read_b64_tr_b16 v[188:189], v10 offset:43008
    s_waitcnt lgkmcnt(5)
    v_mfma_f32_32x32x16_bf16 v[96:111], v[172:175], v[160:163], v[96:111]
    ds_read_b64_tr_b16 v[190:191], v10 offset:43520
    ds_read_b64_tr_b16 v[192:193], v10 offset:51200
    s_waitcnt lgkmcnt(6)
    v_mfma_f32_32x32x16_bf16 v[80:95], v[168:171], v[164:167], v[80:95]
    ds_read_b64_tr_b16 v[194:195], v10 offset:51712
    ds_read_b128 v[184:187], v3 offset:45056
    v_mfma_f32_32x32x16_bf16 v[112:127], v[172:175], v[164:167], v[112:127]
    ds_read_b64_tr_b16 v[196:197], v10 offset:59392
    ds_read_b64_tr_b16 v[198:199], v10 offset:59904
    s_waitcnt lgkmcnt(8)
    v_mfma_f32_32x32x16_bf16 v[128:143], v[160:163], v[176:179], v[128:143]
    v_mfma_f32_32x32x16_bf16 v[144:159], v[164:167], v[176:179], v[144:159]
    s_waitcnt lgkmcnt(5)
    v_mfma_f32_32x32x16_bf16 v[64:79], v[188:191], v[180:183], v[64:79]
    ds_read_b128 v[160:163], v4 offset:40960
    ds_read_b64_tr_b16 v[168:169], v10 offset:45056
    s_waitcnt lgkmcnt(5)
    v_mfma_f32_32x32x16_bf16 v[96:111], v[192:195], v[180:183], v[96:111]
    ds_read_b64_tr_b16 v[170:171], v10 offset:45568
    ds_read_b64_tr_b16 v[172:173], v10 offset:53248
    s_waitcnt lgkmcnt(6)
    v_mfma_f32_32x32x16_bf16 v[80:95], v[188:191], v[184:187], v[80:95]
    ds_read_b64_tr_b16 v[174:175], v10 offset:53760
    ds_read_b128 v[164:167], v4 offset:45056
    v_mfma_f32_32x32x16_bf16 v[112:127], v[192:195], v[184:187], v[112:127]
    ds_read_b64_tr_b16 v[176:177], v10 offset:61440
    ds_read_b64_tr_b16 v[178:179], v10 offset:61952
    s_waitcnt lgkmcnt(8)
    v_mfma_f32_32x32x16_bf16 v[128:143], v[180:183], v[196:199], v[128:143]
    v_mfma_f32_32x32x16_bf16 v[144:159], v[184:187], v[196:199], v[144:159]
    s_waitcnt lgkmcnt(5)
    v_mfma_f32_32x32x16_bf16 v[64:79], v[168:171], v[160:163], v[64:79]
    ds_read_b128 v[180:183], v5 offset:40960
    ds_read_b64_tr_b16 v[188:189], v10 offset:47104
    s_waitcnt lgkmcnt(5)
    v_mfma_f32_32x32x16_bf16 v[96:111], v[172:175], v[160:163], v[96:111]
    ds_read_b64_tr_b16 v[190:191], v10 offset:47616
    ds_read_b64_tr_b16 v[192:193], v10 offset:55296
    s_waitcnt lgkmcnt(6)
    v_mfma_f32_32x32x16_bf16 v[80:95], v[168:171], v[164:167], v[80:95]
    ds_read_b64_tr_b16 v[194:195], v10 offset:55808
    ds_read_b128 v[184:187], v5 offset:45056
    v_mfma_f32_32x32x16_bf16 v[112:127], v[172:175], v[164:167], v[112:127]
    ds_read_b64_tr_b16 v[196:197], v10 offset:63488
    ds_read_b64_tr_b16 v[198:199], v10 offset:64000
    s_waitcnt lgkmcnt(8)
    v_mfma_f32_32x32x16_bf16 v[128:143], v[160:163], v[176:179], v[128:143]
    v_mfma_f32_32x32x16_bf16 v[144:159], v[164:167], v[176:179], v[144:159]
    s_waitcnt lgkmcnt(5)
    v_mfma_f32_32x32x16_bf16 v[64:79], v[188:191], v[180:183], v[64:79]
    s_waitcnt lgkmcnt(3)
    v_mfma_f32_32x32x16_bf16 v[96:111], v[192:195], v[180:183], v[96:111]
    s_waitcnt lgkmcnt(0)
    s_barrier
    v_mfma_f32_32x32x16_bf16 v[80:95], v[188:191], v[184:187], v[80:95]
    ds_read_b128 v[160:163], v6 offset:0
    ds_read_b64_tr_b16 v[168:169], v11 offset:0
    ds_read_b64_tr_b16 v[170:171], v11 offset:512
    v_mfma_f32_32x32x16_bf16 v[112:127], v[192:195], v[184:187], v[112:127]
    ds_read_b64_tr_b16 v[172:173], v11 offset:8192
    ds_read_b64_tr_b16 v[174:175], v11 offset:8704
    ds_read_b128 v[164:167], v6 offset:4096
    v_mfma_f32_32x32x16_bf16 v[128:143], v[180:183], v[196:199], v[128:143]
    ds_read_b64_tr_b16 v[176:177], v11 offset:16384
    ds_read_b64_tr_b16 v[178:179], v11 offset:16896
    v_mfma_f32_32x32x16_bf16 v[144:159], v[184:187], v[196:199], v[144:159]
    s_waitcnt lgkmcnt(5)
    v_mfma_f32_32x32x16_bf16 v[64:79], v[168:171], v[160:163], v[64:79]
    ds_read_b128 v[180:183], v7 offset:0
    ds_read_b64_tr_b16 v[188:189], v11 offset:2048
    s_waitcnt lgkmcnt(5)
    v_mfma_f32_32x32x16_bf16 v[96:111], v[172:175], v[160:163], v[96:111]
    ds_read_b64_tr_b16 v[190:191], v11 offset:2560
    ds_read_b64_tr_b16 v[192:193], v11 offset:10240
    s_waitcnt lgkmcnt(6)
    v_mfma_f32_32x32x16_bf16 v[80:95], v[168:171], v[164:167], v[80:95]
    ds_read_b64_tr_b16 v[194:195], v11 offset:10752
    ds_read_b128 v[184:187], v7 offset:4096
    v_mfma_f32_32x32x16_bf16 v[112:127], v[172:175], v[164:167], v[112:127]
    ds_read_b64_tr_b16 v[196:197], v11 offset:18432
    ds_read_b64_tr_b16 v[198:199], v11 offset:18944
    s_waitcnt lgkmcnt(8)
    v_mfma_f32_32x32x16_bf16 v[128:143], v[160:163], v[176:179], v[128:143]
    v_mfma_f32_32x32x16_bf16 v[144:159], v[164:167], v[176:179], v[144:159]
    s_waitcnt lgkmcnt(5)
    v_mfma_f32_32x32x16_bf16 v[64:79], v[188:191], v[180:183], v[64:79]
    ds_read_b128 v[160:163], v8 offset:0
    ds_read_b64_tr_b16 v[168:169], v11 offset:4096
    s_waitcnt lgkmcnt(5)
    v_mfma_f32_32x32x16_bf16 v[96:111], v[192:195], v[180:183], v[96:111]
    ds_read_b64_tr_b16 v[170:171], v11 offset:4608
    ds_read_b64_tr_b16 v[172:173], v11 offset:12288
    s_waitcnt lgkmcnt(6)
    v_mfma_f32_32x32x16_bf16 v[80:95], v[188:191], v[184:187], v[80:95]
    ds_read_b64_tr_b16 v[174:175], v11 offset:12800
    ds_read_b128 v[164:167], v8 offset:4096
    v_mfma_f32_32x32x16_bf16 v[112:127], v[192:195], v[184:187], v[112:127]
    ds_read_b64_tr_b16 v[176:177], v11 offset:20480
    ds_read_b64_tr_b16 v[178:179], v11 offset:20992
    s_waitcnt lgkmcnt(8)
    v_mfma_f32_32x32x16_bf16 v[128:143], v[180:183], v[196:199], v[128:143]
    v_mfma_f32_32x32x16_bf16 v[144:159], v[184:187], v[196:199], v[144:159]
    s_waitcnt lgkmcnt(5)
    v_mfma_f32_32x32x16_bf16 v[64:79], v[168:171], v[160:163], v[64:79]
    ds_read_b128 v[180:183], v9 offset:0
    ds_read_b64_tr_b16 v[188:189], v11 offset:6144
    s_waitcnt lgkmcnt(5)
    v_mfma_f32_32x32x16_bf16 v[96:111], v[172:175], v[160:163], v[96:111]
    ds_read_b64_tr_b16 v[190:191], v11 offset:6656
    ds_read_b64_tr_b16 v[192:193], v11 offset:14336
    s_waitcnt lgkmcnt(6)
    v_mfma_f32_32x32x16_bf16 v[80:95], v[168:171], v[164:167], v[80:95]
    ds_read_b64_tr_b16 v[194:195], v11 offset:14848
    ds_read_b128 v[184:187], v9 offset:4096
    v_mfma_f32_32x32x16_bf16 v[112:127], v[172:175], v[164:167], v[112:127]
    ds_read_b64_tr_b16 v[196:197], v11 offset:22528
    ds_read_b64_tr_b16 v[198:199], v11 offset:23040
    s_waitcnt lgkmcnt(8)
    v_mfma_f32_32x32x16_bf16 v[128:143], v[160:163], v[176:179], v[128:143]
    v_mfma_f32_32x32x16_bf16 v[144:159], v[164:167], v[176:179], v[144:159]
    s_waitcnt lgkmcnt(5)
    v_mfma_f32_32x32x16_bf16 v[64:79], v[188:191], v[180:183], v[64:79]
    s_waitcnt lgkmcnt(3)
    v_mfma_f32_32x32x16_bf16 v[96:111], v[192:195], v[180:183], v[96:111]
    s_waitcnt lgkmcnt(0)
    s_barrier
    v_mfma_f32_32x32x16_bf16 v[80:95], v[188:191], v[184:187], v[80:95]
    ds_read_b128 v[160:163], v2 offset:0
    ds_read_b64_tr_b16 v[168:169], v10 offset:0
    ds_read_b64_tr_b16 v[170:171], v10 offset:512
    v_mfma_f32_32x32x16_bf16 v[112:127], v[192:195], v[184:187], v[112:127]
    ds_read_b64_tr_b16 v[172:173], v10 offset:8192
    ds_read_b64_tr_b16 v[174:175], v10 offset:8704
    ds_read_b128 v[164:167], v2 offset:4096
    v_mfma_f32_32x32x16_bf16 v[128:143], v[180:183], v[196:199], v[128:143]
    ds_read_b64_tr_b16 v[176:177], v10 offset:16384
    ds_read_b64_tr_b16 v[178:179], v10 offset:16896
    v_mfma_f32_32x32x16_bf16 v[144:159], v[184:187], v[196:199], v[144:159]
    s_waitcnt lgkmcnt(5)
    v_mfma_f32_32x32x16_bf16 v[64:79], v[168:171], v[160:163], v[64:79]
    ds_read_b128 v[180:183], v3 offset:0
    ds_read_b64_tr_b16 v[188:189], v10 offset:2048
    s_waitcnt lgkmcnt(5)
    v_mfma_f32_32x32x16_bf16 v[96:111], v[172:175], v[160:163], v[96:111]
    ds_read_b64_tr_b16 v[190:191], v10 offset:2560
    ds_read_b64_tr_b16 v[192:193], v10 offset:10240
    s_waitcnt lgkmcnt(6)
    v_mfma_f32_32x32x16_bf16 v[80:95], v[168:171], v[164:167], v[80:95]
    ds_read_b64_tr_b16 v[194:195], v10 offset:10752
    ds_read_b128 v[184:187], v3 offset:4096
    v_mfma_f32_32x32x16_bf16 v[112:127], v[172:175], v[164:167], v[112:127]
    ds_read_b64_tr_b16 v[196:197], v10 offset:18432
    ds_read_b64_tr_b16 v[198:199], v10 offset:18944
    s_waitcnt lgkmcnt(8)
    v_mfma_f32_32x32x16_bf16 v[128:143], v[160:163], v[176:179], v[128:143]
    v_mfma_f32_32x32x16_bf16 v[144:159], v[164:167], v[176:179], v[144:159]
    s_waitcnt lgkmcnt(5)
    v_mfma_f32_32x32x16_bf16 v[64:79], v[188:191], v[180:183], v[64:79]
    ds_read_b128 v[160:163], v4 offset:0
    ds_read_b64_tr_b16 v[168:169], v10 offset:4096
    s_waitcnt lgkmcnt(5)
    v_mfma_f32_32x32x16_bf16 v[96:111], v[192:195], v[180:183], v[96:111]
    ds_read_b64_tr_b16 v[170:171], v10 offset:4608
    ds_read_b64_tr_b16 v[172:173], v10 offset:12288
    s_waitcnt lgkmcnt(6)
    v_mfma_f32_32x32x16_bf16 v[80:95], v[188:191], v[184:187], v[80:95]
    ds_read_b64_tr_b16 v[174:175], v10 offset:12800
    ds_read_b128 v[164:167], v4 offset:4096
    v_mfma_f32_32x32x16_bf16 v[112:127], v[192:195], v[184:187], v[112:127]
    ds_read_b64_tr_b16 v[176:177], v10 offset:20480
    ds_read_b64_tr_b16 v[178:179], v10 offset:20992
    s_waitcnt lgkmcnt(8)
    v_mfma_f32_32x32x16_bf16 v[128:143], v[180:183], v[196:199], v[128:143]
    v_mfma_f32_32x32x16_bf16 v[144:159], v[184:187], v[196:199], v[144:159]
    s_waitcnt lgkmcnt(5)
    v_mfma_f32_32x32x16_bf16 v[64:79], v[168:171], v[160:163], v[64:79]
    ds_read_b128 v[180:183], v5 offset:0
    ds_read_b64_tr_b16 v[188:189], v10 offset:6144
    s_waitcnt lgkmcnt(5)
    v_mfma_f32_32x32x16_bf16 v[96:111], v[172:175], v[160:163], v[96:111]
    ds_read_b64_tr_b16 v[190:191], v10 offset:6656
    ds_read_b64_tr_b16 v[192:193], v10 offset:14336
    s_waitcnt lgkmcnt(6)
    v_mfma_f32_32x32x16_bf16 v[80:95], v[168:171], v[164:167], v[80:95]
    ds_read_b64_tr_b16 v[194:195], v10 offset:14848
    ds_read_b128 v[184:187], v5 offset:4096
    v_mfma_f32_32x32x16_bf16 v[112:127], v[172:175], v[164:167], v[112:127]
    ds_read_b64_tr_b16 v[196:197], v10 offset:22528
    ds_read_b64_tr_b16 v[198:199], v10 offset:23040
    s_waitcnt lgkmcnt(8)
    v_mfma_f32_32x32x16_bf16 v[128:143], v[160:163], v[176:179], v[128:143]
    v_mfma_f32_32x32x16_bf16 v[144:159], v[164:167], v[176:179], v[144:159]
    s_waitcnt lgkmcnt(5)
    v_mfma_f32_32x32x16_bf16 v[64:79], v[188:191], v[180:183], v[64:79]
    s_waitcnt lgkmcnt(3)
    v_mfma_f32_32x32x16_bf16 v[96:111], v[192:195], v[180:183], v[96:111]
    s_waitcnt lgkmcnt(0)
    s_barrier
    v_mfma_f32_32x32x16_bf16 v[80:95], v[188:191], v[184:187], v[80:95]
    ds_read_b128 v[160:163], v2 offset:40960
    ds_read_b64_tr_b16 v[168:169], v10 offset:40960
    ds_read_b64_tr_b16 v[170:171], v10 offset:41472
    v_mfma_f32_32x32x16_bf16 v[112:127], v[192:195], v[184:187], v[112:127]
    ds_read_b64_tr_b16 v[172:173], v10 offset:49152
    ds_read_b64_tr_b16 v[174:175], v10 offset:49664
    ds_read_b128 v[164:167], v2 offset:45056
    v_mfma_f32_32x32x16_bf16 v[128:143], v[180:183], v[196:199], v[128:143]
    ds_read_b64_tr_b16 v[176:177], v10 offset:57344
    ds_read_b64_tr_b16 v[178:179], v10 offset:57856
    v_mfma_f32_32x32x16_bf16 v[144:159], v[184:187], v[196:199], v[144:159]
    s_waitcnt lgkmcnt(5)
    v_mfma_f32_32x32x16_bf16 v[64:79], v[168:171], v[160:163], v[64:79]
    ds_read_b128 v[180:183], v3 offset:40960
    ds_read_b64_tr_b16 v[188:189], v10 offset:43008
    s_waitcnt lgkmcnt(5)
    v_mfma_f32_32x32x16_bf16 v[96:111], v[172:175], v[160:163], v[96:111]
    ds_read_b64_tr_b16 v[190:191], v10 offset:43520
    ds_read_b64_tr_b16 v[192:193], v10 offset:51200
    s_waitcnt lgkmcnt(6)
    v_mfma_f32_32x32x16_bf16 v[80:95], v[168:171], v[164:167], v[80:95]
    ds_read_b64_tr_b16 v[194:195], v10 offset:51712
    ds_read_b128 v[184:187], v3 offset:45056
    v_mfma_f32_32x32x16_bf16 v[112:127], v[172:175], v[164:167], v[112:127]
    ds_read_b64_tr_b16 v[196:197], v10 offset:59392
    ds_read_b64_tr_b16 v[198:199], v10 offset:59904
    s_waitcnt lgkmcnt(8)
    v_mfma_f32_32x32x16_bf16 v[128:143], v[160:163], v[176:179], v[128:143]
    v_mfma_f32_32x32x16_bf16 v[144:159], v[164:167], v[176:179], v[144:159]
    s_waitcnt lgkmcnt(5)
    v_mfma_f32_32x32x16_bf16 v[64:79], v[188:191], v[180:183], v[64:79]
    ds_read_b128 v[160:163], v4 offset:40960
    ds_read_b64_tr_b16 v[168:169], v10 offset:45056
    s_waitcnt lgkmcnt(5)
    v_mfma_f32_32x32x16_bf16 v[96:111], v[192:195], v[180:183], v[96:111]
    ds_read_b64_tr_b16 v[170:171], v10 offset:45568
    ds_read_b64_tr_b16 v[172:173], v10 offset:53248
    s_waitcnt lgkmcnt(6)
    v_mfma_f32_32x32x16_bf16 v[80:95], v[188:191], v[184:187], v[80:95]
    ds_read_b64_tr_b16 v[174:175], v10 offset:53760
    ds_read_b128 v[164:167], v4 offset:45056
    v_mfma_f32_32x32x16_bf16 v[112:127], v[192:195], v[184:187], v[112:127]
    ds_read_b64_tr_b16 v[176:177], v10 offset:61440
    ds_read_b64_tr_b16 v[178:179], v10 offset:61952
    s_waitcnt lgkmcnt(8)
    v_mfma_f32_32x32x16_bf16 v[128:143], v[180:183], v[196:199], v[128:143]
    v_mfma_f32_32x32x16_bf16 v[144:159], v[184:187], v[196:199], v[144:159]
    s_waitcnt lgkmcnt(5)
    v_mfma_f32_32x32x16_bf16 v[64:79], v[168:171], v[160:163], v[64:79]
    ds_read_b128 v[180:183], v5 offset:40960
    ds_read_b64_tr_b16 v[188:189], v10 offset:47104
    s_waitcnt lgkmcnt(5)
    v_mfma_f32_32x32x16_bf16 v[96:111], v[172:175], v[160:163], v[96:111]
    ds_read_b64_tr_b16 v[190:191], v10 offset:47616
    ds_read_b64_tr_b16 v[192:193], v10 offset:55296
    s_waitcnt lgkmcnt(6)
    v_mfma_f32_32x32x16_bf16 v[80:95], v[168:171], v[164:167], v[80:95]
    ds_read_b64_tr_b16 v[194:195], v10 offset:55808
    ds_read_b128 v[184:187], v5 offset:45056
    v_mfma_f32_32x32x16_bf16 v[112:127], v[172:175], v[164:167], v[112:127]
    ds_read_b64_tr_b16 v[196:197], v10 offset:63488
    ds_read_b64_tr_b16 v[198:199], v10 offset:64000
    s_waitcnt lgkmcnt(8)
    v_mfma_f32_32x32x16_bf16 v[128:143], v[160:163], v[176:179], v[128:143]
    v_mfma_f32_32x32x16_bf16 v[144:159], v[164:167], v[176:179], v[144:159]
    s_waitcnt lgkmcnt(5)
    v_mfma_f32_32x32x16_bf16 v[64:79], v[188:191], v[180:183], v[64:79]
    s_waitcnt lgkmcnt(3)
    v_mfma_f32_32x32x16_bf16 v[96:111], v[192:195], v[180:183], v[96:111]
    s_waitcnt lgkmcnt(0)
    s_barrier
    v_mfma_f32_32x32x16_bf16 v[80:95], v[188:191], v[184:187], v[80:95]
    ds_read_b128 v[160:163], v6 offset:0
    ds_read_b64_tr_b16 v[168:169], v11 offset:0
    ds_read_b64_tr_b16 v[170:171], v11 offset:512
    v_mfma_f32_32x32x16_bf16 v[112:127], v[192:195], v[184:187], v[112:127]
    ds_read_b64_tr_b16 v[172:173], v11 offset:8192
    ds_read_b64_tr_b16 v[174:175], v11 offset:8704
    ds_read_b128 v[164:167], v6 offset:4096
    v_mfma_f32_32x32x16_bf16 v[128:143], v[180:183], v[196:199], v[128:143]
    ds_read_b64_tr_b16 v[176:177], v11 offset:16384
    ds_read_b64_tr_b16 v[178:179], v11 offset:16896
    v_mfma_f32_32x32x16_bf16 v[144:159], v[184:187], v[196:199], v[144:159]
    s_waitcnt lgkmcnt(5)
    v_mfma_f32_32x32x16_bf16 v[64:79], v[168:171], v[160:163], v[64:79]
    ds_read_b128 v[180:183], v7 offset:0
    ds_read_b64_tr_b16 v[188:189], v11 offset:2048
    s_waitcnt lgkmcnt(5)
    v_mfma_f32_32x32x16_bf16 v[96:111], v[172:175], v[160:163], v[96:111]
    ds_read_b64_tr_b16 v[190:191], v11 offset:2560
    ds_read_b64_tr_b16 v[192:193], v11 offset:10240
    s_waitcnt lgkmcnt(6)
    v_mfma_f32_32x32x16_bf16 v[80:95], v[168:171], v[164:167], v[80:95]
    ds_read_b64_tr_b16 v[194:195], v11 offset:10752
    ds_read_b128 v[184:187], v7 offset:4096
    v_mfma_f32_32x32x16_bf16 v[112:127], v[172:175], v[164:167], v[112:127]
    ds_read_b64_tr_b16 v[196:197], v11 offset:18432
    ds_read_b64_tr_b16 v[198:199], v11 offset:18944
    s_waitcnt lgkmcnt(8)
    v_mfma_f32_32x32x16_bf16 v[128:143], v[160:163], v[176:179], v[128:143]
    v_mfma_f32_32x32x16_bf16 v[144:159], v[164:167], v[176:179], v[144:159]
    s_waitcnt lgkmcnt(5)
    v_mfma_f32_32x32x16_bf16 v[64:79], v[188:191], v[180:183], v[64:79]
    ds_read_b128 v[160:163], v8 offset:0
    ds_read_b64_tr_b16 v[168:169], v11 offset:4096
    s_waitcnt lgkmcnt(5)
    v_mfma_f32_32x32x16_bf16 v[96:111], v[192:195], v[180:183], v[96:111]
    ds_read_b64_tr_b16 v[170:171], v11 offset:4608
    ds_read_b64_tr_b16 v[172:173], v11 offset:12288
    s_waitcnt lgkmcnt(6)
    v_mfma_f32_32x32x16_bf16 v[80:95], v[188:191], v[184:187], v[80:95]
    ds_read_b64_tr_b16 v[174:175], v11 offset:12800
    ds_read_b128 v[164:167], v8 offset:4096
    v_mfma_f32_32x32x16_bf16 v[112:127], v[192:195], v[184:187], v[112:127]
    ds_read_b64_tr_b16 v[176:177], v11 offset:20480
    ds_read_b64_tr_b16 v[178:179], v11 offset:20992
    s_waitcnt lgkmcnt(8)
    v_mfma_f32_32x32x16_bf16 v[128:143], v[180:183], v[196:199], v[128:143]
    v_mfma_f32_32x32x16_bf16 v[144:159], v[184:187], v[196:199], v[144:159]
    s_waitcnt lgkmcnt(5)
    v_mfma_f32_32x32x16_bf16 v[64:79], v[168:171], v[160:163], v[64:79]
    ds_read_b128 v[180:183], v9 offset:0
    ds_read_b64_tr_b16 v[188:189], v11 offset:6144
    s_waitcnt lgkmcnt(5)
    v_mfma_f32_32x32x16_bf16 v[96:111], v[172:175], v[160:163], v[96:111]
    ds_read_b64_tr_b16 v[190:191], v11 offset:6656
    ds_read_b64_tr_b16 v[192:193], v11 offset:14336
    s_waitcnt lgkmcnt(6)
    v_mfma_f32_32x32x16_bf16 v[80:95], v[168:171], v[164:167], v[80:95]
    ds_read_b64_tr_b16 v[194:195], v11 offset:14848
    ds_read_b128 v[184:187], v9 offset:4096
    v_mfma_f32_32x32x16_bf16 v[112:127], v[172:175], v[164:167], v[112:127]
    ds_read_b64_tr_b16 v[196:197], v11 offset:22528
    ds_read_b64_tr_b16 v[198:199], v11 offset:23040
    s_waitcnt lgkmcnt(8)
    v_mfma_f32_32x32x16_bf16 v[128:143], v[160:163], v[176:179], v[128:143]
    v_mfma_f32_32x32x16_bf16 v[144:159], v[164:167], v[176:179], v[144:159]
    s_waitcnt lgkmcnt(5)
    v_mfma_f32_32x32x16_bf16 v[64:79], v[188:191], v[180:183], v[64:79]
    s_waitcnt lgkmcnt(3)
    v_mfma_f32_32x32x16_bf16 v[96:111], v[192:195], v[180:183], v[96:111]
    s_waitcnt lgkmcnt(0)
    s_barrier
    v_mfma_f32_32x32x16_bf16 v[80:95], v[188:191], v[184:187], v[80:95]
    ds_read_b128 v[160:163], v2 offset:0
    ds_read_b64_tr_b16 v[168:169], v10 offset:0
    ds_read_b64_tr_b16 v[170:171], v10 offset:512
    v_mfma_f32_32x32x16_bf16 v[112:127], v[192:195], v[184:187], v[112:127]
    ds_read_b64_tr_b16 v[172:173], v10 offset:8192
    ds_read_b64_tr_b16 v[174:175], v10 offset:8704
    ds_read_b128 v[164:167], v2 offset:4096
    v_mfma_f32_32x32x16_bf16 v[128:143], v[180:183], v[196:199], v[128:143]
    ds_read_b64_tr_b16 v[176:177], v10 offset:16384
    ds_read_b64_tr_b16 v[178:179], v10 offset:16896
    v_mfma_f32_32x32x16_bf16 v[144:159], v[184:187], v[196:199], v[144:159]
    s_waitcnt lgkmcnt(5)
    v_mfma_f32_32x32x16_bf16 v[64:79], v[168:171], v[160:163], v[64:79]
    ds_read_b128 v[180:183], v3 offset:0
    ds_read_b64_tr_b16 v[188:189], v10 offset:2048
    s_waitcnt lgkmcnt(5)
    v_mfma_f32_32x32x16_bf16 v[96:111], v[172:175], v[160:163], v[96:111]
    ds_read_b64_tr_b16 v[190:191], v10 offset:2560
    ds_read_b64_tr_b16 v[192:193], v10 offset:10240
    s_waitcnt lgkmcnt(6)
    v_mfma_f32_32x32x16_bf16 v[80:95], v[168:171], v[164:167], v[80:95]
    ds_read_b64_tr_b16 v[194:195], v10 offset:10752
    ds_read_b128 v[184:187], v3 offset:4096
    v_mfma_f32_32x32x16_bf16 v[112:127], v[172:175], v[164:167], v[112:127]
    ds_read_b64_tr_b16 v[196:197], v10 offset:18432
    ds_read_b64_tr_b16 v[198:199], v10 offset:18944
    s_waitcnt lgkmcnt(8)
    v_mfma_f32_32x32x16_bf16 v[128:143], v[160:163], v[176:179], v[128:143]
    v_mfma_f32_32x32x16_bf16 v[144:159], v[164:167], v[176:179], v[144:159]
    s_waitcnt lgkmcnt(5)
    v_mfma_f32_32x32x16_bf16 v[64:79], v[188:191], v[180:183], v[64:79]
    ds_read_b128 v[160:163], v4 offset:0
    ds_read_b64_tr_b16 v[168:169], v10 offset:4096
    s_waitcnt lgkmcnt(5)
    v_mfma_f32_32x32x16_bf16 v[96:111], v[192:195], v[180:183], v[96:111]
    ds_read_b64_tr_b16 v[170:171], v10 offset:4608
    ds_read_b64_tr_b16 v[172:173], v10 offset:12288
    s_waitcnt lgkmcnt(6)
    v_mfma_f32_32x32x16_bf16 v[80:95], v[188:191], v[184:187], v[80:95]
    ds_read_b64_tr_b16 v[174:175], v10 offset:12800
    ds_read_b128 v[164:167], v4 offset:4096
    v_mfma_f32_32x32x16_bf16 v[112:127], v[192:195], v[184:187], v[112:127]
    ds_read_b64_tr_b16 v[176:177], v10 offset:20480
    ds_read_b64_tr_b16 v[178:179], v10 offset:20992
    s_waitcnt lgkmcnt(8)
    v_mfma_f32_32x32x16_bf16 v[128:143], v[180:183], v[196:199], v[128:143]
    v_mfma_f32_32x32x16_bf16 v[144:159], v[184:187], v[196:199], v[144:159]
    s_waitcnt lgkmcnt(5)
    v_mfma_f32_32x32x16_bf16 v[64:79], v[168:171], v[160:163], v[64:79]
    ds_read_b128 v[180:183], v5 offset:0
    ds_read_b64_tr_b16 v[188:189], v10 offset:6144
    s_waitcnt lgkmcnt(5)
    v_mfma_f32_32x32x16_bf16 v[96:111], v[172:175], v[160:163], v[96:111]
    ds_read_b64_tr_b16 v[190:191], v10 offset:6656
    ds_read_b64_tr_b16 v[192:193], v10 offset:14336
    s_waitcnt lgkmcnt(6)
    v_mfma_f32_32x32x16_bf16 v[80:95], v[168:171], v[164:167], v[80:95]
    ds_read_b64_tr_b16 v[194:195], v10 offset:14848
    ds_read_b128 v[184:187], v5 offset:4096
    v_mfma_f32_32x32x16_bf16 v[112:127], v[172:175], v[164:167], v[112:127]
    ds_read_b64_tr_b16 v[196:197], v10 offset:22528
    ds_read_b64_tr_b16 v[198:199], v10 offset:23040
    s_waitcnt lgkmcnt(8)
    v_mfma_f32_32x32x16_bf16 v[128:143], v[160:163], v[176:179], v[128:143]
    v_mfma_f32_32x32x16_bf16 v[144:159], v[164:167], v[176:179], v[144:159]
    s_waitcnt lgkmcnt(5)
    v_mfma_f32_32x32x16_bf16 v[64:79], v[188:191], v[180:183], v[64:79]
    s_waitcnt lgkmcnt(3)
    v_mfma_f32_32x32x16_bf16 v[96:111], v[192:195], v[180:183], v[96:111]
    s_waitcnt lgkmcnt(0)
    ds_write_b32 v60, v61 offset:144
    v_mfma_f32_32x32x16_bf16 v[80:95], v[188:191], v[184:187], v[80:95]
    v_mfma_f32_32x32x16_bf16 v[112:127], v[192:195], v[184:187], v[112:127]
    v_mfma_f32_32x32x16_bf16 v[128:143], v[180:183], v[196:199], v[128:143]
    v_mfma_f32_32x32x16_bf16 v[144:159], v[184:187], v[196:199], v[144:159]
    s_nop 5
    v_cvt_pk_bf16_f32 v160, v96, v97
    v_cvt_pk_bf16_f32 v161, v98, v99
    v_cvt_pk_bf16_f32 v162, v100, v101
    v_cvt_pk_bf16_f32 v163, v102, v103
    v_cvt_pk_bf16_f32 v164, v104, v105
    v_cvt_pk_bf16_f32 v165, v106, v107
    v_cvt_pk_bf16_f32 v166, v108, v109
    v_cvt_pk_bf16_f32 v167, v110, v111
    v_mfma_f32_32x32x16_bf16 v[176:191], v[20:23], v[160:163], 0
    s_nop 0
    v_mfma_f32_32x32x16_bf16 v[176:191], v[24:27], v[164:167], v[176:191]
    v_cvt_pk_bf16_f32 v168, v112, v113
    v_cvt_pk_bf16_f32 v169, v114, v115
    v_cvt_pk_bf16_f32 v170, v116, v117
    v_cvt_pk_bf16_f32 v171, v118, v119
    v_cvt_pk_bf16_f32 v172, v120, v121
    v_cvt_pk_bf16_f32 v173, v122, v123
    v_cvt_pk_bf16_f32 v174, v124, v125
    v_cvt_pk_bf16_f32 v175, v126, v127
    v_mfma_f32_32x32x16_bf16 v[192:207], v[20:23], v[168:171], 0
    s_nop 0
    v_mfma_f32_32x32x16_bf16 v[192:207], v[24:27], v[172:175], v[192:207]
    v_cvt_pk_bf16_f32 v128, v128, v129
    v_cvt_pk_bf16_f32 v129, v130, v131
    v_cvt_pk_bf16_f32 v130, v132, v133
    v_cvt_pk_bf16_f32 v131, v134, v135
    v_cvt_pk_bf16_f32 v132, v136, v137
    v_cvt_pk_bf16_f32 v133, v138, v139
    v_cvt_pk_bf16_f32 v134, v140, v141
    v_cvt_pk_bf16_f32 v135, v142, v143
    v_cvt_pk_bf16_f32 v136, v144, v145
    v_cvt_pk_bf16_f32 v137, v146, v147
    v_cvt_pk_bf16_f32 v138, v148, v149
    v_cvt_pk_bf16_f32 v139, v150, v151
    v_cvt_pk_bf16_f32 v140, v152, v153
    v_cvt_pk_bf16_f32 v141, v154, v155
    v_cvt_pk_bf16_f32 v142, v156, v157
    v_cvt_pk_bf16_f32 v143, v158, v159
    v_max3_f32 v240, v176, v177, v178
    v_min3_f32 v242, v176, v177, v178
    v_max3_f32 v240, v240, v179, v180
    v_min3_f32 v242, v242, v179, v180
    v_max3_f32 v240, v240, v181, v182
    v_min3_f32 v242, v242, v181, v182
    v_max3_f32 v240, v240, v183, v184
    v_min3_f32 v242, v242, v183, v184
    v_max3_f32 v240, v240, v185, v186
    v_min3_f32 v242, v242, v185, v186
    v_max3_f32 v240, v240, v187, v188
    v_min3_f32 v242, v242, v187, v188
    v_max3_f32 v240, v240, v189, v190
    v_min3_f32 v242, v242, v189, v190
    v_max_f32 v240, v240, v191
    v_min_f32 v242, v242, v191
    v_max3_f32 v248, v192, v193, v194
    v_min3_f32 v250, v192, v193, v194
    v_max3_f32 v248, v248, v195, v196
    v_min3_f32 v250, v250, v195, v196
    v_max3_f32 v248, v248, v197, v198
    v_min3_f32 v250, v250, v197, v198
    v_max3_f32 v248, v248, v199, v200
    v_min3_f32 v250, v250, v199, v200
    v_max3_f32 v248, v248, v201, v202
    v_min3_f32 v250, v250, v201, v202
    v_max3_f32 v248, v248, v203, v204
    v_min3_f32 v250, v250, v203, v204
    v_max3_f32 v248, v248, v205, v206
    v_min3_f32 v250, v250, v205, v206
    v_max_f32 v248, v248, v207
    v_min_f32 v250, v250, v207
    v_mov_b32 v244, v240
    v_mov_b32 v252, v248
    v_mov_b32 v246, v242
    v_mov_b32 v254, v250
    v_permlane32_swap_b32 v244, v240
    v_permlane32_swap_b32 v252, v248
    v_permlane32_swap_b32 v246, v242
    v_permlane32_swap_b32 v254, v250
    v_max_f32 v240, v240, v244
    v_max_f32 v248, v248, v252
    v_min_f32 v242, v242, v246
    v_min_f32 v250, v250, v254
    v_mul_f32 v240, s87, v240
    v_mul_f32 v248, s87, v248
    v_mul_f32 v242, s87, v242
    v_mul_f32 v250, s87, v250
    v_pk_fma_f32 v[208:209], v[176:177], v[62:63], v[240:241] op_sel_hi:[1,1,0] neg_lo:[0,0,1] neg_hi:[0,0,1]
    v_pk_fma_f32 v[224:225], v[192:193], v[62:63], v[248:249] op_sel_hi:[1,1,0] neg_lo:[0,0,1] neg_hi:[0,0,1]
    v_pk_fma_f32 v[176:177], v[176:177], v[62:63], v[242:243] op_sel_hi:[1,1,0] neg_lo:[1,0,0] neg_hi:[1,0,0]
    v_pk_fma_f32 v[192:193], v[192:193], v[62:63], v[250:251] op_sel_hi:[1,1,0] neg_lo:[1,0,0] neg_hi:[1,0,0]
    v_pk_fma_f32 v[210:211], v[178:179], v[62:63], v[240:241] op_sel_hi:[1,1,0] neg_lo:[0,0,1] neg_hi:[0,0,1]
    v_pk_fma_f32 v[226:227], v[194:195], v[62:63], v[248:249] op_sel_hi:[1,1,0] neg_lo:[0,0,1] neg_hi:[0,0,1]
    v_pk_fma_f32 v[178:179], v[178:179], v[62:63], v[242:243] op_sel_hi:[1,1,0] neg_lo:[1,0,0] neg_hi:[1,0,0]
    v_pk_fma_f32 v[194:195], v[194:195], v[62:63], v[250:251] op_sel_hi:[1,1,0] neg_lo:[1,0,0] neg_hi:[1,0,0]
    v_pk_fma_f32 v[212:213], v[180:181], v[62:63], v[240:241] op_sel_hi:[1,1,0] neg_lo:[0,0,1] neg_hi:[0,0,1]
    v_pk_fma_f32 v[228:229], v[196:197], v[62:63], v[248:249] op_sel_hi:[1,1,0] neg_lo:[0,0,1] neg_hi:[0,0,1]
    v_pk_fma_f32 v[180:181], v[180:181], v[62:63], v[242:243] op_sel_hi:[1,1,0] neg_lo:[1,0,0] neg_hi:[1,0,0]
    v_pk_fma_f32 v[196:197], v[196:197], v[62:63], v[250:251] op_sel_hi:[1,1,0] neg_lo:[1,0,0] neg_hi:[1,0,0]
    v_pk_fma_f32 v[214:215], v[182:183], v[62:63], v[240:241] op_sel_hi:[1,1,0] neg_lo:[0,0,1] neg_hi:[0,0,1]
    v_pk_fma_f32 v[230:231], v[198:199], v[62:63], v[248:249] op_sel_hi:[1,1,0] neg_lo:[0,0,1] neg_hi:[0,0,1]
    v_pk_fma_f32 v[182:183], v[182:183], v[62:63], v[242:243] op_sel_hi:[1,1,0] neg_lo:[1,0,0] neg_hi:[1,0,0]
    v_pk_fma_f32 v[198:199], v[198:199], v[62:63], v[250:251] op_sel_hi:[1,1,0] neg_lo:[1,0,0] neg_hi:[1,0,0]
    v_pk_fma_f32 v[216:217], v[184:185], v[62:63], v[240:241] op_sel_hi:[1,1,0] neg_lo:[0,0,1] neg_hi:[0,0,1]
    v_pk_fma_f32 v[232:233], v[200:201], v[62:63], v[248:249] op_sel_hi:[1,1,0] neg_lo:[0,0,1] neg_hi:[0,0,1]
    v_pk_fma_f32 v[184:185], v[184:185], v[62:63], v[242:243] op_sel_hi:[1,1,0] neg_lo:[1,0,0] neg_hi:[1,0,0]
    v_pk_fma_f32 v[200:201], v[200:201], v[62:63], v[250:251] op_sel_hi:[1,1,0] neg_lo:[1,0,0] neg_hi:[1,0,0]
    v_pk_fma_f32 v[218:219], v[186:187], v[62:63], v[240:241] op_sel_hi:[1,1,0] neg_lo:[0,0,1] neg_hi:[0,0,1]
    v_pk_fma_f32 v[234:235], v[202:203], v[62:63], v[248:249] op_sel_hi:[1,1,0] neg_lo:[0,0,1] neg_hi:[0,0,1]
    v_pk_fma_f32 v[186:187], v[186:187], v[62:63], v[242:243] op_sel_hi:[1,1,0] neg_lo:[1,0,0] neg_hi:[1,0,0]
    v_pk_fma_f32 v[202:203], v[202:203], v[62:63], v[250:251] op_sel_hi:[1,1,0] neg_lo:[1,0,0] neg_hi:[1,0,0]
    v_pk_fma_f32 v[220:221], v[188:189], v[62:63], v[240:241] op_sel_hi:[1,1,0] neg_lo:[0,0,1] neg_hi:[0,0,1]
    v_pk_fma_f32 v[236:237], v[204:205], v[62:63], v[248:249] op_sel_hi:[1,1,0] neg_lo:[0,0,1] neg_hi:[0,0,1]
    v_pk_fma_f32 v[188:189], v[188:189], v[62:63], v[242:243] op_sel_hi:[1,1,0] neg_lo:[1,0,0] neg_hi:[1,0,0]
    v_pk_fma_f32 v[204:205], v[204:205], v[62:63], v[250:251] op_sel_hi:[1,1,0] neg_lo:[1,0,0] neg_hi:[1,0,0]
    v_pk_fma_f32 v[222:223], v[190:191], v[62:63], v[240:241] op_sel_hi:[1,1,0] neg_lo:[0,0,1] neg_hi:[0,0,1]
    v_pk_fma_f32 v[238:239], v[206:207], v[62:63], v[248:249] op_sel_hi:[1,1,0] neg_lo:[0,0,1] neg_hi:[0,0,1]
    v_pk_fma_f32 v[190:191], v[190:191], v[62:63], v[242:243] op_sel_hi:[1,1,0] neg_lo:[1,0,0] neg_hi:[1,0,0]
    v_pk_fma_f32 v[206:207], v[206:207], v[62:63], v[250:251] op_sel_hi:[1,1,0] neg_lo:[1,0,0] neg_hi:[1,0,0]
    v_exp_f32 v208, v208
    v_exp_f32 v224, v224
    v_exp_f32 v176, v176
    v_exp_f32 v192, v192
    v_exp_f32 v209, v209
    v_exp_f32 v225, v225
    v_exp_f32 v177, v177
    v_exp_f32 v193, v193
    v_exp_f32 v210, v210
    v_exp_f32 v226, v226
    v_exp_f32 v178, v178
    v_exp_f32 v194, v194
    v_exp_f32 v211, v211
    v_exp_f32 v227, v227
    v_exp_f32 v179, v179
    v_exp_f32 v195, v195
    v_exp_f32 v212, v212
    v_exp_f32 v228, v228
    v_exp_f32 v180, v180
    v_exp_f32 v196, v196
    v_exp_f32 v213, v213
    v_exp_f32 v229, v229
    v_exp_f32 v181, v181
    v_exp_f32 v197, v197
    v_exp_f32 v214, v214
    v_exp_f32 v230, v230
    v_exp_f32 v182, v182
    v_exp_f32 v198, v198
    v_exp_f32 v215, v215
    v_exp_f32 v231, v231
    v_exp_f32 v183, v183
    v_exp_f32 v199, v199
    v_exp_f32 v216, v216
    v_exp_f32 v232, v232
    v_exp_f32 v184, v184
    v_exp_f32 v200, v200
    v_exp_f32 v217, v217
    v_exp_f32 v233, v233
    v_exp_f32 v185, v185
    v_exp_f32 v201, v201
    v_exp_f32 v218, v218
    v_exp_f32 v234, v234
    v_exp_f32 v186, v186
    v_exp_f32 v202, v202
    v_exp_f32 v219, v219
    v_exp_f32 v235, v235
    v_exp_f32 v187, v187
    v_exp_f32 v203, v203
    v_exp_f32 v220, v220
    v_exp_f32 v236, v236
    v_exp_f32 v188, v188
    v_exp_f32 v204, v204
    v_exp_f32 v221, v221
    v_exp_f32 v237, v237
    v_exp_f32 v189, v189
    v_exp_f32 v205, v205
    v_exp_f32 v222, v222
    v_exp_f32 v238, v238
    v_exp_f32 v190, v190
    v_exp_f32 v206, v206
    v_exp_f32 v223, v223
    v_exp_f32 v239, v239
    v_exp_f32 v191, v191
    v_exp_f32 v207, v207
    v_pk_add_f32 v[240:241], v[208:209], v[210:211]
    v_pk_add_f32 v[248:249], v[224:225], v[226:227]
    v_pk_add_f32 v[242:243], v[176:177], v[178:179]
    v_pk_add_f32 v[250:251], v[192:193], v[194:195]
    v_pk_add_f32 v[240:241], v[240:241], v[212:213]
    v_pk_add_f32 v[248:249], v[248:249], v[228:229]
    v_pk_add_f32 v[242:243], v[242:243], v[180:181]
    v_pk_add_f32 v[250:251], v[250:251], v[196:197]
    v_pk_add_f32 v[240:241], v[240:241], v[214:215]
    v_pk_add_f32 v[248:249], v[248:249], v[230:231]
    v_pk_add_f32 v[242:243], v[242:243], v[182:183]
    v_pk_add_f32 v[250:251], v[250:251], v[198:199]
    v_pk_add_f32 v[240:241], v[240:241], v[216:217]
    v_pk_add_f32 v[248:249], v[248:249], v[232:233]
    v_pk_add_f32 v[242:243], v[242:243], v[184:185]
    v_pk_add_f32 v[250:251], v[250:251], v[200:201]
    v_pk_add_f32 v[240:241], v[240:241], v[218:219]
    v_pk_add_f32 v[248:249], v[248:249], v[234:235]
    v_pk_add_f32 v[242:243], v[242:243], v[186:187]
    v_pk_add_f32 v[250:251], v[250:251], v[202:203]
    v_pk_add_f32 v[240:241], v[240:241], v[220:221]
    v_pk_add_f32 v[248:249], v[248:249], v[236:237]
    v_pk_add_f32 v[242:243], v[242:243], v[188:189]
    v_pk_add_f32 v[250:251], v[250:251], v[204:205]
    v_pk_add_f32 v[240:241], v[240:241], v[222:223]
    v_pk_add_f32 v[248:249], v[248:249], v[238:239]
    v_pk_add_f32 v[242:243], v[242:243], v[190:191]
    v_pk_add_f32 v[250:251], v[250:251], v[206:207]
    v_add_f32 v240, v240, v241
    v_add_f32 v248, v248, v249
    v_add_f32 v242, v242, v243
    v_add_f32 v250, v250, v251
    v_mov_b32 v244, v240
    v_mov_b32 v252, v248
    v_mov_b32 v246, v242
    v_mov_b32 v254, v250
    v_permlane32_swap_b32 v244, v240
    v_permlane32_swap_b32 v252, v248
    v_permlane32_swap_b32 v246, v242
    v_permlane32_swap_b32 v254, v250
    v_add_f32 v240, v240, v244
    v_add_f32 v248, v248, v252
    v_add_f32 v242, v242, v246
    v_add_f32 v250, v250, v254
    v_rcp_f32 v240, v240
    v_rcp_f32 v248, v248
    v_rcp_f32 v242, v242
    v_rcp_f32 v250, v250
    v_pk_mul_f32 v[208:209], v[208:209], v[240:241] op_sel_hi:[1,0]
    v_pk_mul_f32 v[224:225], v[224:225], v[248:249] op_sel_hi:[1,0]
    v_pk_mul_f32 v[176:177], v[176:177], v[242:243] op_sel_hi:[1,0]
    v_pk_mul_f32 v[192:193], v[192:193], v[250:251] op_sel_hi:[1,0]
    v_pk_mul_f32 v[210:211], v[210:211], v[240:241] op_sel_hi:[1,0]
    v_pk_mul_f32 v[226:227], v[226:227], v[248:249] op_sel_hi:[1,0]
    v_pk_mul_f32 v[178:179], v[178:179], v[242:243] op_sel_hi:[1,0]
    v_pk_mul_f32 v[194:195], v[194:195], v[250:251] op_sel_hi:[1,0]
    v_pk_mul_f32 v[212:213], v[212:213], v[240:241] op_sel_hi:[1,0]
    v_pk_mul_f32 v[228:229], v[228:229], v[248:249] op_sel_hi:[1,0]
    v_pk_mul_f32 v[180:181], v[180:181], v[242:243] op_sel_hi:[1,0]
    v_pk_mul_f32 v[196:197], v[196:197], v[250:251] op_sel_hi:[1,0]
    v_pk_mul_f32 v[214:215], v[214:215], v[240:241] op_sel_hi:[1,0]
    v_pk_mul_f32 v[230:231], v[230:231], v[248:249] op_sel_hi:[1,0]
    v_pk_mul_f32 v[182:183], v[182:183], v[242:243] op_sel_hi:[1,0]
    v_pk_mul_f32 v[198:199], v[198:199], v[250:251] op_sel_hi:[1,0]
    v_pk_mul_f32 v[216:217], v[216:217], v[240:241] op_sel_hi:[1,0]
    v_pk_mul_f32 v[232:233], v[232:233], v[248:249] op_sel_hi:[1,0]
    v_pk_mul_f32 v[184:185], v[184:185], v[242:243] op_sel_hi:[1,0]
    v_pk_mul_f32 v[200:201], v[200:201], v[250:251] op_sel_hi:[1,0]
    v_pk_mul_f32 v[218:219], v[218:219], v[240:241] op_sel_hi:[1,0]
    v_pk_mul_f32 v[234:235], v[234:235], v[248:249] op_sel_hi:[1,0]
    v_pk_mul_f32 v[186:187], v[186:187], v[242:243] op_sel_hi:[1,0]
    v_pk_mul_f32 v[202:203], v[202:203], v[250:251] op_sel_hi:[1,0]
    v_pk_mul_f32 v[220:221], v[220:221], v[240:241] op_sel_hi:[1,0]
    v_pk_mul_f32 v[236:237], v[236:237], v[248:249] op_sel_hi:[1,0]
    v_pk_mul_f32 v[188:189], v[188:189], v[242:243] op_sel_hi:[1,0]
    v_pk_mul_f32 v[204:205], v[204:205], v[250:251] op_sel_hi:[1,0]
    v_pk_mul_f32 v[222:223], v[222:223], v[240:241] op_sel_hi:[1,0]
    v_pk_mul_f32 v[238:239], v[238:239], v[248:249] op_sel_hi:[1,0]
    v_pk_mul_f32 v[190:191], v[190:191], v[242:243] op_sel_hi:[1,0]
    v_pk_mul_f32 v[206:207], v[206:207], v[250:251] op_sel_hi:[1,0]
    v_cvt_pk_bf16_f32 v96, v208, v209
    v_cvt_pk_bf16_f32 v104, v176, v177
    v_cvt_pk_bf16_f32 v97, v210, v211
    v_cvt_pk_bf16_f32 v105, v178, v179
    v_cvt_pk_bf16_f32 v98, v212, v213
    v_cvt_pk_bf16_f32 v106, v180, v181
    v_cvt_pk_bf16_f32 v99, v214, v215
    v_cvt_pk_bf16_f32 v107, v182, v183
    v_cvt_pk_bf16_f32 v100, v216, v217
    v_cvt_pk_bf16_f32 v108, v184, v185
    v_cvt_pk_bf16_f32 v101, v218, v219
    v_cvt_pk_bf16_f32 v109, v186, v187
    v_cvt_pk_bf16_f32 v102, v220, v221
    v_cvt_pk_bf16_f32 v110, v188, v189
    v_cvt_pk_bf16_f32 v103, v222, v223
    v_cvt_pk_bf16_f32 v111, v190, v191
    v_mov_b32 v36, 0
    v_mov_b32 v37, 0
    v_mfma_f32_32x32x16_bf16 v[176:191], v[104:107], v[28:31], 0
    v_cvt_pk_bf16_f32 v112, v224, v225
    v_cvt_pk_bf16_f32 v120, v192, v193
    v_cvt_pk_bf16_f32 v113, v226, v227
    v_cvt_pk_bf16_f32 v121, v194, v195
    v_mfma_f32_32x32x16_bf16 v[176:191], v[108:111], v[32:35], v[176:191]
    v_cvt_pk_bf16_f32 v114, v228, v229
    v_cvt_pk_bf16_f32 v122, v196, v197
    v_cvt_pk_bf16_f32 v115, v230, v231
    v_cvt_pk_bf16_f32 v123, v198, v199
    v_mfma_f32_32x32x16_bf16 v[160:175], v[96:99], v[28:31], 0
    v_cvt_pk_bf16_f32 v116, v232, v233
    v_cvt_pk_bf16_f32 v124, v200, v201
    v_cvt_pk_bf16_f32 v117, v234, v235
    v_cvt_pk_bf16_f32 v125, v202, v203
    v_mfma_f32_32x32x16_bf16 v[160:175], v[100:103], v[32:35], v[160:175]
    v_cvt_pk_bf16_f32 v118, v236, v237
    v_cvt_pk_bf16_f32 v126, v204, v205
    v_cvt_pk_bf16_f32 v119, v238, v239
    v_cvt_pk_bf16_f32 v127, v206, v207
    v_mfma_f32_32x32x16_bf16 v[192:207], v[120:123], v[28:31], 0
    s_nop 0
    v_mfma_f32_32x32x16_bf16 v[192:207], v[124:127], v[32:35], v[192:207]
    v_cvt_pk_bf16_f32 v176, v176, v177
    v_cvt_pk_bf16_f32 v177, v178, v179
    v_cvt_pk_bf16_f32 v178, v180, v181
    v_cvt_pk_bf16_f32 v179, v182, v183
    v_cvt_pk_bf16_f32 v180, v184, v185
    v_cvt_pk_bf16_f32 v181, v186, v187
    v_mfma_f32_32x32x16_bf16 v[208:223], v[112:115], v[28:31], 0
    v_cvt_pk_bf16_f32 v182, v188, v189
    v_cvt_pk_bf16_f32 v183, v190, v191
    v_cvt_pk_bf16_f32 v160, v160, v161
    v_cvt_pk_bf16_f32 v161, v162, v163
    v_cvt_pk_bf16_f32 v162, v164, v165
    v_mfma_f32_32x32x16_bf16 v[208:223], v[116:119], v[32:35], v[208:223]
    v_cvt_pk_bf16_f32 v163, v166, v167
    v_cvt_pk_bf16_f32 v164, v168, v169
    v_cvt_pk_bf16_f32 v165, v170, v171
    v_cvt_pk_bf16_f32 v166, v172, v173
    v_cvt_pk_bf16_f32 v167, v174, v175
    v_mfma_f32_32x32x16_bf16 v[224:239], v[176:179], v[128:131], 0
    v_cvt_pk_bf16_f32 v192, v192, v193
    v_cvt_pk_bf16_f32 v193, v194, v195
    v_cvt_pk_bf16_f32 v194, v196, v197
    v_cvt_pk_bf16_f32 v195, v198, v199
    v_mfma_f32_32x32x16_bf16 v[224:239], v[180:183], v[132:135], v[224:239]
    v_cvt_pk_bf16_f32 v196, v200, v201
    v_cvt_pk_bf16_f32 v197, v202, v203
    v_cvt_pk_bf16_f32 v198, v204, v205
    v_cvt_pk_bf16_f32 v199, v206, v207
    v_mfma_f32_32x32x16_bf16 v[144:159], v[160:163], v[128:131], 0
    v_cvt_pk_bf16_f32 v208, v208, v209
    v_cvt_pk_bf16_f32 v209, v210, v211
    v_cvt_pk_bf16_f32 v210, v212, v213
    v_cvt_pk_bf16_f32 v211, v214, v215
    v_mfma_f32_32x32x16_bf16 v[144:159], v[164:167], v[132:135], v[144:159]
    v_cvt_pk_bf16_f32 v212, v216, v217
    v_cvt_pk_bf16_f32 v213, v218, v219
    v_cvt_pk_bf16_f32 v214, v220, v221
    v_cvt_pk_bf16_f32 v215, v222, v223
    v_mfma_f32_32x32x16_bf16 v[224:239], v[192:195], v[136:139], v[224:239]
    v_mfma_f32_32x32x16_bf16 v[224:239], v[196:199], v[140:143], v[224:239]
    v_mfma_f32_32x32x16_bf16 v[144:159], v[208:211], v[136:139], v[144:159]
    v_mfma_f32_32x32x16_bf16 v[144:159], v[212:215], v[140:143], v[144:159]
    v_dot2c_f32_bf16 v37, v176, v39
    v_dot2c_f32_bf16 v37, v177, v39
    v_dot2c_f32_bf16 v37, v178, v39
    v_dot2c_f32_bf16 v37, v179, v39
    v_dot2c_f32_bf16 v37, v180, v39
    v_dot2c_f32_bf16 v37, v181, v39
    v_dot2c_f32_bf16 v37, v182, v39
    v_dot2c_f32_bf16 v37, v183, v39
    v_dot2c_f32_bf16 v37, v192, v39
    v_dot2c_f32_bf16 v37, v193, v39
    v_dot2c_f32_bf16 v37, v194, v39
    v_dot2c_f32_bf16 v37, v195, v39
    v_dot2c_f32_bf16 v37, v196, v39
    v_dot2c_f32_bf16 v37, v197, v39
    v_dot2c_f32_bf16 v37, v198, v39
    v_dot2c_f32_bf16 v37, v199, v39
    v_dot2c_f32_bf16 v36, v160, v39
    v_dot2c_f32_bf16 v36, v161, v39
    v_dot2c_f32_bf16 v36, v162, v39
    v_dot2c_f32_bf16 v36, v163, v39
    v_dot2c_f32_bf16 v36, v164, v39
    v_dot2c_f32_bf16 v36, v165, v39
    v_dot2c_f32_bf16 v36, v166, v39
    v_dot2c_f32_bf16 v36, v167, v39
    v_dot2c_f32_bf16 v36, v208, v39
    v_dot2c_f32_bf16 v36, v209, v39
    v_dot2c_f32_bf16 v36, v210, v39
    v_dot2c_f32_bf16 v36, v211, v39
    v_dot2c_f32_bf16 v36, v212, v39
    v_dot2c_f32_bf16 v36, v213, v39
    v_dot2c_f32_bf16 v36, v214, v39
    v_dot2c_f32_bf16 v36, v215, v39
    ds_write_b128 v41, v[224:227] offset:0
    ds_write_b128 v41, v[228:231] offset:1024
    ds_write_b128 v41, v[232:235] offset:2048
    ds_write_b128 v41, v[236:239] offset:3072
    v_permlane32_swap_b32 v36, v37
    v_add_f32 v36, v36, v37
    ds_write_b32 v44, v36
    ds_write_b32 v60, v61 offset:0
    s_mov_b32 s88, 0
Lpair_1:
    ds_read_b32 v58, v55 offset:0
    s_add_u32 s88, s88, 1
    s_cmp_ge_u32 s88, 2097152
    s_waitcnt lgkmcnt(0)
    v_cmp_eq_u32 vcc, 0, v58
    s_cbranch_scc1 Lpaird_2
    s_nop 0
    s_cbranch_vccnz Lpair_1
Lpaird_2:
    ds_read_b128 v[160:163], v42 offset:0
    ds_read_b128 v[164:167], v42 offset:1024
    ds_read_b128 v[168:171], v42 offset:2048
    ds_read_b128 v[172:175], v42 offset:3072
    ds_read_b32 v37, v45
    s_waitcnt lgkmcnt(4)
    v_pk_add_f32 v[144:145], v[144:145], v[160:161]
    v_pk_add_f32 v[146:147], v[146:147], v[162:163]
    v_cvt_pk_bf16_f32 v96, v144, v145
    v_cvt_pk_bf16_f32 v97, v146, v147
    s_waitcnt lgkmcnt(3)
    v_pk_add_f32 v[148:149], v[148:149], v[164:165]
    v_pk_add_f32 v[150:151], v[150:151], v[166:167]
    v_cvt_pk_bf16_f32 v98, v148, v149
    v_cvt_pk_bf16_f32 v99, v150, v151
    buffer_store_dwordx4 v[96:99], v40, s[44:47], s77 offen offset:0 sc1
    s_waitcnt lgkmcnt(2)
    v_pk_add_f32 v[152:153], v[152:153], v[168:169]
    v_pk_add_f32 v[154:155], v[154:155], v[170:171]
    v_cvt_pk_bf16_f32 v100, v152, v153
    v_cvt_pk_bf16_f32 v101, v154, v155
    s_waitcnt lgkmcnt(1)
    v_pk_add_f32 v[156:157], v[156:157], v[172:173]
    v_pk_add_f32 v[158:159], v[158:159], v[174:175]
    v_cvt_pk_bf16_f32 v102, v156, v157
    v_cvt_pk_bf16_f32 v103, v158, v159
    buffer_store_dwordx4 v[100:103], v40, s[44:47], s77 offen offset:1024 sc1
    s_waitcnt lgkmcnt(0)
    ds_write_b32 v60, v61 offset:128
    v_add_f32 v36, v36, v37
    s_mov_b32 exec_hi, 0
    buffer_store_dword v36, v43, s[44:47], s77 offen offset:2048 sc1
    s_mov_b64 exec, -1
    v_cvt_pk_bf16_f32 v160, v64, v65
    v_cvt_pk_bf16_f32 v161, v66, v67
    v_cvt_pk_bf16_f32 v162, v68, v69
    v_cvt_pk_bf16_f32 v163, v70, v71
    v_cvt_pk_bf16_f32 v164, v72, v73
    v_cvt_pk_bf16_f32 v165, v74, v75
    v_cvt_pk_bf16_f32 v166, v76, v77
    v_cvt_pk_bf16_f32 v167, v78, v79
    v_mfma_f32_32x32x16_bf16 v[176:191], v[12:15], v[160:163], 0
    s_nop 0
    v_mfma_f32_32x32x16_bf16 v[176:191], v[16:19], v[164:167], v[176:191]
    v_cvt_pk_bf16_f32 v168, v80, v81
    v_cvt_pk_bf16_f32 v169, v82, v83
    v_cvt_pk_bf16_f32 v170, v84, v85
    v_cvt_pk_bf16_f32 v171, v86, v87
    v_cvt_pk_bf16_f32 v172, v88, v89
    v_cvt_pk_bf16_f32 v173, v90, v91
    v_cvt_pk_bf16_f32 v174, v92, v93
    v_cvt_pk_bf16_f32 v175, v94, v95
    v_mfma_f32_32x32x16_bf16 v[192:207], v[12:15], v[168:171], 0
    s_nop 0
    v_mfma_f32_32x32x16_bf16 v[192:207], v[16:19], v[172:175], v[192:207]
    s_nop 0
    v_max3_f32 v240, v176, v177, v178
    v_min3_f32 v242, v176, v177, v178
    v_max3_f32 v240, v240, v179, v180
    v_min3_f32 v242, v242, v179, v180
    v_max3_f32 v240, v240, v181, v182
    v_min3_f32 v242, v242, v181, v182
    v_max3_f32 v240, v240, v183, v184
    v_min3_f32 v242, v242, v183, v184
    v_max3_f32 v240, v240, v185, v186
    v_min3_f32 v242, v242, v185, v186
    v_max3_f32 v240, v240, v187, v188
    v_min3_f32 v242, v242, v187, v188
    v_max3_f32 v240, v240, v189, v190
    v_min3_f32 v242, v242, v189, v190
    v_max_f32 v240, v240, v191
    v_min_f32 v242, v242, v191
    v_max3_f32 v248, v192, v193, v194
    v_min3_f32 v250, v192, v193, v194
    v_max3_f32 v248, v248, v195, v196
    v_min3_f32 v250, v250, v195, v196
    v_max3_f32 v248, v248, v197, v198
    v_min3_f32 v250, v250, v197, v198
    v_max3_f32 v248, v248, v199, v200
    v_min3_f32 v250, v250, v199, v200
    v_max3_f32 v248, v248, v201, v202
    v_min3_f32 v250, v250, v201, v202
    v_max3_f32 v248, v248, v203, v204
    v_min3_f32 v250, v250, v203, v204
    v_max3_f32 v248, v248, v205, v206
    v_min3_f32 v250, v250, v205, v206
    v_max_f32 v248, v248, v207
    v_min_f32 v250, v250, v207
    v_mov_b32 v244, v240
    v_mov_b32 v252, v248
    v_mov_b32 v246, v242
    v_mov_b32 v254, v250
    v_permlane32_swap_b32 v244, v240
    v_permlane32_swap_b32 v252, v248
    v_permlane32_swap_b32 v246, v242
    v_permlane32_swap_b32 v254, v250
    v_max_f32 v240, v240, v244
    v_max_f32 v248, v248, v252
    v_min_f32 v242, v242, v246
    v_min_f32 v250, v250, v254
    v_mul_f32 v240, s87, v240
    v_mul_f32 v248, s87, v248
    v_mul_f32 v242, s87, v242
    v_mul_f32 v250, s87, v250
    v_pk_fma_f32 v[208:209], v[176:177], v[62:63], v[240:241] op_sel_hi:[1,1,0] neg_lo:[0,0,1] neg_hi:[0,0,1]
    v_pk_fma_f32 v[224:225], v[192:193], v[62:63], v[248:249] op_sel_hi:[1,1,0] neg_lo:[0,0,1] neg_hi:[0,0,1]
    v_pk_fma_f32 v[176:177], v[176:177], v[62:63], v[242:243] op_sel_hi:[1,1,0] neg_lo:[1,0,0] neg_hi:[1,0,0]
    v_pk_fma_f32 v[192:193], v[192:193], v[62:63], v[250:251] op_sel_hi:[1,1,0] neg_lo:[1,0,0] neg_hi:[1,0,0]
    v_pk_fma_f32 v[210:211], v[178:179], v[62:63], v[240:241] op_sel_hi:[1,1,0] neg_lo:[0,0,1] neg_hi:[0,0,1]
    v_pk_fma_f32 v[226:227], v[194:195], v[62:63], v[248:249] op_sel_hi:[1,1,0] neg_lo:[0,0,1] neg_hi:[0,0,1]
    v_pk_fma_f32 v[178:179], v[178:179], v[62:63], v[242:243] op_sel_hi:[1,1,0] neg_lo:[1,0,0] neg_hi:[1,0,0]
    v_pk_fma_f32 v[194:195], v[194:195], v[62:63], v[250:251] op_sel_hi:[1,1,0] neg_lo:[1,0,0] neg_hi:[1,0,0]
    v_pk_fma_f32 v[212:213], v[180:181], v[62:63], v[240:241] op_sel_hi:[1,1,0] neg_lo:[0,0,1] neg_hi:[0,0,1]
    v_pk_fma_f32 v[228:229], v[196:197], v[62:63], v[248:249] op_sel_hi:[1,1,0] neg_lo:[0,0,1] neg_hi:[0,0,1]
    v_pk_fma_f32 v[180:181], v[180:181], v[62:63], v[242:243] op_sel_hi:[1,1,0] neg_lo:[1,0,0] neg_hi:[1,0,0]
    v_pk_fma_f32 v[196:197], v[196:197], v[62:63], v[250:251] op_sel_hi:[1,1,0] neg_lo:[1,0,0] neg_hi:[1,0,0]
    v_pk_fma_f32 v[214:215], v[182:183], v[62:63], v[240:241] op_sel_hi:[1,1,0] neg_lo:[0,0,1] neg_hi:[0,0,1]
    v_pk_fma_f32 v[230:231], v[198:199], v[62:63], v[248:249] op_sel_hi:[1,1,0] neg_lo:[0,0,1] neg_hi:[0,0,1]
    v_pk_fma_f32 v[182:183], v[182:183], v[62:63], v[242:243] op_sel_hi:[1,1,0] neg_lo:[1,0,0] neg_hi:[1,0,0]
    v_pk_fma_f32 v[198:199], v[198:199], v[62:63], v[250:251] op_sel_hi:[1,1,0] neg_lo:[1,0,0] neg_hi:[1,0,0]
    v_pk_fma_f32 v[216:217], v[184:185], v[62:63], v[240:241] op_sel_hi:[1,1,0] neg_lo:[0,0,1] neg_hi:[0,0,1]
    v_pk_fma_f32 v[232:233], v[200:201], v[62:63], v[248:249] op_sel_hi:[1,1,0] neg_lo:[0,0,1] neg_hi:[0,0,1]
    v_pk_fma_f32 v[184:185], v[184:185], v[62:63], v[242:243] op_sel_hi:[1,1,0] neg_lo:[1,0,0] neg_hi:[1,0,0]
    v_pk_fma_f32 v[200:201], v[200:201], v[62:63], v[250:251] op_sel_hi:[1,1,0] neg_lo:[1,0,0] neg_hi:[1,0,0]
    v_pk_fma_f32 v[218:219], v[186:187], v[62:63], v[240:241] op_sel_hi:[1,1,0] neg_lo:[0,0,1] neg_hi:[0,0,1]
    v_pk_fma_f32 v[234:235], v[202:203], v[62:63], v[248:249] op_sel_hi:[1,1,0] neg_lo:[0,0,1] neg_hi:[0,0,1]
    v_pk_fma_f32 v[186:187], v[186:187], v[62:63], v[242:243] op_sel_hi:[1,1,0] neg_lo:[1,0,0] neg_hi:[1,0,0]
    v_pk_fma_f32 v[202:203], v[202:203], v[62:63], v[250:251] op_sel_hi:[1,1,0] neg_lo:[1,0,0] neg_hi:[1,0,0]
    v_pk_fma_f32 v[220:221], v[188:189], v[62:63], v[240:241] op_sel_hi:[1,1,0] neg_lo:[0,0,1] neg_hi:[0,0,1]
    v_pk_fma_f32 v[236:237], v[204:205], v[62:63], v[248:249] op_sel_hi:[1,1,0] neg_lo:[0,0,1] neg_hi:[0,0,1]
    v_pk_fma_f32 v[188:189], v[188:189], v[62:63], v[242:243] op_sel_hi:[1,1,0] neg_lo:[1,0,0] neg_hi:[1,0,0]
    v_pk_fma_f32 v[204:205], v[204:205], v[62:63], v[250:251] op_sel_hi:[1,1,0] neg_lo:[1,0,0] neg_hi:[1,0,0]
    v_pk_fma_f32 v[222:223], v[190:191], v[62:63], v[240:241] op_sel_hi:[1,1,0] neg_lo:[0,0,1] neg_hi:[0,0,1]
    v_pk_fma_f32 v[238:239], v[206:207], v[62:63], v[248:249] op_sel_hi:[1,1,0] neg_lo:[0,0,1] neg_hi:[0,0,1]
    v_pk_fma_f32 v[190:191], v[190:191], v[62:63], v[242:243] op_sel_hi:[1,1,0] neg_lo:[1,0,0] neg_hi:[1,0,0]
    v_pk_fma_f32 v[206:207], v[206:207], v[62:63], v[250:251] op_sel_hi:[1,1,0] neg_lo:[1,0,0] neg_hi:[1,0,0]
    v_exp_f32 v208, v208
    v_exp_f32 v224, v224
    v_exp_f32 v176, v176
    v_exp_f32 v192, v192
    v_exp_f32 v209, v209
    v_exp_f32 v225, v225
    v_exp_f32 v177, v177
    v_exp_f32 v193, v193
    v_exp_f32 v210, v210
    v_exp_f32 v226, v226
    v_exp_f32 v178, v178
    v_exp_f32 v194, v194
    v_exp_f32 v211, v211
    v_exp_f32 v227, v227
    v_exp_f32 v179, v179
    v_exp_f32 v195, v195
    v_exp_f32 v212, v212
    v_exp_f32 v228, v228
    v_exp_f32 v180, v180
    v_exp_f32 v196, v196
    v_exp_f32 v213, v213
    v_exp_f32 v229, v229
    v_exp_f32 v181, v181
    v_exp_f32 v197, v197
    v_exp_f32 v214, v214
    v_exp_f32 v230, v230
    v_exp_f32 v182, v182
    v_exp_f32 v198, v198
    v_exp_f32 v215, v215
    v_exp_f32 v231, v231
    v_exp_f32 v183, v183
    v_exp_f32 v199, v199
    v_exp_f32 v216, v216
    v_exp_f32 v232, v232
    v_exp_f32 v184, v184
    v_exp_f32 v200, v200
    v_exp_f32 v217, v217
    v_exp_f32 v233, v233
    v_exp_f32 v185, v185
    v_exp_f32 v201, v201
    v_exp_f32 v218, v218
    v_exp_f32 v234, v234
    v_exp_f32 v186, v186
    v_exp_f32 v202, v202
    v_exp_f32 v219, v219
    v_exp_f32 v235, v235
    v_exp_f32 v187, v187
    v_exp_f32 v203, v203
    v_exp_f32 v220, v220
    v_exp_f32 v236, v236
    v_exp_f32 v188, v188
    v_exp_f32 v204, v204
    v_exp_f32 v221, v221
    v_exp_f32 v237, v237
    v_exp_f32 v189, v189
    v_exp_f32 v205, v205
    v_exp_f32 v222, v222
    v_exp_f32 v238, v238
    v_exp_f32 v190, v190
    v_exp_f32 v206, v206
    v_exp_f32 v223, v223
    v_exp_f32 v239, v239
    v_exp_f32 v191, v191
    v_exp_f32 v207, v207
    v_pk_add_f32 v[240:241], v[208:209], v[210:211]
    v_pk_add_f32 v[248:249], v[224:225], v[226:227]
    v_pk_add_f32 v[242:243], v[176:177], v[178:179]
    v_pk_add_f32 v[250:251], v[192:193], v[194:195]
    v_pk_add_f32 v[240:241], v[240:241], v[212:213]
    v_pk_add_f32 v[248:249], v[248:249], v[228:229]
    v_pk_add_f32 v[242:243], v[242:243], v[180:181]
    v_pk_add_f32 v[250:251], v[250:251], v[196:197]
    v_pk_add_f32 v[240:241], v[240:241], v[214:215]
    v_pk_add_f32 v[248:249], v[248:249], v[230:231]
    v_pk_add_f32 v[242:243], v[242:243], v[182:183]
    v_pk_add_f32 v[250:251], v[250:251], v[198:199]
    v_pk_add_f32 v[240:241], v[240:241], v[216:217]
    v_pk_add_f32 v[248:249], v[248:249], v[232:233]
    v_pk_add_f32 v[242:243], v[242:243], v[184:185]
    v_pk_add_f32 v[250:251], v[250:251], v[200:201]
    v_pk_add_f32 v[240:241], v[240:241], v[218:219]
    v_pk_add_f32 v[248:249], v[248:249], v[234:235]
    v_pk_add_f32 v[242:243], v[242:243], v[186:187]
    v_pk_add_f32 v[250:251], v[250:251], v[202:203]
    v_pk_add_f32 v[240:241], v[240:241], v[220:221]
    v_pk_add_f32 v[248:249], v[248:249], v[236:237]
    v_pk_add_f32 v[242:243], v[242:243], v[188:189]
    v_pk_add_f32 v[250:251], v[250:251], v[204:205]
    v_pk_add_f32 v[240:241], v[240:241], v[222:223]
    v_pk_add_f32 v[248:249], v[248:249], v[238:239]
    v_pk_add_f32 v[242:243], v[242:243], v[190:191]
    v_pk_add_f32 v[250:251], v[250:251], v[206:207]
    v_add_f32 v240, v240, v241
    v_add_f32 v248, v248, v249
    v_add_f32 v242, v242, v243
    v_add_f32 v250, v250, v251
    v_mov_b32 v244, v240
    v_mov_b32 v252, v248
    v_mov_b32 v246, v242
    v_mov_b32 v254, v250
    v_permlane32_swap_b32 v244, v240
    v_permlane32_swap_b32 v252, v248
    v_permlane32_swap_b32 v246, v242
    v_permlane32_swap_b32 v254, v250
    v_add_f32 v240, v240, v244
    v_add_f32 v248, v248, v252
    v_add_f32 v242, v242, v246
    v_add_f32 v250, v250, v254
    v_rcp_f32 v240, v240
    v_rcp_f32 v248, v248
    v_rcp_f32 v242, v242
    v_rcp_f32 v250, v250
    v_pk_mul_f32 v[208:209], v[208:209], v[240:241] op_sel_hi:[1,0]
    v_pk_mul_f32 v[224:225], v[224:225], v[248:249] op_sel_hi:[1,0]
    v_pk_mul_f32 v[176:177], v[176:177], v[242:243] op_sel_hi:[1,0]
    v_pk_mul_f32 v[192:193], v[192:193], v[250:251] op_sel_hi:[1,0]
    v_pk_mul_f32 v[210:211], v[210:211], v[240:241] op_sel_hi:[1,0]
    v_pk_mul_f32 v[226:227], v[226:227], v[248:249] op_sel_hi:[1,0]
    v_pk_mul_f32 v[178:179], v[178:179], v[242:243] op_sel_hi:[1,0]
    v_pk_mul_f32 v[194:195], v[194:195], v[250:251] op_sel_hi:[1,0]
    v_pk_mul_f32 v[212:213], v[212:213], v[240:241] op_sel_hi:[1,0]
    v_pk_mul_f32 v[228:229], v[228:229], v[248:249] op_sel_hi:[1,0]
    v_pk_mul_f32 v[180:181], v[180:181], v[242:243] op_sel_hi:[1,0]
    v_pk_mul_f32 v[196:197], v[196:197], v[250:251] op_sel_hi:[1,0]
    s_waitcnt vmcnt(0)
    buffer_atomic_add v61, v56, s[44:47], 0 offen sc1
    v_pk_mul_f32 v[214:215], v[214:215], v[240:241] op_sel_hi:[1,0]
    v_pk_mul_f32 v[230:231], v[230:231], v[248:249] op_sel_hi:[1,0]
    v_pk_mul_f32 v[182:183], v[182:183], v[242:243] op_sel_hi:[1,0]
    v_pk_mul_f32 v[198:199], v[198:199], v[250:251] op_sel_hi:[1,0]
    v_pk_mul_f32 v[216:217], v[216:217], v[240:241] op_sel_hi:[1,0]
    v_pk_mul_f32 v[232:233], v[232:233], v[248:249] op_sel_hi:[1,0]
    v_pk_mul_f32 v[184:185], v[184:185], v[242:243] op_sel_hi:[1,0]
    v_pk_mul_f32 v[200:201], v[200:201], v[250:251] op_sel_hi:[1,0]
    v_pk_mul_f32 v[218:219], v[218:219], v[240:241] op_sel_hi:[1,0]
    v_pk_mul_f32 v[234:235], v[234:235], v[248:249] op_sel_hi:[1,0]
    v_pk_mul_f32 v[186:187], v[186:187], v[242:243] op_sel_hi:[1,0]
    v_pk_mul_f32 v[202:203], v[202:203], v[250:251] op_sel_hi:[1,0]
    v_pk_mul_f32 v[220:221], v[220:221], v[240:241] op_sel_hi:[1,0]
    v_pk_mul_f32 v[236:237], v[236:237], v[248:249] op_sel_hi:[1,0]
    v_pk_mul_f32 v[188:189], v[188:189], v[242:243] op_sel_hi:[1,0]
    v_pk_mul_f32 v[204:205], v[204:205], v[250:251] op_sel_hi:[1,0]
    v_pk_mul_f32 v[222:223], v[222:223], v[240:241] op_sel_hi:[1,0]
    v_pk_mul_f32 v[238:239], v[238:239], v[248:249] op_sel_hi:[1,0]
    v_pk_mul_f32 v[190:191], v[190:191], v[242:243] op_sel_hi:[1,0]
    v_pk_mul_f32 v[206:207], v[206:207], v[250:251] op_sel_hi:[1,0]
    v_cvt_pk_bf16_f32 v64, v208, v209
    v_cvt_pk_bf16_f32 v72, v176, v177
    v_cvt_pk_bf16_f32 v65, v210, v211
    v_cvt_pk_bf16_f32 v73, v178, v179
    v_cvt_pk_bf16_f32 v66, v212, v213
    v_cvt_pk_bf16_f32 v74, v180, v181
    v_cvt_pk_bf16_f32 v67, v214, v215
    v_cvt_pk_bf16_f32 v75, v182, v183
    v_cvt_pk_bf16_f32 v68, v216, v217
    v_cvt_pk_bf16_f32 v76, v184, v185
    v_cvt_pk_bf16_f32 v69, v218, v219
    v_cvt_pk_bf16_f32 v77, v186, v187
    v_cvt_pk_bf16_f32 v70, v220, v221
    v_cvt_pk_bf16_f32 v78, v188, v189
    v_cvt_pk_bf16_f32 v71, v222, v223
    v_cvt_pk_bf16_f32 v79, v190, v191
    v_cvt_pk_bf16_f32 v80, v224, v225
    v_cvt_pk_bf16_f32 v88, v192, v193
    v_cvt_pk_bf16_f32 v81, v226, v227
    v_mov_b32 v42, 0
    buffer_atomic_add v42, v56, s[44:47], 0 offen sc0 sc1
    v_cvt_pk_bf16_f32 v89, v194, v195
    v_cvt_pk_bf16_f32 v82, v228, v229
    v_cvt_pk_bf16_f32 v90, v196, v197
    v_cvt_pk_bf16_f32 v83, v230, v231
    v_cvt_pk_bf16_f32 v91, v198, v199
    v_cvt_pk_bf16_f32 v84, v232, v233
    v_cvt_pk_bf16_f32 v92, v200, v201
    v_cvt_pk_bf16_f32 v85, v234, v235
    v_cvt_pk_bf16_f32 v93, v202, v203
    v_cvt_pk_bf16_f32 v86, v236, v237
    v_cvt_pk_bf16_f32 v94, v204, v205
    v_cvt_pk_bf16_f32 v87, v238, v239
    v_cvt_pk_bf16_f32 v95, v206, v207
    ds_write_b32 v60, v61 offset:32
    s_lshl_b32 s77, s68, 18
    s_lshl_b32 s72, s70, 12
    s_add_u32 s77, s77, s72
    s_add_u32 s77, s77, 8388608
    s_lshl_b32 s72, s68, 10
    s_add_u32 s72, s72, 16793600
    v_lshl_add_u32 v54, v1, 8, s72
    v_bfe_u32 v50, v1, 2, 2
    v_lshrrev_b32 v51, 5, v1
    v_lshl_add_u32 v50, v51, 2, v50
    v_lshlrev_b32 v50, 7, v50
    v_bfe_u32 v52, v1, 3, 1
    v_lshl_add_u32 v50, v52, 6, v50
    v_bfe_u32 v52, v1, 4, 1
    v_lshl_add_u32 v50, v52, 5, v50
    v_and_b32 v52, 3, v1
    v_lshl_add_u32 v2, v52, 3, v50
    v_xor_b32 v3, 64, v2
    v_add_u32 v4, 0x10000, v2
    v_add_u32 v5, 0x10000, v3
    v_add_u32 v6, 122880, v2
    v_add_u32 v7, 122880, v3
    v_and_b32 v53, 7, v1
    v_lshlrev_b32 v53, 2, v53
    v_add_u32 v53, 163584, v53
    v_mov_b32 v49, 163584
    s_mul_i32 s75, s67, 139264
    s_mul_i32 s72, s70, 2176
    s_add_u32 s75, s75, s72
    s_add_u32 s75, s75, 12582912
    s_waitcnt vmcnt(0)
    v_readfirstlane_b32 s72, v42
    s_nop 1
    s_cmp_ge_u32 s72, 16
    s_cbranch_scc1 Learly_3
    s_mov_b64 exec, 1
    s_mov_b32 s88, 0
Lpoll_4:
    v_mov_b32 v42, 0
    buffer_atomic_add v42, v56, s[44:47], 0 offen sc0 sc1
    s_add_u32 s88, s88, 1
    s_waitcnt vmcnt(0)
    v_cmp_gt_u32 vcc, 16, v42
    s_cmp_ge_u32 s88, 262144
    s_cbranch_scc1 Lpdone_5
    s_cbranch_vccz Lpdone_5
    s_sleep 2
    s_branch Lpoll_4
Lpdone_5:
    s_mov_b64 exec, -1
Learly_3:
    s_mov_b32 s97, 0
Lgather_6:
    v_mov_b32 v244, 0
    s_add_u32 s72, s66, 0
    s_and_b32 s72, s72, 15
    s_mul_i32 s72, s72, 8704
    s_add_u32 s72, s72, s75
    buffer_load_dwordx4 v[96:99], v40, s[44:47], s72 offen sc1
    buffer_load_dwordx4 v[100:103], v40, s[44:47], s72 offen offset:1024 sc1
    buffer_load_dword v224, v43, s[44:47], s72 offen offset:2048 sc1
    s_add_u32 s72, s66, 1
    s_and_b32 s72, s72, 15
    s_mul_i32 s72, s72, 8704
    s_add_u32 s72, s72, s75
    buffer_load_dwordx4 v[104:107], v40, s[44:47], s72 offen sc1
    buffer_load_dwordx4 v[108:111], v40, s[44:47], s72 offen offset:1024 sc1
    buffer_load_dword v225, v43, s[44:47], s72 offen offset:2048 sc1
    s_add_u32 s72, s66, 2
    s_and_b32 s72, s72, 15
    s_mul_i32 s72, s72, 8704
    s_add_u32 s72, s72, s75
    buffer_load_dwordx4 v[112:115], v40, s[44:47], s72 offen sc1
    buffer_load_dwordx4 v[116:119], v40, s[44:47], s72 offen offset:1024 sc1
    buffer_load_dword v226, v43, s[44:47], s72 offen offset:2048 sc1
    s_add_u32 s72, s66, 3
    s_and_b32 s72, s72, 15
    s_mul_i32 s72, s72, 8704
    s_add_u32 s72, s72, s75
    buffer_load_dwordx4 v[120:123], v40, s[44:47], s72 offen sc1
    buffer_load_dwordx4 v[124:127], v40, s[44:47], s72 offen offset:1024 sc1
    buffer_load_dword v227, v43, s[44:47], s72 offen offset:2048 sc1
    s_add_u32 s72, s66, 4
    s_and_b32 s72, s72, 15
    s_mul_i32 s72, s72, 8704
    s_add_u32 s72, s72, s75
    buffer_load_dwordx4 v[128:131], v40, s[44:47], s72 offen sc1
    buffer_load_dwordx4 v[132:135], v40, s[44:47], s72 offen offset:1024 sc1
    buffer_load_dword v228, v43, s[44:47], s72 offen offset:2048 sc1
    s_waitcnt vmcnt(12)
    v_mfma_f32_32x32x16_bf16 v[12:27], v[28:31], v[96:99], 0
    v_mfma_f32_32x32x16_bf16 v[12:27], v[32:35], v[100:103], v[12:27]
    v_add_f32 v244, v244, v224
    s_add_u32 s72, s66, 5
    s_and_b32 s72, s72, 15
    s_mul_i32 s72, s72, 8704
    s_add_u32 s72, s72, s75
    buffer_load_dwordx4 v[136:139], v40, s[44:47], s72 offen sc1
    buffer_load_dwordx4 v[140:143], v40, s[44:47], s72 offen offset:1024 sc1
    buffer_load_dword v229, v43, s[44:47], s72 offen offset:2048 sc1
    s_waitcnt vmcnt(12)
    v_mfma_f32_32x32x16_bf16 v[12:27], v[28:31], v[104:107], v[12:27]
    v_mfma_f32_32x32x16_bf16 v[12:27], v[32:35], v[108:111], v[12:27]
    v_add_f32 v244, v244, v225
    s_add_u32 s72, s66, 6
    s_and_b32 s72, s72, 15
    s_mul_i32 s72, s72, 8704
    s_add_u32 s72, s72, s75
    buffer_load_dwordx4 v[144:147], v40, s[44:47], s72 offen sc1
    buffer_load_dwordx4 v[148:151], v40, s[44:47], s72 offen offset:1024 sc1
    buffer_load_dword v230, v43, s[44:47], s72 offen offset:2048 sc1
    s_waitcnt vmcnt(12)
    v_mfma_f32_32x32x16_bf16 v[12:27], v[28:31], v[112:115], v[12:27]
    v_mfma_f32_32x32x16_bf16 v[12:27], v[32:35], v[116:119], v[12:27]
    v_add_f32 v244, v244, v226
    s_add_u32 s72, s66, 7
    s_and_b32 s72, s72, 15
    s_mul_i32 s72, s72, 8704
    s_add_u32 s72, s72, s75
    buffer_load_dwordx4 v[152:155], v40, s[44:47], s72 offen sc1
    buffer_load_dwordx4 v[156:159], v40, s[44:47], s72 offen offset:1024 sc1
    buffer_load_dword v231, v43, s[44:47], s72 offen offset:2048 sc1
    s_waitcnt vmcnt(12)
    v_mfma_f32_32x32x16_bf16 v[12:27], v[28:31], v[120:123], v[12:27]
    v_mfma_f32_32x32x16_bf16 v[12:27], v[32:35], v[124:127], v[12:27]
    v_add_f32 v244, v244, v227
    s_add_u32 s72, s66, 8
    s_and_b32 s72, s72, 15
    s_mul_i32 s72, s72, 8704
    s_add_u32 s72, s72, s75
    buffer_load_dwordx4 v[160:163], v40, s[44:47], s72 offen sc1
    buffer_load_dwordx4 v[164:167], v40, s[44:47], s72 offen offset:1024 sc1
    buffer_load_dword v232, v43, s[44:47], s72 offen offset:2048 sc1
    s_waitcnt vmcnt(12)
    v_mfma_f32_32x32x16_bf16 v[12:27], v[28:31], v[128:131], v[12:27]
    v_mfma_f32_32x32x16_bf16 v[12:27], v[32:35], v[132:135], v[12:27]
    v_add_f32 v244, v244, v228
    s_add_u32 s72, s66, 9
    s_and_b32 s72, s72, 15
    s_mul_i32 s72, s72, 8704
    s_add_u32 s72, s72, s75
    buffer_load_dwordx4 v[168:171], v40, s[44:47], s72 offen sc1
    buffer_load_dwordx4 v[172:175], v40, s[44:47], s72 offen offset:1024 sc1
    buffer_load_dword v233, v43, s[44:47], s72 offen offset:2048 sc1
    s_waitcnt vmcnt(12)
    v_mfma_f32_32x32x16_bf16 v[12:27], v[28:31], v[136:139], v[12:27]
    v_mfma_f32_32x32x16_bf16 v[12:27], v[32:35], v[140:143], v[12:27]
    v_add_f32 v244, v244, v229
    s_add_u32 s72, s66, 10
    s_and_b32 s72, s72, 15
    s_mul_i32 s72, s72, 8704
    s_add_u32 s72, s72, s75
    buffer_load_dwordx4 v[176:179], v40, s[44:47], s72 offen sc1
    buffer_load_dwordx4 v[180:183], v40, s[44:47], s72 offen offset:1024 sc1
    buffer_load_dword v234, v43, s[44:47], s72 offen offset:2048 sc1
    s_waitcnt vmcnt(12)
    v_mfma_f32_32x32x16_bf16 v[12:27], v[28:31], v[144:147], v[12:27]
    v_mfma_f32_32x32x16_bf16 v[12:27], v[32:35], v[148:151], v[12:27]
    v_add_f32 v244, v244, v230
    s_add_u32 s72, s66, 11
    s_and_b32 s72, s72, 15
    s_mul_i32 s72, s72, 8704
    s_add_u32 s72, s72, s75
    buffer_load_dwordx4 v[184:187], v40, s[44:47], s72 offen sc1
    buffer_load_dwordx4 v[188:191], v40, s[44:47], s72 offen offset:1024 sc1
    buffer_load_dword v235, v43, s[44:47], s72 offen offset:2048 sc1
    s_waitcnt vmcnt(12)
    v_mfma_f32_32x32x16_bf16 v[12:27], v[28:31], v[152:155], v[12:27]
    v_mfma_f32_32x32x16_bf16 v[12:27], v[32:35], v[156:159], v[12:27]
    v_add_f32 v244, v244, v231
    s_add_u32 s72, s66, 12
    s_and_b32 s72, s72, 15
    s_mul_i32 s72, s72, 8704
    s_add_u32 s72, s72, s75
    buffer_load_dwordx4 v[192:195], v40, s[44:47], s72 offen sc1
    buffer_load_dwordx4 v[196:199], v40, s[44:47], s72 offen offset:1024 sc1
    buffer_load_dword v236, v43, s[44:47], s72 offen offset:2048 sc1
    s_waitcnt vmcnt(12)
    v_mfma_f32_32x32x16_bf16 v[12:27], v[28:31], v[160:163], v[12:27]
    v_mfma_f32_32x32x16_bf16 v[12:27], v[32:35], v[164:167], v[12:27]
    v_add_f32 v244, v244, v232
    s_add_u32 s72, s66, 13
    s_and_b32 s72, s72, 15
    s_mul_i32 s72, s72, 8704
    s_add_u32 s72, s72, s75
    buffer_load_dwordx4 v[200:203], v40, s[44:47], s72 offen sc1
    buffer_load_dwordx4 v[204:207], v40, s[44:47], s72 offen offset:1024 sc1
    buffer_load_dword v237, v43, s[44:47], s72 offen offset:2048 sc1
    s_waitcnt vmcnt(12)
    v_mfma_f32_32x32x16_bf16 v[12:27], v[28:31], v[168:171], v[12:27]
    v_mfma_f32_32x32x16_bf16 v[12:27], v[32:35], v[172:175], v[12:27]
    v_add_f32 v244, v244, v233
    s_add_u32 s72, s66, 14
    s_and_b32 s72, s72, 15
    s_mul_i32 s72, s72, 8704
    s_add_u32 s72, s72, s75
    buffer_load_dwordx4 v[208:211], v40, s[44:47], s72 offen sc1
    buffer_load_dwordx4 v[212:215], v40, s[44:47], s72 offen offset:1024 sc1
    buffer_load_dword v238, v43, s[44:47], s72 offen offset:2048 sc1
    s_waitcnt vmcnt(12)
    v_mfma_f32_32x32x16_bf16 v[12:27], v[28:31], v[176:179], v[12:27]
    v_mfma_f32_32x32x16_bf16 v[12:27], v[32:35], v[180:183], v[12:27]
    v_add_f32 v244, v244, v234
    s_add_u32 s72, s66, 15
    s_and_b32 s72, s72, 15
    s_mul_i32 s72, s72, 8704
    s_add_u32 s72, s72, s75
    buffer_load_dwordx4 v[216:219], v40, s[44:47], s72 offen sc1
    buffer_load_dwordx4 v[220:223], v40, s[44:47], s72 offen offset:1024 sc1
    buffer_load_dword v239, v43, s[44:47], s72 offen offset:2048 sc1
    s_waitcnt vmcnt(12)
    v_mfma_f32_32x32x16_bf16 v[12:27], v[28:31], v[184:187], v[12:27]
    v_mfma_f32_32x32x16_bf16 v[12:27], v[32:35], v[188:191], v[12:27]
    v_add_f32 v244, v244, v235
    s_waitcnt vmcnt(9)
    v_mfma_f32_32x32x16_bf16 v[12:27], v[28:31], v[192:195], v[12:27]
    v_mfma_f32_32x32x16_bf16 v[12:27], v[32:35], v[196:199], v[12:27]
    v_add_f32 v244, v244, v236
    s_waitcnt vmcnt(6)
    v_mfma_f32_32x32x16_bf16 v[12:27], v[28:31], v[200:203], v[12:27]
    v_mfma_f32_32x32x16_bf16 v[12:27], v[32:35], v[204:207], v[12:27]
    v_add_f32 v244, v244, v237
    s_waitcnt vmcnt(3)
    v_mfma_f32_32x32x16_bf16 v[12:27], v[28:31], v[208:211], v[12:27]
    v_mfma_f32_32x32x16_bf16 v[12:27], v[32:35], v[212:215], v[12:27]
    v_add_f32 v244, v244, v238
    s_waitcnt vmcnt(0)
    v_mfma_f32_32x32x16_bf16 v[12:27], v[28:31], v[216:219], v[12:27]
    v_mfma_f32_32x32x16_bf16 v[12:27], v[32:35], v[220:223], v[12:27]
    v_add_f32 v244, v244, v239
    s_lshl_b32 s72, s70, 11
    s_add_u32 s72, s72, 152576
    v_add_u32 v46, s72, v40
    v_and_b32 v47, 0x13, v1
    v_bfe_u32 v48, v1, 2, 1
    v_lshl_or_b32 v47, v48, 3, v47
    v_bfe_u32 v48, v1, 3, 1
    v_lshl_or_b32 v47, v48, 2, v47
    s_lshl_b32 s72, s70, 6
    s_add_u32 s72, s72, 160768
    v_lshl_add_u32 v47, v47, 1, s72
    v_cvt_pk_bf16_f32 v96, v12, v13
    v_cvt_pk_bf16_f32 v97, v14, v15
    v_cvt_pk_bf16_f32 v98, v16, v17
    v_cvt_pk_bf16_f32 v99, v18, v19
    v_cvt_pk_bf16_f32 v100, v20, v21
    v_cvt_pk_bf16_f32 v101, v22, v23
    v_cvt_pk_bf16_f32 v102, v24, v25
    v_cvt_pk_bf16_f32 v103, v26, v27
    v_cvt_pk_bf16_f32 v104, v244, v244
    ds_write_b128 v46, v[96:99]
    ds_write_b128 v46, v[100:103] offset:1024
    s_mov_b32 exec_hi, 0
    ds_write_b16 v47, v104
    s_mov_b64 exec, -1
    ds_write_b32 v60, v61 offset:16
    s_mov_b32 s88, 0
Lpair_9:
    ds_read_b32 v58, v59 offset:16
    s_add_u32 s88, s88, 1
    s_cmp_ge_u32 s88, 2097152
    s_waitcnt lgkmcnt(0)
    v_cmp_eq_u32 vcc, 0, v58
    s_cbranch_scc1 Lpaird_10
    s_nop 0
    s_cbranch_vccnz Lpair_9
Lpaird_10:
    s_lshr_b32 s72, s70, 1
    s_lshl_b32 s73, s72, 12
    s_add_u32 s73, s73, 152576
    v_lshl_add_u32 v40, v1, 4, s73
    s_lshl_b32 s73, s72, 7
    s_add_u32 s73, s73, 160768
    v_lshrrev_b32 v41, 5, v1
    v_lshl_add_u32 v41, v41, 4, s73
    ds_read_b128 v[200:203], v40 offset:0
    ds_read_b128 v[204:207], v40 offset:1024
    ds_read_b128 v[208:211], v40 offset:2048
    ds_read_b128 v[212:215], v40 offset:3072
    ds_read_b128 v[216:219], v41 offset:0
    ds_read_b128 v[220:223], v41 offset:32
    ds_read_b128 v[224:227], v41 offset:64
    ds_read_b128 v[228:231], v41 offset:96
    v_lshlrev_b32 v40, 4, v1
    s_waitcnt lgkmcnt(0)
    v_mfma_f32_32x32x16_bf16 v[96:111], v[216:219], v[64:67], 0
    v_mfma_f32_32x32x16_bf16 v[96:111], v[220:223], v[68:71], v[96:111]
    v_mfma_f32_32x32x16_bf16 v[96:111], v[224:227], v[72:75], v[96:111]
    v_mfma_f32_32x32x16_bf16 v[96:111], v[228:231], v[76:79], v[96:111]
    v_mfma_f32_32x32x16_bf16 v[160:175], v[200:203], v[64:67], 0
    v_mfma_f32_32x32x16_bf16 v[160:175], v[204:207], v[68:71], v[160:175]
    v_mfma_f32_32x32x16_bf16 v[160:175], v[208:211], v[72:75], v[160:175]
    v_mfma_f32_32x32x16_bf16 v[160:175], v[212:215], v[76:79], v[160:175]
    v_mfma_f32_32x32x16_bf16 v[112:127], v[216:219], v[80:83], 0
    v_mfma_f32_32x32x16_bf16 v[112:127], v[220:223], v[84:87], v[112:127]
    v_mfma_f32_32x32x16_bf16 v[112:127], v[224:227], v[88:91], v[112:127]
    v_mfma_f32_32x32x16_bf16 v[112:127], v[228:231], v[92:95], v[112:127]
    v_mfma_f32_32x32x16_bf16 v[176:191], v[200:203], v[80:83], 0
    v_mfma_f32_32x32x16_bf16 v[176:191], v[204:207], v[84:87], v[176:191]
    v_mfma_f32_32x32x16_bf16 v[176:191], v[208:211], v[88:91], v[176:191]
    v_mfma_f32_32x32x16_bf16 v[176:191], v[212:215], v[92:95], v[176:191]
    v_add_f32 v232, 0x358637bd, v96
    v_rcp_f32 v232, v232
    s_nop 1
    v_mul_f32 v160, v232, v160
    v_mul_f32 v161, v232, v161
    v_mul_f32 v162, v232, v162
    v_mul_f32 v163, v232, v163
    v_mul_f32 v164, v232, v164
    v_mul_f32 v165, v232, v165
    v_mul_f32 v166, v232, v166
    v_mul_f32 v167, v232, v167
    v_mul_f32 v168, v232, v168
    v_mul_f32 v169, v232, v169
    v_mul_f32 v170, v232, v170
    v_mul_f32 v171, v232, v171
    v_mul_f32 v172, v232, v172
    v_mul_f32 v173, v232, v173
    v_mul_f32 v174, v232, v174
    v_mul_f32 v175, v232, v175
    v_cvt_pk_bf16_f32 v200, v160, v161
    v_cvt_pk_bf16_f32 v201, v162, v163
    v_cvt_pk_bf16_f32 v202, v164, v165
    v_cvt_pk_bf16_f32 v203, v166, v167
    v_cvt_pk_bf16_f32 v204, v168, v169
    v_cvt_pk_bf16_f32 v205, v170, v171
    v_cvt_pk_bf16_f32 v206, v172, v173
    v_cvt_pk_bf16_f32 v207, v174, v175
    buffer_store_dwordx4 v[200:203], v40, s[44:47], s96 offen offset:0 sc1
    buffer_store_dwordx4 v[204:207], v40, s[44:47], s96 offen offset:1024 sc1
    v_add_f32 v233, 0x358637bd, v112
    v_rcp_f32 v233, v233
    s_nop 0
    v_mul_f32 v176, v233, v176
    v_mul_f32 v177, v233, v177
    v_mul_f32 v178, v233, v178
    v_mul_f32 v179, v233, v179
    v_mul_f32 v180, v233, v180
    v_mul_f32 v181, v233, v181
    v_mul_f32 v182, v233, v182
    v_mul_f32 v183, v233, v183
    v_mul_f32 v184, v233, v184
    v_mul_f32 v185, v233, v185
    v_mul_f32 v186, v233, v186
    v_mul_f32 v187, v233, v187
    v_mul_f32 v188, v233, v188
    v_mul_f32 v189, v233, v189
    v_mul_f32 v190, v233, v190
    v_mul_f32 v191, v233, v191
    v_cvt_pk_bf16_f32 v208, v176, v177
    v_cvt_pk_bf16_f32 v209, v178, v179
    v_cvt_pk_bf16_f32 v210, v180, v181
    v_cvt_pk_bf16_f32 v211, v182, v183
    v_cvt_pk_bf16_f32 v212, v184, v185
    v_cvt_pk_bf16_f32 v213, v186, v187
    v_cvt_pk_bf16_f32 v214, v188, v189
    v_cvt_pk_bf16_f32 v215, v190, v191
    buffer_store_dwordx4 v[208:211], v40, s[44:47], s99 offen offset:0 sc1
    buffer_store_dwordx4 v[212:215], v40, s[44:47], s99 offen offset:1024 sc1
    s_mov_b32 s3, 0
    s_cmp_eq_u32 s70, 0
    s_cbranch_scc0 Lnoask_11
    s_bitcmp1_b32 s3, 0
    s_cbranch_scc1 Lnoask_11
    s_mov_b64 exec, 15
    v_mov_b32 v42, 0
    buffer_atomic_add v42, v54, s[44:47], 0 offen sc0 sc1
    s_mov_b64 exec, -1
Lnoask_11:
    s_lshl_b32 s72, s70, 12
    v_and_b32 v14, 31, v1
    v_lshl_add_u32 v14, v14, 7, s72
    v_and_b32 v15, 7, v1
    v_xor_b32 v16, v15, v51
    v_lshl_add_u32 v8, v16, 4, v14
    v_xor_b32 v9, 32, v8
    v_xor_b32 v10, 64, v8
    v_xor_b32 v11, 96, v8
    v_lshrrev_b32 v14, 3, v1
    v_xor_b32 v16, v15, v14
    v_lshlrev_b32 v16, 4, v16
    v_lshl_add_u32 v16, v14, 7, v16
    v_add_u32 v12, s72, v16
    s_lshl_b32 s72, s68, 7
    s_lshl_b32 s73, s70, 5
    s_add_u32 s72, s72, s73
    v_add_u32 v13, s72, v14
    v_lshlrev_b32 v13, 12, v13
    v_lshl_add_u32 v13, v15, 4, v13
    s_lshl_b32 s72, s69, 7
    v_add_u32 v13, s72, v13
    s_waitcnt vmcnt(0)
    buffer_atomic_add v61, v57, s[44:47], 0 offen sc1
    s_bitcmp1_b32 s3, 0
    s_cbranch_scc1 Lknown_12
    s_cmp_eq_u32 s70, 0
    s_cbranch_scc0 Lwatch_13
    s_waitcnt vmcnt(1)
    s_mov_b64 exec, 15
    v_cmp_le_u32 vcc, 16, v42
    s_mov_b64 exec, -1
    s_nop 0
    s_or_b32 s3, vcc_lo, 16
    s_bitcmp1_b32 s3, 0
    s_cbranch_scc1 Ltell_14
    s_mov_b32 s88, 0
Lspin_15:
    s_mov_b64 exec, 15
    v_mov_b32 v42, 0
    buffer_atomic_add v42, v54, s[44:47], 0 offen sc0 sc1
    s_mov_b64 exec, -1
    s_add_u32 s88, s88, 1
    s_waitcnt vmcnt(0)
    s_mov_b64 exec, 15
    v_cmp_le_u32 vcc, 16, v42
    s_mov_b64 exec, -1
    s_nop 0
    s_or_b32 s3, vcc_lo, 16
    s_cmp_ge_u32 s88, 262144
    s_cbranch_scc1 Lspun_16
    s_bitcmp1_b32 s3, 0
    s_cbranch_scc1 Lspun_16
    s_sleep 2
    s_branch Lspin_15
Lspun_16:
Ltell_14:
    v_mov_b32 v42, s3
    ds_write_b32 v49, v42 offset:192
    s_waitcnt lgkmcnt(0)
    s_branch Lknown_12
Lwatch_13:
    s_mov_b32 s88, 0
Lwatchl_17:
    ds_read_b32 v58, v49 offset:192
    s_add_u32 s88, s88, 1
    s_cmp_ge_u32 s88, 2097152
    s_waitcnt lgkmcnt(0)
    v_readfirstlane_b32 s3, v58
    s_cbranch_scc1 Lknown_12
    s_nop 0
    s_bitcmp1_b32 s3, 0
    s_cbranch_scc0 Lwatchl_17
Lknown_12:
    s_add_u32 s72, s69, 0
    s_and_b32 s72, s72, 3
    s_add_u32 s72, s72, 0
    s_lshl_b32 s72, s72, 14
    s_add_u32 s76, s72, s77
    buffer_load_dwordx4 v[96:99], v40, s[44:47], s76 offen offset:0 sc1
    buffer_load_dwordx4 v[100:103], v40, s[44:47], s76 offen offset:1024 sc1
    buffer_load_dwordx4 v[104:107], v40, s[44:47], s76 offen offset:2048 sc1
    buffer_load_dwordx4 v[108:111], v40, s[44:47], s76 offen offset:3072 sc1
    s_add_u32 s72, s69, 1
    s_and_b32 s72, s72, 3
    s_add_u32 s72, s72, 0
    s_lshl_b32 s72, s72, 14
    s_add_u32 s76, s72, s77
    buffer_load_dwordx4 v[112:115], v40, s[44:47], s76 offen offset:0 sc1
    buffer_load_dwordx4 v[116:119], v40, s[44:47], s76 offen offset:1024 sc1
    buffer_load_dwordx4 v[120:123], v40, s[44:47], s76 offen offset:2048 sc1
    buffer_load_dwordx4 v[124:127], v40, s[44:47], s76 offen offset:3072 sc1
    s_add_u32 s72, s69, 2
    s_and_b32 s72, s72, 3
    s_add_u32 s72, s72, 0
    s_lshl_b32 s72, s72, 14
    s_add_u32 s76, s72, s77
    buffer_load_dwordx4 v[128:131], v40, s[44:47], s76 offen offset:0 sc1
    buffer_load_dwordx4 v[132:135], v40, s[44:47], s76 offen offset:1024 sc1
    s_setprio 0
    v_and_b32 v59, 3, v1
    v_lshlrev_b32 v59, 2, v59
    v_add_u32 v59, 163584, v59
    s_mov_b32 s88, 0
Lpair_18:
    ds_read_b32 v58, v59 offset:112
    s_add_u32 s88, s88, 1
    s_cmp_ge_u32 s88, 2097152
    s_waitcnt lgkmcnt(0)
    v_cmp_eq_u32 vcc, 0, v58
    s_cbranch_scc1 Lpaird_19
    s_nop 0
    s_cbranch_vccnz Lpair_18
Lpaird_19:
    ds_read_b64_tr_b16 v[224:225], v2 offset:0
    ds_read_b64_tr_b16 v[226:227], v2 offset:1024
    ds_read_b64_tr_b16 v[228:229], v3 offset:0
    ds_read_b64_tr_b16 v[230:231], v3 offset:1024
    s_waitcnt vmcnt(9) lgkmcnt(2)
    v_mfma_f32_32x32x16_bf16 v[64:79], v[224:227], v[96:99], 0
    ds_read_b64_tr_b16 v[232:233], v2 offset:2048
    ds_read_b64_tr_b16 v[234:235], v2 offset:3072
    s_waitcnt lgkmcnt(2)
    v_mfma_f32_32x32x16_bf16 v[80:95], v[228:231], v[96:99], 0
    ds_read_b64_tr_b16 v[236:237], v3 offset:2048
    ds_read_b64_tr_b16 v[238:239], v3 offset:3072
    s_cmp_eq_u32 s70, 0
    s_cbranch_scc0 Lnoask_20
    s_bitcmp1_b32 s3, 1
    s_cbranch_scc1 Lnoask_20
    s_mov_b64 exec, 15
    v_mov_b32 v42, 0
    buffer_atomic_add v42, v54, s[44:47], 0 offen sc0 sc1
    s_mov_b64 exec, -1
Lnoask_20:
    buffer_load_dwordx4 v[96:99], v40, s[44:47], s76 offen offset:2048 sc1
    s_waitcnt vmcnt(9) lgkmcnt(2)
    v_mfma_f32_32x32x16_bf16 v[64:79], v[232:235], v[100:103], v[64:79]
    ds_read_b64_tr_b16 v[224:225], v2 offset:4096
    ds_read_b64_tr_b16 v[226:227], v2 offset:5120
    s_waitcnt lgkmcnt(2)
    v_mfma_f32_32x32x16_bf16 v[80:95], v[236:239], v[100:103], v[80:95]
    ds_read_b64_tr_b16 v[228:229], v3 offset:4096
    ds_read_b64_tr_b16 v[230:231], v3 offset:5120
    buffer_load_dwordx4 v[100:103], v40, s[44:47], s76 offen offset:3072 sc1
    s_waitcnt vmcnt(9) lgkmcnt(2)
    v_mfma_f32_32x32x16_bf16 v[64:79], v[224:227], v[104:107], v[64:79]
    ds_read_b64_tr_b16 v[232:233], v2 offset:6144
    ds_read_b64_tr_b16 v[234:235], v2 offset:7168
    s_waitcnt lgkmcnt(2)
    v_mfma_f32_32x32x16_bf16 v[80:95], v[228:231], v[104:107], v[80:95]
    ds_read_b64_tr_b16 v[236:237], v3 offset:6144
    ds_read_b64_tr_b16 v[238:239], v3 offset:7168
    s_add_u32 s72, s69, 3
    s_and_b32 s72, s72, 3
    s_add_u32 s72, s72, 0
    s_lshl_b32 s72, s72, 14
    s_add_u32 s76, s72, s77
    buffer_load_dwordx4 v[104:107], v40, s[44:47], s76 offen offset:0 sc1
    s_waitcnt vmcnt(9) lgkmcnt(2)
    v_mfma_f32_32x32x16_bf16 v[64:79], v[232:235], v[108:111], v[64:79]
    ds_read_b64_tr_b16 v[224:225], v2 offset:8192
    ds_read_b64_tr_b16 v[226:227], v2 offset:9216
    s_waitcnt lgkmcnt(2)
    v_mfma_f32_32x32x16_bf16 v[80:95], v[236:239], v[108:111], v[80:95]
    ds_read_b64_tr_b16 v[228:229], v3 offset:8192
    ds_read_b64_tr_b16 v[230:231], v3 offset:9216
    buffer_load_dwordx4 v[108:111], v40, s[44:47], s76 offen offset:1024 sc1
    s_waitcnt vmcnt(9) lgkmcnt(2)
    v_mfma_f32_32x32x16_bf16 v[64:79], v[224:227], v[112:115], v[64:79]
    ds_read_b64_tr_b16 v[232:233], v2 offset:10240
    ds_read_b64_tr_b16 v[234:235], v2 offset:11264
    s_waitcnt lgkmcnt(2)
    v_mfma_f32_32x32x16_bf16 v[80:95], v[228:231], v[112:115], v[80:95]
    ds_read_b64_tr_b16 v[236:237], v3 offset:10240
    ds_read_b64_tr_b16 v[238:239], v3 offset:11264
    buffer_load_dwordx4 v[112:115], v40, s[44:47], s76 offen offset:2048 sc1
    s_waitcnt vmcnt(9) lgkmcnt(2)
    v_mfma_f32_32x32x16_bf16 v[64:79], v[232:235], v[116:119], v[64:79]
    ds_read_b64_tr_b16 v[224:225], v2 offset:12288
    ds_read_b64_tr_b16 v[226:227], v2 offset:13312
    s_waitcnt lgkmcnt(2)
    v_mfma_f32_32x32x16_bf16 v[80:95], v[236:239], v[116:119], v[80:95]
    ds_read_b64_tr_b16 v[228:229], v3 offset:12288
    ds_read_b64_tr_b16 v[230:231], v3 offset:13312
    buffer_load_dwordx4 v[116:119], v40, s[44:47], s76 offen offset:3072 sc1
    s_waitcnt vmcnt(9) lgkmcnt(2)
    v_mfma_f32_32x32x16_bf16 v[64:79], v[224:227], v[120:123], v[64:79]
    ds_read_b64_tr_b16 v[232:233], v2 offset:14336
    ds_read_b64_tr_b16 v[234:235], v2 offset:15360
    s_waitcnt lgkmcnt(2)
    v_mfma_f32_32x32x16_bf16 v[80:95], v[228:231], v[120:123], v[80:95]
    ds_read_b64_tr_b16 v[236:237], v3 offset:14336
    ds_read_b64_tr_b16 v[238:239], v3 offset:15360
    s_bitcmp1_b32 s3, 1
    s_cbranch_scc1 Lknown_21
    s_cmp_eq_u32 s70, 0
    s_cbranch_scc0 Lwatch_22
    s_waitcnt vmcnt(6)
    s_mov_b64 exec, 15
    v_cmp_le_u32 vcc, 16, v42
    s_mov_b64 exec, -1
    s_nop 0
    s_or_b32 s3, vcc_lo, 16
    s_bitcmp1_b32 s3, 1
    s_cbranch_scc1 Ltell_23
    s_mov_b32 s88, 0
Lspin_24:
    s_mov_b64 exec, 15
    v_mov_b32 v42, 0
    buffer_atomic_add v42, v54, s[44:47], 0 offen sc0 sc1
    s_mov_b64 exec, -1
    s_add_u32 s88, s88, 1
    s_waitcnt vmcnt(0)
    s_mov_b64 exec, 15
    v_cmp_le_u32 vcc, 16, v42
    s_mov_b64 exec, -1
    s_nop 0
    s_or_b32 s3, vcc_lo, 16
    s_cmp_ge_u32 s88, 262144
    s_cbranch_scc1 Lspun_25
    s_bitcmp1_b32 s3, 1
    s_cbranch_scc1 Lspun_25
    s_sleep 2
    s_branch Lspin_24
Lspun_25:
Ltell_23:
    v_mov_b32 v42, s3
    ds_write_b32 v49, v42 offset:192
    s_waitcnt lgkmcnt(0)
    s_branch Lknown_21
Lwatch_22:
    s_mov_b32 s88, 0
Lwatchl_26:
    ds_read_b32 v58, v49 offset:192
    s_add_u32 s88, s88, 1
    s_cmp_ge_u32 s88, 2097152
    s_waitcnt lgkmcnt(0)
    v_readfirstlane_b32 s3, v58
    s_cbranch_scc1 Lknown_21
    s_nop 0
    s_bitcmp1_b32 s3, 1
    s_cbranch_scc0 Lwatchl_26
Lknown_21:
    s_add_u32 s72, s69, 4
    s_and_b32 s72, s72, 3
    s_add_u32 s72, s72, 4
    s_lshl_b32 s72, s72, 14
    s_add_u32 s76, s72, s77
    buffer_load_dwordx4 v[120:123], v40, s[44:47], s76 offen offset:0 sc1
    s_waitcnt vmcnt(9) lgkmcnt(2)
    v_mfma_f32_32x32x16_bf16 v[64:79], v[232:235], v[124:127], v[64:79]
    ds_read_b64_tr_b16 v[224:225], v2 offset:16384
    ds_read_b64_tr_b16 v[226:227], v2 offset:17408
    s_waitcnt lgkmcnt(2)
    v_mfma_f32_32x32x16_bf16 v[80:95], v[236:239], v[124:127], v[80:95]
    ds_read_b64_tr_b16 v[228:229], v3 offset:16384
    ds_read_b64_tr_b16 v[230:231], v3 offset:17408
    buffer_load_dwordx4 v[124:127], v40, s[44:47], s76 offen offset:1024 sc1
    s_waitcnt vmcnt(9) lgkmcnt(2)
    v_mfma_f32_32x32x16_bf16 v[64:79], v[224:227], v[128:131], v[64:79]
    ds_read_b64_tr_b16 v[232:233], v2 offset:18432
    ds_read_b64_tr_b16 v[234:235], v2 offset:19456
    s_waitcnt lgkmcnt(2)
    v_mfma_f32_32x32x16_bf16 v[80:95], v[228:231], v[128:131], v[80:95]
    ds_read_b64_tr_b16 v[236:237], v3 offset:18432
    ds_read_b64_tr_b16 v[238:239], v3 offset:19456
    buffer_load_dwordx4 v[128:131], v40, s[44:47], s76 offen offset:2048 sc1
    s_waitcnt vmcnt(9) lgkmcnt(2)
    v_mfma_f32_32x32x16_bf16 v[64:79], v[232:235], v[132:135], v[64:79]
    ds_read_b64_tr_b16 v[224:225], v2 offset:20480
    ds_read_b64_tr_b16 v[226:227], v2 offset:21504
    s_waitcnt lgkmcnt(2)
    v_mfma_f32_32x32x16_bf16 v[80:95], v[236:239], v[132:135], v[80:95]
    ds_read_b64_tr_b16 v[228:229], v3 offset:20480
    ds_read_b64_tr_b16 v[230:231], v3 offset:21504
    buffer_load_dwordx4 v[132:135], v40, s[44:47], s76 offen offset:3072 sc1
    s_waitcnt vmcnt(9) lgkmcnt(2)
    v_mfma_f32_32x32x16_bf16 v[64:79], v[224:227], v[96:99], v[64:79]
    ds_read_b64_tr_b16 v[232:233], v2 offset:22528
    ds_read_b64_tr_b16 v[234:235], v2 offset:23552
    s_waitcnt lgkmcnt(2)
    v_mfma_f32_32x32x16_bf16 v[80:95], v[228:231], v[96:99], v[80:95]
    ds_read_b64_tr_b16 v[236:237], v3 offset:22528
    ds_read_b64_tr_b16 v[238:239], v3 offset:23552
    s_add_u32 s72, s69, 5
    s_and_b32 s72, s72, 3
    s_add_u32 s72, s72, 4
    s_lshl_b32 s72, s72, 14
    s_add_u32 s76, s72, s77
    buffer_load_dwordx4 v[96:99], v40, s[44:47], s76 offen offset:0 sc1
    s_waitcnt vmcnt(9) lgkmcnt(2)
    v_mfma_f32_32x32x16_bf16 v[64:79], v[232:235], v[100:103], v[64:79]
    ds_read_b64_tr_b16 v[224:225], v2 offset:24576
    ds_read_b64_tr_b16 v[226:227], v2 offset:25600
    s_waitcnt lgkmcnt(2)
    v_mfma_f32_32x32x16_bf16 v[80:95], v[236:239], v[100:103], v[80:95]
    ds_read_b64_tr_b16 v[228:229], v3 offset:24576
    ds_read_b64_tr_b16 v[230:231], v3 offset:25600
    buffer_load_dwordx4 v[100:103], v40, s[44:47], s76 offen offset:1024 sc1
    s_waitcnt vmcnt(9) lgkmcnt(2)
    v_mfma_f32_32x32x16_bf16 v[64:79], v[224:227], v[104:107], v[64:79]
    ds_read_b64_tr_b16 v[232:233], v2 offset:26624
    ds_read_b64_tr_b16 v[234:235], v2 offset:27648
    s_waitcnt lgkmcnt(2)
    v_mfma_f32_32x32x16_bf16 v[80:95], v[228:231], v[104:107], v[80:95]
    ds_read_b64_tr_b16 v[236:237], v3 offset:26624
    ds_read_b64_tr_b16 v[238:239], v3 offset:27648
    buffer_load_dwordx4 v[104:107], v40, s[44:47], s76 offen offset:2048 sc1
    s_waitcnt vmcnt(9) lgkmcnt(2)
    v_mfma_f32_32x32x16_bf16 v[64:79], v[232:235], v[108:111], v[64:79]
    ds_read_b64_tr_b16 v[224:225], v2 offset:28672
    ds_read_b64_tr_b16 v[226:227], v2 offset:29696
    s_waitcnt lgkmcnt(2)
    v_mfma_f32_32x32x16_bf16 v[80:95], v[236:239], v[108:111], v[80:95]
    ds_read_b64_tr_b16 v[228:229], v3 offset:28672
    ds_read_b64_tr_b16 v[230:231], v3 offset:29696
    buffer_load_dwordx4 v[108:111], v40, s[44:47], s76 offen offset:3072 sc1
    s_waitcnt vmcnt(9) lgkmcnt(2)
    v_mfma_f32_32x32x16_bf16 v[64:79], v[224:227], v[112:115], v[64:79]
    ds_read_b64_tr_b16 v[232:233], v2 offset:30720
    ds_read_b64_tr_b16 v[234:235], v2 offset:31744
    s_waitcnt lgkmcnt(2)
    v_mfma_f32_32x32x16_bf16 v[80:95], v[228:231], v[112:115], v[80:95]
    ds_read_b64_tr_b16 v[236:237], v3 offset:30720
    ds_read_b64_tr_b16 v[238:239], v3 offset:31744
    s_add_u32 s72, s69, 6
    s_and_b32 s72, s72, 3
    s_add_u32 s72, s72, 4
    s_lshl_b32 s72, s72, 14
    s_add_u32 s76, s72, s77
    buffer_load_dwordx4 v[112:115], v40, s[44:47], s76 offen offset:0 sc1
    s_waitcnt vmcnt(9) lgkmcnt(2)
    v_mfma_f32_32x32x16_bf16 v[64:79], v[232:235], v[116:119], v[64:79]
    ds_read_b64_tr_b16 v[224:225], v2 offset:32768
    ds_read_b64_tr_b16 v[226:227], v2 offset:33792
    s_waitcnt lgkmcnt(2)
    v_mfma_f32_32x32x16_bf16 v[80:95], v[236:239], v[116:119], v[80:95]
    ds_read_b64_tr_b16 v[228:229], v3 offset:32768
    ds_read_b64_tr_b16 v[230:231], v3 offset:33792
    buffer_load_dwordx4 v[116:119], v40, s[44:47], s76 offen offset:1024 sc1
    s_waitcnt vmcnt(9) lgkmcnt(2)
    v_mfma_f32_32x32x16_bf16 v[64:79], v[224:227], v[120:123], v[64:79]
    ds_read_b64_tr_b16 v[232:233], v2 offset:34816
    ds_read_b64_tr_b16 v[234:235], v2 offset:35840
    s_waitcnt lgkmcnt(2)
    v_mfma_f32_32x32x16_bf16 v[80:95], v[228:231], v[120:123], v[80:95]
    ds_read_b64_tr_b16 v[236:237], v3 offset:34816
    ds_read_b64_tr_b16 v[238:239], v3 offset:35840
    s_cmp_eq_u32 s70, 0
    s_cbranch_scc0 Lnoask_27
    s_bitcmp1_b32 s3, 2
    s_cbranch_scc1 Lnoask_27
    s_mov_b64 exec, 15
    v_mov_b32 v42, 0
    buffer_atomic_add v42, v54, s[44:47], 0 offen sc0 sc1
    s_mov_b64 exec, -1
Lnoask_27:
    buffer_load_dwordx4 v[120:123], v40, s[44:47], s76 offen offset:2048 sc1
    s_waitcnt vmcnt(9) lgkmcnt(2)
    v_mfma_f32_32x32x16_bf16 v[64:79], v[232:235], v[124:127], v[64:79]
    ds_read_b64_tr_b16 v[224:225], v2 offset:36864
    ds_read_b64_tr_b16 v[226:227], v2 offset:37888
    s_waitcnt lgkmcnt(2)
    v_mfma_f32_32x32x16_bf16 v[80:95], v[236:239], v[124:127], v[80:95]
    ds_read_b64_tr_b16 v[228:229], v3 offset:36864
    ds_read_b64_tr_b16 v[230:231], v3 offset:37888
    buffer_load_dwordx4 v[124:127], v40, s[44:47], s76 offen offset:3072 sc1
    s_waitcnt vmcnt(9) lgkmcnt(2)
    v_mfma_f32_32x32x16_bf16 v[64:79], v[224:227], v[128:131], v[64:79]
    ds_read_b64_tr_b16 v[232:233], v2 offset:38912
    ds_read_b64_tr_b16 v[234:235], v2 offset:39936
    s_waitcnt lgkmcnt(2)
    v_mfma_f32_32x32x16_bf16 v[80:95], v[228:231], v[128:131], v[80:95]
    ds_read_b64_tr_b16 v[236:237], v3 offset:38912
    ds_read_b64_tr_b16 v[238:239], v3 offset:39936
    s_add_u32 s72, s69, 7
    s_and_b32 s72, s72, 3
    s_add_u32 s72, s72, 4
    s_lshl_b32 s72, s72, 14
    s_add_u32 s76, s72, s77
    buffer_load_dwordx4 v[128:131], v40, s[44:47], s76 offen offset:0 sc1
    s_waitcnt vmcnt(9) lgkmcnt(2)
    v_mfma_f32_32x32x16_bf16 v[64:79], v[232:235], v[132:135], v[64:79]
    ds_read_b64_tr_b16 v[224:225], v2 offset:40960
    ds_read_b64_tr_b16 v[226:227], v2 offset:41984
    s_waitcnt lgkmcnt(2)
    v_mfma_f32_32x32x16_bf16 v[80:95], v[236:239], v[132:135], v[80:95]
    ds_read_b64_tr_b16 v[228:229], v3 offset:40960
    ds_read_b64_tr_b16 v[230:231], v3 offset:41984
    buffer_load_dwordx4 v[132:135], v40, s[44:47], s76 offen offset:1024 sc1
    s_waitcnt vmcnt(9) lgkmcnt(2)
    v_mfma_f32_32x32x16_bf16 v[64:79], v[224:227], v[96:99], v[64:79]
    ds_read_b64_tr_b16 v[232:233], v2 offset:43008
    ds_read_b64_tr_b16 v[234:235], v2 offset:44032
    s_waitcnt lgkmcnt(2)
    v_mfma_f32_32x32x16_bf16 v[80:95], v[228:231], v[96:99], v[80:95]
    ds_read_b64_tr_b16 v[236:237], v3 offset:43008
    ds_read_b64_tr_b16 v[238:239], v3 offset:44032
    buffer_load_dwordx4 v[96:99], v40, s[44:47], s76 offen offset:2048 sc1
    s_waitcnt vmcnt(9) lgkmcnt(2)
    v_mfma_f32_32x32x16_bf16 v[64:79], v[232:235], v[100:103], v[64:79]
    ds_read_b64_tr_b16 v[224:225], v2 offset:45056
    ds_read_b64_tr_b16 v[226:227], v2 offset:46080
    s_waitcnt lgkmcnt(2)
    v_mfma_f32_32x32x16_bf16 v[80:95], v[236:239], v[100:103], v[80:95]
    ds_read_b64_tr_b16 v[228:229], v3 offset:45056
    ds_read_b64_tr_b16 v[230:231], v3 offset:46080
    buffer_load_dwordx4 v[100:103], v40, s[44:47], s76 offen offset:3072 sc1
    s_waitcnt vmcnt(9) lgkmcnt(2)
    v_mfma_f32_32x32x16_bf16 v[64:79], v[224:227], v[104:107], v[64:79]
    ds_read_b64_tr_b16 v[232:233], v2 offset:47104
    ds_read_b64_tr_b16 v[234:235], v2 offset:48128
    s_waitcnt lgkmcnt(2)
    v_mfma_f32_32x32x16_bf16 v[80:95], v[228:231], v[104:107], v[80:95]
    ds_read_b64_tr_b16 v[236:237], v3 offset:47104
    ds_read_b64_tr_b16 v[238:239], v3 offset:48128
    s_bitcmp1_b32 s3, 2
    s_cbranch_scc1 Lknown_28
    s_cmp_eq_u32 s70, 0
    s_cbranch_scc0 Lwatch_29
    s_waitcnt vmcnt(6)
    s_mov_b64 exec, 15
    v_cmp_le_u32 vcc, 16, v42
    s_mov_b64 exec, -1
    s_nop 0
    s_or_b32 s3, vcc_lo, 16
    s_bitcmp1_b32 s3, 2
    s_cbranch_scc1 Ltell_30
    s_mov_b32 s88, 0
Lspin_31:
    s_mov_b64 exec, 15
    v_mov_b32 v42, 0
    buffer_atomic_add v42, v54, s[44:47], 0 offen sc0 sc1
    s_mov_b64 exec, -1
    s_add_u32 s88, s88, 1
    s_waitcnt vmcnt(0)
    s_mov_b64 exec, 15
    v_cmp_le_u32 vcc, 16, v42
    s_mov_b64 exec, -1
    s_nop 0
    s_or_b32 s3, vcc_lo, 16
    s_cmp_ge_u32 s88, 262144
    s_cbranch_scc1 Lspun_32
    s_bitcmp1_b32 s3, 2
    s_cbranch_scc1 Lspun_32
    s_sleep 2
    s_branch Lspin_31
Lspun_32:
Ltell_30:
    v_mov_b32 v42, s3
    ds_write_b32 v49, v42 offset:192
    s_waitcnt lgkmcnt(0)
    s_branch Lknown_28
Lwatch_29:
    s_mov_b32 s88, 0
Lwatchl_33:
    ds_read_b32 v58, v49 offset:192
    s_add_u32 s88, s88, 1
    s_cmp_ge_u32 s88, 2097152
    s_waitcnt lgkmcnt(0)
    v_readfirstlane_b32 s3, v58
    s_cbranch_scc1 Lknown_28
    s_nop 0
    s_bitcmp1_b32 s3, 2
    s_cbranch_scc0 Lwatchl_33
Lknown_28:
    s_add_u32 s72, s69, 8
    s_and_b32 s72, s72, 3
    s_add_u32 s72, s72, 8
    s_lshl_b32 s72, s72, 14
    s_add_u32 s76, s72, s77
    buffer_load_dwordx4 v[104:107], v40, s[44:47], s76 offen offset:0 sc1
    s_waitcnt vmcnt(9) lgkmcnt(2)
    v_mfma_f32_32x32x16_bf16 v[64:79], v[232:235], v[108:111], v[64:79]
    ds_read_b64_tr_b16 v[224:225], v2 offset:49152
    ds_read_b64_tr_b16 v[226:227], v2 offset:50176
    s_waitcnt lgkmcnt(2)
    v_mfma_f32_32x32x16_bf16 v[80:95], v[236:239], v[108:111], v[80:95]
    ds_read_b64_tr_b16 v[228:229], v3 offset:49152
    ds_read_b64_tr_b16 v[230:231], v3 offset:50176
    buffer_load_dwordx4 v[108:111], v40, s[44:47], s76 offen offset:1024 sc1
    s_waitcnt vmcnt(9) lgkmcnt(2)
    v_mfma_f32_32x32x16_bf16 v[64:79], v[224:227], v[112:115], v[64:79]
    ds_read_b64_tr_b16 v[232:233], v2 offset:51200
    ds_read_b64_tr_b16 v[234:235], v2 offset:52224
    s_waitcnt lgkmcnt(2)
    v_mfma_f32_32x32x16_bf16 v[80:95], v[228:231], v[112:115], v[80:95]
    ds_read_b64_tr_b16 v[236:237], v3 offset:51200
    ds_read_b64_tr_b16 v[238:239], v3 offset:52224
    buffer_load_dwordx4 v[112:115], v40, s[44:47], s76 offen offset:2048 sc1
    s_waitcnt vmcnt(9) lgkmcnt(2)
    v_mfma_f32_32x32x16_bf16 v[64:79], v[232:235], v[116:119], v[64:79]
    ds_read_b64_tr_b16 v[224:225], v2 offset:53248
    ds_read_b64_tr_b16 v[226:227], v2 offset:54272
    s_waitcnt lgkmcnt(2)
    v_mfma_f32_32x32x16_bf16 v[80:95], v[236:239], v[116:119], v[80:95]
    ds_read_b64_tr_b16 v[228:229], v3 offset:53248
    ds_read_b64_tr_b16 v[230:231], v3 offset:54272
    buffer_load_dwordx4 v[116:119], v40, s[44:47], s76 offen offset:3072 sc1
    s_waitcnt vmcnt(9) lgkmcnt(2)
    v_mfma_f32_32x32x16_bf16 v[64:79], v[224:227], v[120:123], v[64:79]
    ds_read_b64_tr_b16 v[232:233], v2 offset:55296
    ds_read_b64_tr_b16 v[234:235], v2 offset:56320
    s_waitcnt lgkmcnt(2)
    v_mfma_f32_32x32x16_bf16 v[80:95], v[228:231], v[120:123], v[80:95]
    ds_read_b64_tr_b16 v[236:237], v3 offset:55296
    ds_read_b64_tr_b16 v[238:239], v3 offset:56320
    s_add_u32 s72, s69, 9
    s_and_b32 s72, s72, 3
    s_add_u32 s72, s72, 8
    s_lshl_b32 s72, s72, 14
    s_add_u32 s76, s72, s77
    buffer_load_dwordx4 v[120:123], v40, s[44:47], s76 offen offset:0 sc1
    s_waitcnt vmcnt(9) lgkmcnt(2)
    v_mfma_f32_32x32x16_bf16 v[64:79], v[232:235], v[124:127], v[64:79]
    ds_read_b64_tr_b16 v[224:225], v2 offset:57344
    ds_read_b64_tr_b16 v[226:227], v2 offset:58368
    s_waitcnt lgkmcnt(2)
    v_mfma_f32_32x32x16_bf16 v[80:95], v[236:239], v[124:127], v[80:95]
    ds_read_b64_tr_b16 v[228:229], v3 offset:57344
    ds_read_b64_tr_b16 v[230:231], v3 offset:58368
    buffer_load_dwordx4 v[124:127], v40, s[44:47], s76 offen offset:1024 sc1
    s_waitcnt vmcnt(9) lgkmcnt(2)
    v_mfma_f32_32x32x16_bf16 v[64:79], v[224:227], v[128:131], v[64:79]
    ds_read_b64_tr_b16 v[232:233], v2 offset:59392
    ds_read_b64_tr_b16 v[234:235], v2 offset:60416
    s_waitcnt lgkmcnt(2)
    v_mfma_f32_32x32x16_bf16 v[80:95], v[228:231], v[128:131], v[80:95]
    ds_read_b64_tr_b16 v[236:237], v3 offset:59392
    ds_read_b64_tr_b16 v[238:239], v3 offset:60416
    buffer_load_dwordx4 v[128:131], v40, s[44:47], s76 offen offset:2048 sc1
    s_waitcnt vmcnt(9) lgkmcnt(2)
    v_mfma_f32_32x32x16_bf16 v[64:79], v[232:235], v[132:135], v[64:79]
    ds_read_b64_tr_b16 v[224:225], v2 offset:61440
    ds_read_b64_tr_b16 v[226:227], v2 offset:62464
    s_waitcnt lgkmcnt(2)
    v_mfma_f32_32x32x16_bf16 v[80:95], v[236:239], v[132:135], v[80:95]
    ds_read_b64_tr_b16 v[228:229], v3 offset:61440
    ds_read_b64_tr_b16 v[230:231], v3 offset:62464
    buffer_load_dwordx4 v[132:135], v40, s[44:47], s76 offen offset:3072 sc1
    s_waitcnt vmcnt(9) lgkmcnt(2)
    v_mfma_f32_32x32x16_bf16 v[64:79], v[224:227], v[96:99], v[64:79]
    ds_read_b64_tr_b16 v[232:233], v2 offset:63488
    ds_read_b64_tr_b16 v[234:235], v2 offset:64512
    s_waitcnt lgkmcnt(2)
    v_mfma_f32_32x32x16_bf16 v[80:95], v[228:231], v[96:99], v[80:95]
    ds_read_b64_tr_b16 v[236:237], v3 offset:63488
    ds_read_b64_tr_b16 v[238:239], v3 offset:64512
    s_add_u32 s72, s69, 10
    s_and_b32 s72, s72, 3
    s_add_u32 s72, s72, 8
    s_lshl_b32 s72, s72, 14
    s_add_u32 s76, s72, s77
    buffer_load_dwordx4 v[96:99], v40, s[44:47], s76 offen offset:0 sc1
    s_waitcnt vmcnt(9) lgkmcnt(2)
    v_mfma_f32_32x32x16_bf16 v[64:79], v[232:235], v[100:103], v[64:79]
    ds_read_b64_tr_b16 v[224:225], v4 offset:0
    ds_read_b64_tr_b16 v[226:227], v4 offset:1024
    s_waitcnt lgkmcnt(2)
    v_mfma_f32_32x32x16_bf16 v[80:95], v[236:239], v[100:103], v[80:95]
    ds_read_b64_tr_b16 v[228:229], v5 offset:0
    ds_read_b64_tr_b16 v[230:231], v5 offset:1024
    buffer_load_dwordx4 v[100:103], v40, s[44:47], s76 offen offset:1024 sc1
    s_waitcnt vmcnt(9) lgkmcnt(2)
    v_mfma_f32_32x32x16_bf16 v[64:79], v[224:227], v[104:107], v[64:79]
    ds_read_b64_tr_b16 v[232:233], v4 offset:2048
    ds_read_b64_tr_b16 v[234:235], v4 offset:3072
    s_waitcnt lgkmcnt(2)
    v_mfma_f32_32x32x16_bf16 v[80:95], v[228:231], v[104:107], v[80:95]
    ds_read_b64_tr_b16 v[236:237], v5 offset:2048
    ds_read_b64_tr_b16 v[238:239], v5 offset:3072
    s_cmp_eq_u32 s70, 0
    s_cbranch_scc0 Lnoask_34
    s_bitcmp1_b32 s3, 3
    s_cbranch_scc1 Lnoask_34
    s_mov_b64 exec, 15
    v_mov_b32 v42, 0
    buffer_atomic_add v42, v54, s[44:47], 0 offen sc0 sc1
    s_mov_b64 exec, -1
Lnoask_34:
    buffer_load_dwordx4 v[104:107], v40, s[44:47], s76 offen offset:2048 sc1
    ds_write_b32 v60, v61 offset:48
    s_waitcnt vmcnt(9) lgkmcnt(3)
    v_mfma_f32_32x32x16_bf16 v[64:79], v[232:235], v[108:111], v[64:79]
    ds_read_b64_tr_b16 v[224:225], v4 offset:4096
    ds_read_b64_tr_b16 v[226:227], v4 offset:5120
    s_waitcnt lgkmcnt(2)
    v_mfma_f32_32x32x16_bf16 v[80:95], v[236:239], v[108:111], v[80:95]
    ds_read_b64_tr_b16 v[228:229], v5 offset:4096
    ds_read_b64_tr_b16 v[230:231], v5 offset:5120
    buffer_load_dwordx4 v[108:111], v40, s[44:47], s76 offen offset:3072 sc1
    s_waitcnt vmcnt(9) lgkmcnt(2)
    v_mfma_f32_32x32x16_bf16 v[64:79], v[224:227], v[112:115], v[64:79]
    ds_read_b64_tr_b16 v[232:233], v4 offset:6144
    ds_read_b64_tr_b16 v[234:235], v4 offset:7168
    s_waitcnt lgkmcnt(2)
    v_mfma_f32_32x32x16_bf16 v[80:95], v[228:231], v[112:115], v[80:95]
    ds_read_b64_tr_b16 v[236:237], v5 offset:6144
    ds_read_b64_tr_b16 v[238:239], v5 offset:7168
    s_add_u32 s72, s69, 11
    s_and_b32 s72, s72, 3
    s_add_u32 s72, s72, 8
    s_lshl_b32 s72, s72, 14
    s_add_u32 s76, s72, s77
    buffer_load_dwordx4 v[112:115], v40, s[44:47], s76 offen offset:0 sc1
    s_waitcnt vmcnt(9) lgkmcnt(2)
    v_mfma_f32_32x32x16_bf16 v[64:79], v[232:235], v[116:119], v[64:79]
    ds_read_b64_tr_b16 v[224:225], v4 offset:8192
    ds_read_b64_tr_b16 v[226:227], v4 offset:9216
    s_waitcnt lgkmcnt(2)
    v_mfma_f32_32x32x16_bf16 v[80:95], v[236:239], v[116:119], v[80:95]
    ds_read_b64_tr_b16 v[228:229], v5 offset:8192
    ds_read_b64_tr_b16 v[230:231], v5 offset:9216
    buffer_load_dwordx4 v[116:119], v40, s[44:47], s76 offen offset:1024 sc1
    s_waitcnt vmcnt(9) lgkmcnt(2)
    v_mfma_f32_32x32x16_bf16 v[64:79], v[224:227], v[120:123], v[64:79]
    ds_read_b64_tr_b16 v[232:233], v4 offset:10240
    ds_read_b64_tr_b16 v[234:235], v4 offset:11264
    s_waitcnt lgkmcnt(2)
    v_mfma_f32_32x32x16_bf16 v[80:95], v[228:231], v[120:123], v[80:95]
    ds_read_b64_tr_b16 v[236:237], v5 offset:10240
    ds_read_b64_tr_b16 v[238:239], v5 offset:11264
    buffer_load_dwordx4 v[120:123], v40, s[44:47], s76 offen offset:2048 sc1
    s_waitcnt vmcnt(9) lgkmcnt(2)
    v_mfma_f32_32x32x16_bf16 v[64:79], v[232:235], v[124:127], v[64:79]
    ds_read_b64_tr_b16 v[224:225], v4 offset:12288
    ds_read_b64_tr_b16 v[226:227], v4 offset:13312
    s_waitcnt lgkmcnt(2)
    v_mfma_f32_32x32x16_bf16 v[80:95], v[236:239], v[124:127], v[80:95]
    ds_read_b64_tr_b16 v[228:229], v5 offset:12288
    ds_read_b64_tr_b16 v[230:231], v5 offset:13312
    buffer_load_dwordx4 v[124:127], v40, s[44:47], s76 offen offset:3072 sc1
    s_waitcnt vmcnt(9) lgkmcnt(2)
    v_mfma_f32_32x32x16_bf16 v[64:79], v[224:227], v[128:131], v[64:79]
    ds_read_b64_tr_b16 v[232:233], v4 offset:14336
    ds_read_b64_tr_b16 v[234:235], v4 offset:15360
    s_waitcnt lgkmcnt(2)
    v_mfma_f32_32x32x16_bf16 v[80:95], v[228:231], v[128:131], v[80:95]
    ds_read_b64_tr_b16 v[236:237], v5 offset:14336
    ds_read_b64_tr_b16 v[238:239], v5 offset:15360
    s_bitcmp1_b32 s3, 3
    s_cbranch_scc1 Lknown_35
    s_cmp_eq_u32 s70, 0
    s_cbranch_scc0 Lwatch_36
    s_waitcnt vmcnt(6)
    s_mov_b64 exec, 15
    v_cmp_le_u32 vcc, 16, v42
    s_mov_b64 exec, -1
    s_nop 0
    s_or_b32 s3, vcc_lo, 16
    s_bitcmp1_b32 s3, 3
    s_cbranch_scc1 Ltell_37
    s_mov_b32 s88, 0
Lspin_38:
    s_mov_b64 exec, 15
    v_mov_b32 v42, 0
    buffer_atomic_add v42, v54, s[44:47], 0 offen sc0 sc1
    s_mov_b64 exec, -1
    s_add_u32 s88, s88, 1
    s_waitcnt vmcnt(0)
    s_mov_b64 exec, 15
    v_cmp_le_u32 vcc, 16, v42
    s_mov_b64 exec, -1
    s_nop 0
    s_or_b32 s3, vcc_lo, 16
    s_cmp_ge_u32 s88, 262144
    s_cbranch_scc1 Lspun_39
    s_bitcmp1_b32 s3, 3
    s_cbranch_scc1 Lspun_39
    s_sleep 2
    s_branch Lspin_38
Lspun_39:
Ltell_37:
    v_mov_b32 v42, s3
    ds_write_b32 v49, v42 offset:192
    s_waitcnt lgkmcnt(0)
    s_branch Lknown_35
Lwatch_36:
    s_mov_b32 s88, 0
Lwatchl_40:
    ds_read_b32 v58, v49 offset:192
    s_add_u32 s88, s88, 1
    s_cmp_ge_u32 s88, 2097152
    s_waitcnt lgkmcnt(0)
    v_readfirstlane_b32 s3, v58
    s_cbranch_scc1 Lknown_35
    s_nop 0
    s_bitcmp1_b32 s3, 3
    s_cbranch_scc0 Lwatchl_40
Lknown_35:
    s_add_u32 s72, s69, 12
    s_and_b32 s72, s72, 3
    s_add_u32 s72, s72, 12
    s_lshl_b32 s72, s72, 14
    s_add_u32 s76, s72, s77
    buffer_load_dwordx4 v[128:131], v40, s[44:47], s76 offen offset:0 sc1
    s_waitcnt vmcnt(9) lgkmcnt(2)
    v_mfma_f32_32x32x16_bf16 v[64:79], v[232:235], v[132:135], v[64:79]
    ds_read_b64_tr_b16 v[224:225], v4 offset:16384
    ds_read_b64_tr_b16 v[226:227], v4 offset:17408
    s_waitcnt lgkmcnt(2)
    v_mfma_f32_32x32x16_bf16 v[80:95], v[236:239], v[132:135], v[80:95]
    ds_read_b64_tr_b16 v[228:229], v5 offset:16384
    ds_read_b64_tr_b16 v[230:231], v5 offset:17408
    buffer_load_dwordx4 v[132:135], v40, s[44:47], s76 offen offset:1024 sc1
    s_waitcnt vmcnt(9) lgkmcnt(2)
    v_mfma_f32_32x32x16_bf16 v[64:79], v[224:227], v[96:99], v[64:79]
    ds_read_b64_tr_b16 v[232:233], v4 offset:18432
    ds_read_b64_tr_b16 v[234:235], v4 offset:19456
    s_waitcnt lgkmcnt(2)
    v_mfma_f32_32x32x16_bf16 v[80:95], v[228:231], v[96:99], v[80:95]
    ds_read_b64_tr_b16 v[236:237], v5 offset:18432
    ds_read_b64_tr_b16 v[238:239], v5 offset:19456
    buffer_load_dwordx4 v[96:99], v40, s[44:47], s76 offen offset:2048 sc1
    s_waitcnt vmcnt(9) lgkmcnt(2)
    v_mfma_f32_32x32x16_bf16 v[64:79], v[232:235], v[100:103], v[64:79]
    ds_read_b64_tr_b16 v[224:225], v4 offset:20480
    ds_read_b64_tr_b16 v[226:227], v4 offset:21504
    s_waitcnt lgkmcnt(2)
    v_mfma_f32_32x32x16_bf16 v[80:95], v[236:239], v[100:103], v[80:95]
    ds_read_b64_tr_b16 v[228:229], v5 offset:20480
    ds_read_b64_tr_b16 v[230:231], v5 offset:21504
    buffer_load_dwordx4 v[100:103], v40, s[44:47], s76 offen offset:3072 sc1
    s_waitcnt vmcnt(9) lgkmcnt(2)
    v_mfma_f32_32x32x16_bf16 v[64:79], v[224:227], v[104:107], v[64:79]
    ds_read_b64_tr_b16 v[232:233], v4 offset:22528
    ds_read_b64_tr_b16 v[234:235], v4 offset:23552
    s_waitcnt lgkmcnt(2)
    v_mfma_f32_32x32x16_bf16 v[80:95], v[228:231], v[104:107], v[80:95]
    ds_read_b64_tr_b16 v[236:237], v5 offset:22528
    ds_read_b64_tr_b16 v[238:239], v5 offset:23552
    s_add_u32 s72, s69, 13
    s_and_b32 s72, s72, 3
    s_add_u32 s72, s72, 12
    s_lshl_b32 s72, s72, 14
    s_add_u32 s76, s72, s77
    buffer_load_dwordx4 v[104:107], v40, s[44:47], s76 offen offset:0 sc1
    s_waitcnt vmcnt(9) lgkmcnt(2)
    v_mfma_f32_32x32x16_bf16 v[64:79], v[232:235], v[108:111], v[64:79]
    ds_read_b64_tr_b16 v[224:225], v4 offset:24576
    ds_read_b64_tr_b16 v[226:227], v4 offset:25600
    s_waitcnt lgkmcnt(2)
    v_mfma_f32_32x32x16_bf16 v[80:95], v[236:239], v[108:111], v[80:95]
    ds_read_b64_tr_b16 v[228:229], v5 offset:24576
    ds_read_b64_tr_b16 v[230:231], v5 offset:25600
    buffer_load_dwordx4 v[108:111], v40, s[44:47], s76 offen offset:1024 sc1
    s_waitcnt vmcnt(9) lgkmcnt(2)
    v_mfma_f32_32x32x16_bf16 v[64:79], v[224:227], v[112:115], v[64:79]
    ds_read_b64_tr_b16 v[232:233], v4 offset:26624
    ds_read_b64_tr_b16 v[234:235], v4 offset:27648
    s_waitcnt lgkmcnt(2)
    v_mfma_f32_32x32x16_bf16 v[80:95], v[228:231], v[112:115], v[80:95]
    ds_read_b64_tr_b16 v[236:237], v5 offset:26624
    ds_read_b64_tr_b16 v[238:239], v5 offset:27648
    buffer_load_dwordx4 v[112:115], v40, s[44:47], s76 offen offset:2048 sc1
    s_waitcnt vmcnt(9) lgkmcnt(2)
    v_mfma_f32_32x32x16_bf16 v[64:79], v[232:235], v[116:119], v[64:79]
    ds_read_b64_tr_b16 v[224:225], v4 offset:28672
    ds_read_b64_tr_b16 v[226:227], v4 offset:29696
    s_waitcnt lgkmcnt(2)
    v_mfma_f32_32x32x16_bf16 v[80:95], v[236:239], v[116:119], v[80:95]
    ds_read_b64_tr_b16 v[228:229], v5 offset:28672
    ds_read_b64_tr_b16 v[230:231], v5 offset:29696
    buffer_load_dwordx4 v[116:119], v40, s[44:47], s76 offen offset:3072 sc1
    s_waitcnt vmcnt(9) lgkmcnt(2)
    v_mfma_f32_32x32x16_bf16 v[64:79], v[224:227], v[120:123], v[64:79]
    ds_read_b64_tr_b16 v[232:233], v4 offset:30720
    ds_read_b64_tr_b16 v[234:235], v4 offset:31744
    s_waitcnt lgkmcnt(2)
    v_mfma_f32_32x32x16_bf16 v[80:95], v[228:231], v[120:123], v[80:95]
    ds_read_b64_tr_b16 v[236:237], v5 offset:30720
    ds_read_b64_tr_b16 v[238:239], v5 offset:31744
    s_add_u32 s72, s69, 14
    s_and_b32 s72, s72, 3
    s_add_u32 s72, s72, 12
    s_lshl_b32 s72, s72, 14
    s_add_u32 s76, s72, s77
    buffer_load_dwordx4 v[120:123], v40, s[44:47], s76 offen offset:0 sc1
    s_waitcnt vmcnt(9) lgkmcnt(2)
    v_mfma_f32_32x32x16_bf16 v[64:79], v[232:235], v[124:127], v[64:79]
    ds_read_b64_tr_b16 v[224:225], v4 offset:32768
    ds_read_b64_tr_b16 v[226:227], v4 offset:33792
    s_waitcnt lgkmcnt(2)
    v_mfma_f32_32x32x16_bf16 v[80:95], v[236:239], v[124:127], v[80:95]
    ds_read_b64_tr_b16 v[228:229], v5 offset:32768
    ds_read_b64_tr_b16 v[230:231], v5 offset:33792
    buffer_load_dwordx4 v[124:127], v40, s[44:47], s76 offen offset:1024 sc1
    s_waitcnt vmcnt(9) lgkmcnt(2)
    v_mfma_f32_32x32x16_bf16 v[64:79], v[224:227], v[128:131], v[64:79]
    ds_read_b64_tr_b16 v[232:233], v4 offset:34816
    ds_read_b64_tr_b16 v[234:235], v4 offset:35840
    s_waitcnt lgkmcnt(2)
    v_mfma_f32_32x32x16_bf16 v[80:95], v[228:231], v[128:131], v[80:95]
    ds_read_b64_tr_b16 v[236:237], v5 offset:34816
    ds_read_b64_tr_b16 v[238:239], v5 offset:35840
    buffer_load_dwordx4 v[128:131], v40, s[44:47], s76 offen offset:2048 sc1
    ds_write_b32 v60, v61 offset:64
    s_waitcnt vmcnt(9) lgkmcnt(3)
    v_mfma_f32_32x32x16_bf16 v[64:79], v[232:235], v[132:135], v[64:79]
    ds_read_b64_tr_b16 v[224:225], v4 offset:36864
    ds_read_b64_tr_b16 v[226:227], v4 offset:37888
    s_waitcnt lgkmcnt(2)
    v_mfma_f32_32x32x16_bf16 v[80:95], v[236:239], v[132:135], v[80:95]
    ds_read_b64_tr_b16 v[228:229], v5 offset:36864
    ds_read_b64_tr_b16 v[230:231], v5 offset:37888
    buffer_load_dwordx4 v[132:135], v40, s[44:47], s76 offen offset:3072 sc1
    s_waitcnt vmcnt(9) lgkmcnt(2)
    v_mfma_f32_32x32x16_bf16 v[64:79], v[224:227], v[96:99], v[64:79]
    ds_read_b64_tr_b16 v[232:233], v4 offset:38912
    ds_read_b64_tr_b16 v[234:235], v4 offset:39936
    s_waitcnt lgkmcnt(2)
    v_mfma_f32_32x32x16_bf16 v[80:95], v[228:231], v[96:99], v[80:95]
    ds_read_b64_tr_b16 v[236:237], v5 offset:38912
    ds_read_b64_tr_b16 v[238:239], v5 offset:39936
    s_add_u32 s72, s69, 15
    s_and_b32 s72, s72, 3
    s_add_u32 s72, s72, 12
    s_lshl_b32 s72, s72, 14
    s_add_u32 s76, s72, s77
    buffer_load_dwordx4 v[96:99], v40, s[44:47], s76 offen offset:0 sc1
    s_waitcnt vmcnt(9) lgkmcnt(2)
    v_mfma_f32_32x32x16_bf16 v[64:79], v[232:235], v[100:103], v[64:79]
    ds_read_b64_tr_b16 v[224:225], v4 offset:40960
    ds_read_b64_tr_b16 v[226:227], v4 offset:41984
    s_waitcnt lgkmcnt(2)
    v_mfma_f32_32x32x16_bf16 v[80:95], v[236:239], v[100:103], v[80:95]
    ds_read_b64_tr_b16 v[228:229], v5 offset:40960
    ds_read_b64_tr_b16 v[230:231], v5 offset:41984
    buffer_load_dwordx4 v[100:103], v40, s[44:47], s76 offen offset:1024 sc1
    s_waitcnt vmcnt(9) lgkmcnt(2)
    v_mfma_f32_32x32x16_bf16 v[64:79], v[224:227], v[104:107], v[64:79]
    ds_read_b64_tr_b16 v[232:233], v4 offset:43008
    ds_read_b64_tr_b16 v[234:235], v4 offset:44032
    s_waitcnt lgkmcnt(2)
    v_mfma_f32_32x32x16_bf16 v[80:95], v[228:231], v[104:107], v[80:95]
    ds_read_b64_tr_b16 v[236:237], v5 offset:43008
    ds_read_b64_tr_b16 v[238:239], v5 offset:44032
    buffer_load_dwordx4 v[104:107], v40, s[44:47], s76 offen offset:2048 sc1
    s_waitcnt vmcnt(9) lgkmcnt(2)
    v_mfma_f32_32x32x16_bf16 v[64:79], v[232:235], v[108:111], v[64:79]
    ds_read_b64_tr_b16 v[224:225], v4 offset:45056
    ds_read_b64_tr_b16 v[226:227], v4 offset:46080
    s_waitcnt lgkmcnt(2)
    v_mfma_f32_32x32x16_bf16 v[80:95], v[236:239], v[108:111], v[80:95]
    ds_read_b64_tr_b16 v[228:229], v5 offset:45056
    ds_read_b64_tr_b16 v[230:231], v5 offset:46080
    buffer_load_dwordx4 v[108:111], v40, s[44:47], s76 offen offset:3072 sc1
    s_waitcnt vmcnt(9) lgkmcnt(2)
    v_mfma_f32_32x32x16_bf16 v[64:79], v[224:227], v[112:115], v[64:79]
    ds_read_b64_tr_b16 v[232:233], v4 offset:47104
    ds_read_b64_tr_b16 v[234:235], v4 offset:48128
    s_waitcnt lgkmcnt(2)
    v_mfma_f32_32x32x16_bf16 v[80:95], v[228:231], v[112:115], v[80:95]
    ds_read_b64_tr_b16 v[236:237], v5 offset:47104
    ds_read_b64_tr_b16 v[238:239], v5 offset:48128
    s_waitcnt vmcnt(8) lgkmcnt(2)
    v_mfma_f32_32x32x16_bf16 v[64:79], v[232:235], v[116:119], v[64:79]
    ds_read_b64_tr_b16 v[224:225], v4 offset:49152
    ds_read_b64_tr_b16 v[226:227], v4 offset:50176
    s_waitcnt lgkmcnt(2)
    v_mfma_f32_32x32x16_bf16 v[80:95], v[236:239], v[116:119], v[80:95]
    ds_read_b64_tr_b16 v[228:229], v5 offset:49152
    ds_read_b64_tr_b16 v[230:231], v5 offset:50176
    s_waitcnt vmcnt(7) lgkmcnt(2)
    v_mfma_f32_32x32x16_bf16 v[64:79], v[224:227], v[120:123], v[64:79]
    ds_read_b64_tr_b16 v[232:233], v4 offset:51200
    ds_read_b64_tr_b16 v[234:235], v4 offset:52224
    s_waitcnt lgkmcnt(2)
    v_mfma_f32_32x32x16_bf16 v[80:95], v[228:231], v[120:123], v[80:95]
    ds_read_b64_tr_b16 v[236:237], v5 offset:51200
    ds_read_b64_tr_b16 v[238:239], v5 offset:52224
    s_waitcnt vmcnt(6) lgkmcnt(2)
    v_mfma_f32_32x32x16_bf16 v[64:79], v[232:235], v[124:127], v[64:79]
    ds_read_b64_tr_b16 v[224:225], v4 offset:53248
    ds_read_b64_tr_b16 v[226:227], v4 offset:54272
    s_waitcnt lgkmcnt(2)
    v_mfma_f32_32x32x16_bf16 v[80:95], v[236:239], v[124:127], v[80:95]
    ds_read_b64_tr_b16 v[228:229], v5 offset:53248
    ds_read_b64_tr_b16 v[230:231], v5 offset:54272
    s_waitcnt vmcnt(5) lgkmcnt(2)
    v_mfma_f32_32x32x16_bf16 v[64:79], v[224:227], v[128:131], v[64:79]
    ds_read_b64_tr_b16 v[232:233], v4 offset:55296
    ds_read_b64_tr_b16 v[234:235], v4 offset:56320
    s_waitcnt lgkmcnt(2)
    v_mfma_f32_32x32x16_bf16 v[80:95], v[228:231], v[128:131], v[80:95]
    ds_read_b64_tr_b16 v[236:237], v5 offset:55296
    ds_read_b64_tr_b16 v[238:239], v5 offset:56320
    s_mov_b32 s88, 0
Lpair_41:
    ds_read_b32 v58, v59 offset:160
    s_add_u32 s88, s88, 1
    s_cmp_ge_u32 s88, 2097152
    s_waitcnt lgkmcnt(0)
    v_cmp_eq_u32 vcc, 0, v58
    s_cbranch_scc1 Lpaird_42
    s_nop 0
    s_cbranch_vccnz Lpair_41
Lpaird_42:
    s_mov_b32 s88, 0
Lpair_43:
    ds_read_b32 v58, v59 offset:48
    s_add_u32 s88, s88, 1
    s_cmp_ge_u32 s88, 2097152
    s_waitcnt lgkmcnt(0)
    v_cmp_eq_u32 vcc, 0, v58
    s_cbranch_scc1 Lpaird_44
    s_nop 0
    s_cbranch_vccnz Lpair_43
Lpaird_44:
    s_waitcnt vmcnt(4) lgkmcnt(2)
    v_mfma_f32_32x32x16_bf16 v[64:79], v[232:235], v[132:135], v[64:79]
    ds_read_b64_tr_b16 v[224:225], v6 offset:0
    ds_read_b64_tr_b16 v[226:227], v6 offset:1024
    s_waitcnt lgkmcnt(2)
    v_mfma_f32_32x32x16_bf16 v[80:95], v[236:239], v[132:135], v[80:95]
    ds_read_b64_tr_b16 v[228:229], v7 offset:0
    ds_read_b64_tr_b16 v[230:231], v7 offset:1024
    s_waitcnt vmcnt(3) lgkmcnt(2)
    v_mfma_f32_32x32x16_bf16 v[64:79], v[224:227], v[96:99], v[64:79]
    ds_read_b64_tr_b16 v[232:233], v6 offset:7424
    ds_read_b64_tr_b16 v[234:235], v6 offset:8448
    s_waitcnt lgkmcnt(2)
    v_mfma_f32_32x32x16_bf16 v[80:95], v[228:231], v[96:99], v[80:95]
    ds_read_b64_tr_b16 v[236:237], v7 offset:7424
    ds_read_b64_tr_b16 v[238:239], v7 offset:8448
    s_waitcnt vmcnt(2) lgkmcnt(2)
    v_mfma_f32_32x32x16_bf16 v[64:79], v[232:235], v[100:103], v[64:79]
    ds_read_b64_tr_b16 v[224:225], v6 offset:14848
    ds_read_b64_tr_b16 v[226:227], v6 offset:15872
    s_waitcnt lgkmcnt(2)
    v_mfma_f32_32x32x16_bf16 v[80:95], v[236:239], v[100:103], v[80:95]
    ds_read_b64_tr_b16 v[228:229], v7 offset:14848
    ds_read_b64_tr_b16 v[230:231], v7 offset:15872
    s_waitcnt vmcnt(1) lgkmcnt(2)
    v_mfma_f32_32x32x16_bf16 v[64:79], v[224:227], v[104:107], v[64:79]
    ds_read_b64_tr_b16 v[232:233], v6 offset:22272
    ds_read_b64_tr_b16 v[234:235], v6 offset:23296
    s_waitcnt lgkmcnt(2)
    v_mfma_f32_32x32x16_bf16 v[80:95], v[228:231], v[104:107], v[80:95]
    ds_read_b64_tr_b16 v[236:237], v7 offset:22272
    ds_read_b64_tr_b16 v[238:239], v7 offset:23296
    s_waitcnt vmcnt(0) lgkmcnt(2)
    v_mfma_f32_32x32x16_bf16 v[64:79], v[232:235], v[108:111], v[64:79]
    s_waitcnt lgkmcnt(0)
    v_mfma_f32_32x32x16_bf16 v[80:95], v[236:239], v[108:111], v[80:95]
    s_nop 9
    v_cvt_pk_bf16_f32 v96, v64, v65
    v_cvt_pk_bf16_f32 v97, v66, v67
    v_cvt_pk_bf16_f32 v98, v68, v69
    v_cvt_pk_bf16_f32 v99, v70, v71
    v_cvt_pk_bf16_f32 v100, v72, v73
    v_cvt_pk_bf16_f32 v101, v74, v75
    v_cvt_pk_bf16_f32 v102, v76, v77
    v_cvt_pk_bf16_f32 v103, v78, v79
    v_permlane32_swap_b32 v96, v98
    v_permlane32_swap_b32 v97, v99
    ds_write_b128 v8, v[96:99]
    v_permlane32_swap_b32 v100, v102
    v_permlane32_swap_b32 v101, v103
    ds_write_b128 v9, v[100:103]
    v_cvt_pk_bf16_f32 v104, v80, v81
    v_cvt_pk_bf16_f32 v105, v82, v83
    v_cvt_pk_bf16_f32 v106, v84, v85
    v_cvt_pk_bf16_f32 v107, v86, v87
    v_cvt_pk_bf16_f32 v108, v88, v89
    v_cvt_pk_bf16_f32 v109, v90, v91
    v_cvt_pk_bf16_f32 v110, v92, v93
    v_cvt_pk_bf16_f32 v111, v94, v95
    v_permlane32_swap_b32 v104, v106
    v_permlane32_swap_b32 v105, v107
    ds_write_b128 v10, v[104:107]
    v_permlane32_swap_b32 v108, v110
    v_permlane32_swap_b32 v109, v111
    ds_write_b128 v11, v[108:111]
    ds_read_b128 v[112:115], v12 offset:0
    ds_read_b128 v[116:119], v12 offset:1024
    ds_read_b128 v[120:123], v12 offset:2048
    ds_read_b128 v[124:127], v12 offset:3072
    s_waitcnt lgkmcnt(3)
    s_mov_b32 s72, 0
    buffer_store_dwordx4 v[112:115], v13, s[48:51], s72 offen sc1
    s_waitcnt lgkmcnt(2)
    s_mov_b32 s72, 32768
    buffer_store_dwordx4 v[116:119], v13, s[48:51], s72 offen sc1
    s_waitcnt lgkmcnt(1)
    s_mov_b32 s72, 65536
    buffer_store_dwordx4 v[120:123], v13, s[48:51], s72 offen sc1
    s_waitcnt lgkmcnt(0)
    s_mov_b32 s72, 98304
    buffer_store_dwordx4 v[124:127], v13, s[48:51], s72 offen sc1
L_end:
    s_endpgm
L_P:
    s_and_b32 s72, s64, 1
    s_lshl_b32 s72, s72, 3
    s_and_b32 s66, s65, 7
    s_add_u32 s66, s66, s72
    s_lshr_b32 s72, s64, 1
    s_lshl_b32 s72, s72, 2
    s_lshr_b32 s67, s65, 3
    s_add_u32 s67, s67, s72
    s_lshl_b32 s72, s64, 1
    s_lshr_b32 s68, s65, 4
    s_add_u32 s68, s68, s72
    s_and_b32 s69, s65, 15
    s_mul_i32 s71, s66, 2
    s_mul_i32 s72, s67, 0
    s_add_u32 s71, s71, s72
    s_lshr_b32 s72, s67, 2
    s_mul_i32 s72, s72, 4
    s_add_u32 s71, s71, s72
    s_mov_b32 s87, 0x3fb8aa3b
    s_sub_u32 s74, s70, 4
    v_lshrrev_b32 v6, 3, v1
    v_and_b32 v7, 7, v1
    v_lshrrev_b32 v8, 4, v1
    s_lshl_b32 s72, s66, 7
    s_lshl_b32 s73, s74, 5
    s_add_u32 s72, s72, s73
    v_add_u32 v9, s72, v6
    v_lshlrev_b32 v9, 11, v9
    v_xor_b32 v10, v7, v8
    v_lshl_add_u32 v2, v10, 4, v9
    v_xor_b32 v10, 4, v10
    v_lshl_add_u32 v3, v10, 4, v9
    v_and_b32 v10, 1, v8
    v_lshlrev_b32 v10, 2, v10
    v_xor_b32 v10, v10, v7
    v_lshlrev_b32 v10, 4, v10
    v_mul_u32_u24 v11, 6144, v6
    s_lshl_b32 s72, s67, 7
    v_add3_u32 v4, v10, v11, s72
    s_lshl_b32 s78, s74, 12
    s_mul_i32 s79, s74, 6144
    s_add_u32 s79, s79, 16384
    s_mul_i32 s72, s74, 6
    s_add_u32 s72, s72, 0
    s_lshr_b32 s73, s72, 3
    s_lshl_b32 s73, s73, 11
    s_and_b32 s72, s72, 7
    s_mul_i32 s72, s72, 49152
    s_add_u32 s80, s72, s73
    s_mul_i32 s72, s74, 6
    s_add_u32 s72, s72, 1
    s_lshr_b32 s73, s72, 3
    s_lshl_b32 s73, s73, 11
    s_and_b32 s72, s72, 7
    s_mul_i32 s72, s72, 49152
    s_add_u32 s81, s72, s73
    s_mul_i32 s72, s74, 6
    s_add_u32 s72, s72, 2
    s_lshr_b32 s73, s72, 3
    s_lshl_b32 s73, s73, 11
    s_and_b32 s72, s72, 7
    s_mul_i32 s72, s72, 49152
    s_add_u32 s82, s72, s73
    s_mul_i32 s72, s74, 6
    s_add_u32 s72, s72, 3
    s_lshr_b32 s73, s72, 3
    s_lshl_b32 s73, s73, 11
    s_and_b32 s72, s72, 7
    s_mul_i32 s72, s72, 49152
    s_add_u32 s83, s72, s73
    s_mul_i32 s72, s74, 6
    s_add_u32 s72, s72, 4
    s_lshr_b32 s73, s72, 3
    s_lshl_b32 s73, s73, 11
    s_and_b32 s72, s72, 7
    s_mul_i32 s72, s72, 49152
    s_add_u32 s84, s72, s73
    s_mul_i32 s72, s74, 6
    s_add_u32 s72, s72, 5
    s_lshr_b32 s73, s72, 3
    s_lshl_b32 s73, s73, 11
    s_and_b32 s72, s72, 7
    s_mul_i32 s72, s72, 49152
    s_add_u32 s85, s72, s73
    s_mov_b32 s89, s74
    s_waitcnt lgkmcnt(0)
    s_mov_b32 s36, s4
    s_mov_b32 s37, s5
    s_mov_b32 s38, 0x400000
    s_mov_b32 s39, 0x20000
    s_mov_b32 s40, s6
    s_mov_b32 s41, s7
    s_mov_b32 s42, 0x600000
    s_mov_b32 s43, 0x20000
    s_add_u32 s72, s71, 0
    s_and_b32 s72, s72, 15
    s_lshl_b32 s76, s72, 7
    s_mul_i32 s77, s72, 393216
    s_add_u32 m0, s78, 0
    s_add_u32 s73, s76, 0
    buffer_load_dwordx4 v2, s[36:39], s73 offen lds
    s_add_u32 m0, s78, 1024
    s_add_u32 s73, s76, 16384
    buffer_load_dwordx4 v3, s[36:39], s73 offen lds
    s_add_u32 m0, s78, 2048
    s_add_u32 s73, s76, 32768
    buffer_load_dwordx4 v2, s[36:39], s73 offen lds
    s_add_u32 m0, s78, 3072
    s_add_u32 s73, s76, 49152
    buffer_load_dwordx4 v3, s[36:39], s73 offen lds
    s_add_u32 m0, s79, 0
    s_add_u32 s73, s77, s80
    buffer_load_dwordx4 v4, s[40:43], s73 offen lds
    s_add_u32 m0, s79, 1024
    s_add_u32 s73, s77, s81
    buffer_load_dwordx4 v4, s[40:43], s73 offen lds
    s_mov_b32 s44, s34
    s_mov_b32 s45, s35
    s_mov_b32 s46, 0x2000000
    s_mov_b32 s47, 0x20000
    s_mov_b32 s48, s30
    s_mov_b32 s49, s31
    s_mov_b32 s50, 0x800000
    s_mov_b32 s51, 0x20000
    s_mov_b32 s52, s10
    s_mov_b32 s53, s11
    s_mov_b32 s54, 0x200000
    s_mov_b32 s55, 0x20000
    s_mov_b32 s56, s12
    s_mov_b32 s57, s13
    s_mov_b32 s58, 0x400000
    s_mov_b32 s59, 0x20000
    s_mov_b32 s60, s32
    s_mov_b32 s61, s33
    s_mov_b32 s62, 0x100
    s_mov_b32 s63, 0x20000
    s_lshl_b32 s86, s67, 6
    s_lshl_b32 s72, s66, 2
    s_add_u32 s86, s86, s72
    s_add_u32 s86, s86, s89
    s_lshl_b32 s72, s86, 1
    v_mov_b32 v31, s72
    global_load_ushort v26, v31, s[28:29]
    s_mul_i32 s72, s89, 8704
    s_add_u32 s72, s72, 122880
    v_lshl_add_u32 v250, v1, 2, s72
    s_lshl_b32 s72, s2, 2
    s_add_u32 s72, s72, s89
    s_lshl_b32 s72, s72, 11
    v_and_b32 v248, 15, v1
    v_lshl_add_u32 v248, v248, 7, s72
    s_lshl_b32 s72, s74, 4
    v_add_u32 v11, s72, v6
    v_lshlrev_b32 v11, 11, v11
    s_lshl_b32 s72, s69, 7
    v_add3_u32 v5, v10, v11, s72
    s_lshl_b32 s75, s74, 11
    v_and_b32 v13, 15, v1
    s_lshl_b32 s72, s67, 10
    s_add_u32 s72, s72, 16826368
    v_and_b32 v241, 3, v1
    v_lshl_add_u32 v241, v241, 8, s72
    s_mov_b32 s99, s67
    s_lshl_b32 s72, s99, 2
    s_add_u32 s72, s72, s74
    s_lshl_b32 s72, s72, 8
    s_add_u32 s72, s72, 16826368
    v_mov_b32 v240, 0x40000000
    v_writelane_b32 v240, s72, 0
    s_lshl_b32 s72, s99, 7
    v_lshl_add_u32 v12, v7, 4, v9
    v_add_u32 v12, s72, v12
    s_mul_i32 s96, s74, 7424
    s_add_u32 s96, s96, 126160
    v_lshrrev_b32 v14, 2, v13
    v_lshl_add_u32 v14, v8, 3, v14
    v_lshlrev_b32 v14, 7, v14
    v_and_b32 v15, 3, v1
    v_lshl_add_u32 v14, v15, 3, v14
    v_add_u32 v14, s96, v14
    v_lshlrev_b32 v15, 6, v13
    v_lshl_add_u32 v15, v8, 4, v15
    s_lshl_b32 s72, s99, 4
    s_add_u32 s72, s72, s66
    s_lshl_b32 s72, s72, 14
    s_add_u32 s72, s72, s78
    v_add_u32 v15, s72, v15
    s_lshl_b32 s72, s67, 2
    s_add_u32 s72, s72, s74
    s_lshl_b32 s72, s72, 8
    s_add_u32 s72, s72, 16809984
    v_mov_b32 v242, 0x40000000
    v_writelane_b32 v242, s72, 0
    v_mov_b32 v243, 0
    v_mov_b32 v244, 1
    v_and_b32 v245, 3, v1
    v_lshlrev_b32 v245, 2, v245
    s_lshl_b32 s72, s74, 2
    s_add_u32 s72, s72, 163584
    v_mov_b32 v59, s72
    s_lshl_b32 s72, s67, 6
    v_lshrrev_b32 v246, 2, v1
    v_add_u32 v246, s72, v246
    v_lshlrev_b32 v246, 12, v246
    v_and_b32 v11, 3, v1
    v_lshl_add_u32 v246, v11, 4, v246
    s_lshl_b32 s72, s66, 8
    s_lshl_b32 s73, s74, 6
    s_add_u32 s72, s72, s73
    v_add_u32 v246, s72, v246
    s_mul_i32 s72, s74, 7424
    s_add_u32 s72, s72, 126160
    v_lshl_add_u32 v247, v1, 4, s72
    s_getpc_b64 s[90:91]
L_pc:
    s_add_u32 s90, s90, L_box-L_pc
    s_addc_u32 s91, s91, 0
    v_lshlrev_b32 v40, 4, v1
    v_add_u32 v41, 4096, v40
    global_load_dwordx4 v[128:131], v40, s[90:91] offset:0
    global_load_dwordx4 v[132:135], v40, s[90:91] offset:1024
    global_load_dwordx4 v[136:139], v40, s[90:91] offset:2048
    global_load_dwordx4 v[140:143], v40, s[90:91] offset:3072
    global_load_dwordx4 v[144:147], v41, s[90:91] offset:0
    global_load_dwordx4 v[148:151], v41, s[90:91] offset:1024
    s_mul_i32 s98, s89, 7424
    s_add_u32 s98, s98, 122880
    v_and_b32 v40, 15, v1
    v_lshrrev_b32 v41, 4, v1
    v_lshlrev_b32 v28, 5, v40
    v_lshl_add_u32 v28, v41, 4, v28
    s_add_u32 s99, s98, 2768
    v_add_u32 v28, s99, v28
    s_add_u32 s99, s98, 3264
    v_mov_b32 v29, s99
    v_and_b32 v42, 1, v40
    v_xor_b32 v42, 1, v42
    v_mul_u32_u24 v42, 1212, v42
    v_lshrrev_b32 v43, 1, v40
    v_lshl_add_u32 v42, v43, 2, v42
    v_lshlrev_b32 v43, 4, v41
    v_sub_u32 v42, v42, v43
    s_add_u32 s99, s98, 20
    v_add_u32 v30, s99, v42
    v_add_u32 v31, 1024, v30
    v_lshlrev_b32 v43, 2, v41
    v_sub_u32 v43, v40, v43
    s_add_u32 s99, s98, 2528
    v_lshl_add_u32 v32, v43, 3, s99
    s_add_u32 s99, s98, 2992
    v_lshl_add_u32 v33, v43, 2, s99
    v_mov_b32 v96, 0
    v_mov_b32 v97, 0
    v_mov_b32 v98, 0
    v_mov_b32 v99, 0
    v_mov_b32 v100, 0
    v_mov_b32 v101, 0
    v_mov_b32 v102, 0
    v_mov_b32 v103, 0
    v_mov_b32 v104, 0
    v_mov_b32 v105, 0
    v_mov_b32 v106, 0
    v_mov_b32 v107, 0
    v_mov_b32 v108, 0
    v_mov_b32 v109, 0
    v_mov_b32 v110, 0
    v_mov_b32 v111, 0
    v_mov_b32 v112, 0
    v_mov_b32 v113, 0
    v_mov_b32 v114, 0
    v_mov_b32 v115, 0
    v_mov_b32 v116, 0
    v_mov_b32 v117, 0
    v_mov_b32 v118, 0
    v_mov_b32 v119, 0
    v_mov_b32 v120, 0
    v_mov_b32 v121, 0
    v_mov_b32 v122, 0
    v_mov_b32 v123, 0
    v_mov_b32 v124, 0
    v_mov_b32 v125, 0
    v_mov_b32 v126, 0
    v_mov_b32 v127, 0
    s_mul_i32 s98, s89, 7424
    s_add_u32 s98, s98, 122880
    v_lshl_add_u32 v160, v1, 4, s98
    v_mov_b32 v168, 0
    v_mov_b32 v169, 0
    v_mov_b32 v170, 0
    v_mov_b32 v171, 0
    v_and_b32 v166, 15, v1
    v_lshrrev_b32 v167, 4, v1
    v_lshlrev_b32 v161, 8, v167
    v_lshl_add_u32 v161, v166, 4, v161
    s_add_u32 s99, s98, 540
    v_add_u32 v161, s99, v161
    v_and_b32 v162, 1, v167
    v_lshlrev_b32 v162, 7, v162
    v_lshl_add_u32 v162, v166, 2, v162
    s_add_u32 s99, s98, 2552
    v_add_u32 v162, s99, v162
    v_lshrrev_b32 v163, 1, v167
    v_lshlrev_b32 v163, 8, v163
    v_lshl_add_u32 v163, v166, 4, v163
    v_and_b32 v165, 1, v167
    v_lshl_add_u32 v163, v165, 3, v163
    s_add_u32 s99, s98, 24
    v_add_u32 v163, s99, v163
    v_lshlrev_b32 v164, 7, v167
    v_lshl_add_u32 v164, v166, 1, v164
    s_add_u32 s99, s98, 3004
    v_add_u32 v164, s99, v164
    v_mov_b32 v165, s98
    s_mov_b32 s98, 0x01000100
    s_mov_b32 s99, 0x03020302
    s_add_u32 m0, s79, 2048
    s_add_u32 s73, s77, s82
    buffer_load_dwordx4 v4, s[40:43], s73 offen lds
    s_add_u32 m0, s79, 3072
    s_add_u32 s73, s77, s83
    buffer_load_dwordx4 v4, s[40:43], s73 offen lds
    s_add_u32 m0, s79, 4096
    s_add_u32 s73, s77, s84
    buffer_load_dwordx4 v4, s[40:43], s73 offen lds
    s_add_u32 m0, s79, 5120
    s_add_u32 s73, s77, s85
    buffer_load_dwordx4 v4, s[40:43], s73 offen lds
    s_add_u32 s72, s71, 1
    s_and_b32 s72, s72, 15
    s_lshl_b32 s76, s72, 7
    s_mul_i32 s77, s72, 393216
    s_add_u32 m0, s78, 40960
    s_add_u32 s73, s76, 0
    buffer_load_dwordx4 v2, s[36:39], s73 offen lds
    s_add_u32 m0, s78, 41984
    s_add_u32 s73, s76, 16384
    buffer_load_dwordx4 v3, s[36:39], s73 offen lds
    s_add_u32 m0, s78, 43008
    s_add_u32 s73, s76, 32768
    buffer_load_dwordx4 v2, s[36:39], s73 offen lds
    s_add_u32 m0, s78, 44032
    s_add_u32 s73, s76, 49152
    buffer_load_dwordx4 v3, s[36:39], s73 offen lds
    s_add_u32 m0, s79, 40960
    s_add_u32 s73, s77, s80
    buffer_load_dwordx4 v4, s[40:43], s73 offen lds
    s_add_u32 m0, s79, 41984
    s_add_u32 s73, s77, s81
    buffer_load_dwordx4 v4, s[40:43], s73 offen lds
    s_waitcnt vmcnt(6)
    s_barrier
    ds_read_b32 v20, v250 offset:0
    ds_read_b32 v21, v250 offset:256
    ds_read_b32 v22, v250 offset:512
    ds_read_b32 v23, v250 offset:768
    ds_read_b32 v24, v250 offset:1024
    ds_read_b32 v25, v250 offset:1280
    s_add_u32 m0, s79, 43008
    s_add_u32 s73, s77, s82
    buffer_load_dwordx4 v4, s[40:43], s73 offen lds
    s_add_u32 m0, s79, 44032
    s_add_u32 s73, s77, s83
    buffer_load_dwordx4 v4, s[40:43], s73 offen lds
    s_add_u32 m0, s79, 45056
    s_add_u32 s73, s77, s84
    buffer_load_dwordx4 v4, s[40:43], s73 offen lds
    s_add_u32 m0, s79, 46080
    s_add_u32 s73, s77, s85
    buffer_load_dwordx4 v4, s[40:43], s73 offen lds
    s_add_u32 s72, s71, 2
    s_and_b32 s72, s72, 15
    s_lshl_b32 s76, s72, 7
    s_mul_i32 s77, s72, 393216
    s_add_u32 m0, s78, 81920
    s_add_u32 s73, s76, 0
    buffer_load_dwordx4 v2, s[36:39], s73 offen lds
    s_add_u32 m0, s78, 82944
    s_add_u32 s73, s76, 16384
    buffer_load_dwordx4 v3, s[36:39], s73 offen lds
    s_add_u32 m0, s78, 83968
    s_add_u32 s73, s76, 32768
    buffer_load_dwordx4 v2, s[36:39], s73 offen lds
    s_add_u32 m0, s78, 84992
    s_add_u32 s73, s76, 49152
    buffer_load_dwordx4 v3, s[36:39], s73 offen lds
    s_add_u32 m0, s79, 81920
    s_add_u32 s73, s77, s80
    buffer_load_dwordx4 v4, s[40:43], s73 offen lds
    s_add_u32 m0, s79, 82944
    s_add_u32 s73, s77, s81
    buffer_load_dwordx4 v4, s[40:43], s73 offen lds
    s_add_u32 m0, s79, 83968
    s_add_u32 s73, s77, s82
    buffer_load_dwordx4 v4, s[40:43], s73 offen lds
    s_add_u32 m0, s79, 84992
    s_add_u32 s73, s77, s83
    buffer_load_dwordx4 v4, s[40:43], s73 offen lds
    s_add_u32 m0, s79, 86016
    s_add_u32 s73, s77, s84
    buffer_load_dwordx4 v4, s[40:43], s73 offen lds
    s_add_u32 m0, s79, 87040
    s_add_u32 s73, s77, s85
    buffer_load_dwordx4 v4, s[40:43], s73 offen lds
    s_waitcnt vmcnt(10) lgkmcnt(0)
    s_barrier
    s_add_u32 s72, s71, 3
    s_and_b32 s72, s72, 15
    s_lshl_b32 s76, s72, 7
    s_mul_i32 s77, s72, 393216
    s_add_u32 m0, s78, 0
    s_add_u32 s73, s76, 0
    buffer_load_dwordx4 v2, s[36:39], s73 offen lds
    s_add_u32 m0, s78, 1024
    s_add_u32 s73, s76, 16384
    buffer_load_dwordx4 v3, s[36:39], s73 offen lds
    s_add_u32 m0, s78, 2048
    s_add_u32 s73, s76, 32768
    buffer_load_dwordx4 v2, s[36:39], s73 offen lds
    s_add_u32 m0, s78, 3072
    s_add_u32 s73, s76, 49152
    buffer_load_dwordx4 v3, s[36:39], s73 offen lds
    s_add_u32 m0, s79, 0
    s_add_u32 s73, s77, s80
    buffer_load_dwordx4 v4, s[40:43], s73 offen lds
    s_add_u32 m0, s79, 1024
    s_add_u32 s73, s77, s81
    buffer_load_dwordx4 v4, s[40:43], s73 offen lds
    s_add_u32 m0, s79, 2048
    s_add_u32 s73, s77, s82
    buffer_load_dwordx4 v4, s[40:43], s73 offen lds
    s_add_u32 m0, s79, 3072
    s_add_u32 s73, s77, s83
    buffer_load_dwordx4 v4, s[40:43], s73 offen lds
    s_add_u32 m0, s79, 4096
    s_add_u32 s73, s77, s84
    buffer_load_dwordx4 v4, s[40:43], s73 offen lds
    s_add_u32 m0, s79, 5120
    s_add_u32 s73, s77, s85
    buffer_load_dwordx4 v4, s[40:43], s73 offen lds
    s_waitcnt vmcnt(10) lgkmcnt(0)
    s_barrier
    s_add_u32 s72, s71, 4
    s_and_b32 s72, s72, 15
    s_lshl_b32 s76, s72, 7
    s_mul_i32 s77, s72, 393216
    s_add_u32 m0, s78, 40960
    s_add_u32 s73, s76, 0
    buffer_load_dwordx4 v2, s[36:39], s73 offen lds
    s_add_u32 m0, s78, 41984
    s_add_u32 s73, s76, 16384
    buffer_load_dwordx4 v3, s[36:39], s73 offen lds
    s_add_u32 m0, s78, 43008
    s_add_u32 s73, s76, 32768
    buffer_load_dwordx4 v2, s[36:39], s73 offen lds
    s_add_u32 m0, s78, 44032
    s_add_u32 s73, s76, 49152
    buffer_load_dwordx4 v3, s[36:39], s73 offen lds
    s_add_u32 m0, s79, 40960
    s_add_u32 s73, s77, s80
    buffer_load_dwordx4 v4, s[40:43], s73 offen lds
    s_add_u32 m0, s79, 41984
    s_add_u32 s73, s77, s81
    buffer_load_dwordx4 v4, s[40:43], s73 offen lds
    s_add_u32 m0, s79, 43008
    s_add_u32 s73, s77, s82
    buffer_load_dwordx4 v4, s[40:43], s73 offen lds
    s_add_u32 m0, s79, 44032
    s_add_u32 s73, s77, s83
    buffer_load_dwordx4 v4, s[40:43], s73 offen lds
    s_add_u32 m0, s79, 45056
    s_add_u32 s73, s77, s84
    buffer_load_dwordx4 v4, s[40:43], s73 offen lds
    s_add_u32 m0, s79, 46080
    s_add_u32 s73, s77, s85
    buffer_load_dwordx4 v4, s[40:43], s73 offen lds
    s_waitcnt vmcnt(10) lgkmcnt(0)
    s_barrier
    s_add_u32 s72, s71, 5
    s_and_b32 s72, s72, 15
    s_lshl_b32 s76, s72, 7
    s_mul_i32 s77, s72, 393216
    s_add_u32 m0, s78, 81920
    s_add_u32 s73, s76, 0
    buffer_load_dwordx4 v2, s[36:39], s73 offen lds
    s_add_u32 m0, s78, 82944
    s_add_u32 s73, s76, 16384
    buffer_load_dwordx4 v3, s[36:39], s73 offen lds
    s_add_u32 m0, s78, 83968
    s_add_u32 s73, s76, 32768
    buffer_load_dwordx4 v2, s[36:39], s73 offen lds
    s_add_u32 m0, s78, 84992
    s_add_u32 s73, s76, 49152
    buffer_load_dwordx4 v3, s[36:39], s73 offen lds
    s_add_u32 m0, s79, 81920
    s_add_u32 s73, s77, s80
    buffer_load_dwordx4 v4, s[40:43], s73 offen lds
    s_add_u32 m0, s79, 82944
    s_add_u32 s73, s77, s81
    buffer_load_dwordx4 v4, s[40:43], s73 offen lds
    s_add_u32 m0, s79, 83968
    s_add_u32 s73, s77, s82
    buffer_load_dwordx4 v4, s[40:43], s73 offen lds
    s_add_u32 m0, s79, 84992
    s_add_u32 s73, s77, s83
    buffer_load_dwordx4 v4, s[40:43], s73 offen lds
    s_add_u32 m0, s79, 86016
    s_add_u32 s73, s77, s84
    buffer_load_dwordx4 v4, s[40:43], s73 offen lds
    s_add_u32 m0, s79, 87040
    s_add_u32 s73, s77, s85
    buffer_load_dwordx4 v4, s[40:43], s73 offen lds
    s_waitcnt vmcnt(10) lgkmcnt(0)
    s_barrier
    s_add_u32 s72, s71, 6
    s_and_b32 s72, s72, 15
    s_lshl_b32 s76, s72, 7
    s_mul_i32 s77, s72, 393216
    s_add_u32 m0, s78, 0
    s_add_u32 s73, s76, 0
    buffer_load_dwordx4 v2, s[36:39], s73 offen lds
    s_add_u32 m0, s78, 1024
    s_add_u32 s73, s76, 16384
    buffer_load_dwordx4 v3, s[36:39], s73 offen lds
    s_add_u32 m0, s78, 2048
    s_add_u32 s73, s76, 32768
    buffer_load_dwordx4 v2, s[36:39], s73 offen lds
    s_add_u32 m0, s78, 3072
    s_add_u32 s73, s76, 49152
    buffer_load_dwordx4 v3, s[36:39], s73 offen lds
    s_add_u32 m0, s79, 0
    s_add_u32 s73, s77, s80
    buffer_load_dwordx4 v4, s[40:43], s73 offen lds
    s_add_u32 m0, s79, 1024
    s_add_u32 s73, s77, s81
    buffer_load_dwordx4 v4, s[40:43], s73 offen lds
    s_add_u32 m0, s79, 2048
    s_add_u32 s73, s77, s82
    buffer_load_dwordx4 v4, s[40:43], s73 offen lds
    s_add_u32 m0, s79, 3072
    s_add_u32 s73, s77, s83
    buffer_load_dwordx4 v4, s[40:43], s73 offen lds
    s_add_u32 m0, s79, 4096
    s_add_u32 s73, s77, s84
    buffer_load_dwordx4 v4, s[40:43], s73 offen lds
    s_add_u32 m0, s79, 5120
    s_add_u32 s73, s77, s85
    buffer_load_dwordx4 v4, s[40:43], s73 offen lds
    s_waitcnt vmcnt(10) lgkmcnt(0)
    s_barrier
    s_add_u32 s72, s71, 7
    s_and_b32 s72, s72, 15
    s_lshl_b32 s76, s72, 7
    s_mul_i32 s77, s72, 393216
    s_add_u32 m0, s78, 40960
    s_add_u32 s73, s76, 0
    buffer_load_dwordx4 v2, s[36:39], s73 offen lds
    s_add_u32 m0, s78, 41984
    s_add_u32 s73, s76, 16384
    buffer_load_dwordx4 v3, s[36:39], s73 offen lds
    s_add_u32 m0, s78, 43008
    s_add_u32 s73, s76, 32768
    buffer_load_dwordx4 v2, s[36:39], s73 offen lds
    s_add_u32 m0, s78, 44032
    s_add_u32 s73, s76, 49152
    buffer_load_dwordx4 v3, s[36:39], s73 offen lds
    s_add_u32 m0, s79, 40960
    s_add_u32 s73, s77, s80
    buffer_load_dwordx4 v4, s[40:43], s73 offen lds
    s_add_u32 m0, s79, 41984
    s_add_u32 s73, s77, s81
    buffer_load_dwordx4 v4, s[40:43], s73 offen lds
    s_add_u32 m0, s79, 43008
    s_add_u32 s73, s77, s82
    buffer_load_dwordx4 v4, s[40:43], s73 offen lds
    s_add_u32 m0, s79, 44032
    s_add_u32 s73, s77, s83
    buffer_load_dwordx4 v4, s[40:43], s73 offen lds
    s_add_u32 m0, s79, 45056
    s_add_u32 s73, s77, s84
    buffer_load_dwordx4 v4, s[40:43], s73 offen lds
    s_add_u32 m0, s79, 46080
    s_add_u32 s73, s77, s85
    buffer_load_dwordx4 v4, s[40:43], s73 offen lds
    s_waitcnt vmcnt(10) lgkmcnt(0)
    s_barrier
    s_add_u32 s72, s71, 8
    s_and_b32 s72, s72, 15
    s_lshl_b32 s76, s72, 7
    s_mul_i32 s77, s72, 393216
    s_add_u32 m0, s78, 81920
    s_add_u32 s73, s76, 0
    buffer_load_dwordx4 v2, s[36:39], s73 offen lds
    s_add_u32 m0, s78, 82944
    s_add_u32 s73, s76, 16384
    buffer_load_dwordx4 v3, s[36:39], s73 offen lds
    s_add_u32 m0, s78, 83968
    s_add_u32 s73, s76, 32768
    buffer_load_dwordx4 v2, s[36:39], s73 offen lds
    s_add_u32 m0, s78, 84992
    s_add_u32 s73, s76, 49152
    buffer_load_dwordx4 v3, s[36:39], s73 offen lds
    s_add_u32 m0, s79, 81920
    s_add_u32 s73, s77, s80
    buffer_load_dwordx4 v4, s[40:43], s73 offen lds
    s_add_u32 m0, s79, 82944
    s_add_u32 s73, s77, s81
    buffer_load_dwordx4 v4, s[40:43], s73 offen lds
    s_add_u32 m0, s79, 83968
    s_add_u32 s73, s77, s82
    buffer_load_dwordx4 v4, s[40:43], s73 offen lds
    s_add_u32 m0, s79, 84992
    s_add_u32 s73, s77, s83
    buffer_load_dwordx4 v4, s[40:43], s73 offen lds
    s_add_u32 m0, s79, 86016
    s_add_u32 s73, s77, s84
    buffer_load_dwordx4 v4, s[40:43], s73 offen lds
    s_add_u32 m0, s79, 87040
    s_add_u32 s73, s77, s85
    buffer_load_dwordx4 v4, s[40:43], s73 offen lds
    s_waitcnt vmcnt(10) lgkmcnt(0)
    s_barrier
    s_add_u32 s72, s71, 9
    s_and_b32 s72, s72, 15
    s_lshl_b32 s76, s72, 7
    s_mul_i32 s77, s72, 393216
    s_add_u32 m0, s78, 0
    s_add_u32 s73, s76, 0
    buffer_load_dwordx4 v2, s[36:39], s73 offen lds
    s_add_u32 m0, s78, 1024
    s_add_u32 s73, s76, 16384
    buffer_load_dwordx4 v3, s[36:39], s73 offen lds
    s_add_u32 m0, s78, 2048
    s_add_u32 s73, s76, 32768
    buffer_load_dwordx4 v2, s[36:39], s73 offen lds
    s_add_u32 m0, s78, 3072
    s_add_u32 s73, s76, 49152
    buffer_load_dwordx4 v3, s[36:39], s73 offen lds
    s_add_u32 m0, s79, 0
    s_add_u32 s73, s77, s80
    buffer_load_dwordx4 v4, s[40:43], s73 offen lds
    s_add_u32 m0, s79, 1024
    s_add_u32 s73, s77, s81
    buffer_load_dwordx4 v4, s[40:43], s73 offen lds
    s_add_u32 m0, s79, 2048
    s_add_u32 s73, s77, s82
    buffer_load_dwordx4 v4, s[40:43], s73 offen lds
    s_add_u32 m0, s79, 3072
    s_add_u32 s73, s77, s83
    buffer_load_dwordx4 v4, s[40:43], s73 offen lds
    s_add_u32 m0, s79, 4096
    s_add_u32 s73, s77, s84
    buffer_load_dwordx4 v4, s[40:43], s73 offen lds
    s_add_u32 m0, s79, 5120
    s_add_u32 s73, s77, s85
    buffer_load_dwordx4 v4, s[40:43], s73 offen lds
    s_waitcnt vmcnt(10) lgkmcnt(0)
    s_barrier
    s_add_u32 s72, s71, 10
    s_and_b32 s72, s72, 15
    s_lshl_b32 s76, s72, 7
    s_mul_i32 s77, s72, 393216
    s_add_u32 m0, s78, 40960
    s_add_u32 s73, s76, 0
    buffer_load_dwordx4 v2, s[36:39], s73 offen lds
    s_add_u32 m0, s78, 41984
    s_add_u32 s73, s76, 16384
    buffer_load_dwordx4 v3, s[36:39], s73 offen lds
    s_add_u32 m0, s78, 43008
    s_add_u32 s73, s76, 32768
    buffer_load_dwordx4 v2, s[36:39], s73 offen lds
    s_add_u32 m0, s78, 44032
    s_add_u32 s73, s76, 49152
    buffer_load_dwordx4 v3, s[36:39], s73 offen lds
    s_add_u32 m0, s79, 40960
    s_add_u32 s73, s77, s80
    buffer_load_dwordx4 v4, s[40:43], s73 offen lds
    s_add_u32 m0, s79, 41984
    s_add_u32 s73, s77, s81
    buffer_load_dwordx4 v4, s[40:43], s73 offen lds
    s_add_u32 m0, s79, 43008
    s_add_u32 s73, s77, s82
    buffer_load_dwordx4 v4, s[40:43], s73 offen lds
    s_add_u32 m0, s79, 44032
    s_add_u32 s73, s77, s83
    buffer_load_dwordx4 v4, s[40:43], s73 offen lds
    s_add_u32 m0, s79, 45056
    s_add_u32 s73, s77, s84
    buffer_load_dwordx4 v4, s[40:43], s73 offen lds
    s_add_u32 m0, s79, 46080
    s_add_u32 s73, s77, s85
    buffer_load_dwordx4 v4, s[40:43], s73 offen lds
    buffer_load_dword v16, v245, s[60:63], 0 offen sc1
    s_waitcnt vmcnt(11) lgkmcnt(0)
    s_barrier
    s_add_u32 s72, s71, 11
    s_and_b32 s72, s72, 15
    s_lshl_b32 s76, s72, 7
    s_mul_i32 s77, s72, 393216
    s_add_u32 m0, s78, 81920
    s_add_u32 s73, s76, 0
    buffer_load_dwordx4 v2, s[36:39], s73 offen lds
    s_add_u32 m0, s78, 82944
    s_add_u32 s73, s76, 16384
    buffer_load_dwordx4 v3, s[36:39], s73 offen lds
    s_add_u32 m0, s78, 83968
    s_add_u32 s73, s76, 32768
    buffer_load_dwordx4 v2, s[36:39], s73 offen lds
    s_add_u32 m0, s78, 84992
    s_add_u32 s73, s76, 49152
    buffer_load_dwordx4 v3, s[36:39], s73 offen lds
    s_add_u32 m0, s79, 81920
    s_add_u32 s73, s77, s80
    buffer_load_dwordx4 v4, s[40:43], s73 offen lds
    s_add_u32 m0, s79, 82944
    s_add_u32 s73, s77, s81
    buffer_load_dwordx4 v4, s[40:43], s73 offen lds
    s_add_u32 m0, s79, 83968
    s_add_u32 s73, s77, s82
    buffer_load_dwordx4 v4, s[40:43], s73 offen lds
    s_add_u32 m0, s79, 84992
    s_add_u32 s73, s77, s83
    buffer_load_dwordx4 v4, s[40:43], s73 offen lds
    s_add_u32 m0, s79, 86016
    s_add_u32 s73, s77, s84
    buffer_load_dwordx4 v4, s[40:43], s73 offen lds
    s_add_u32 m0, s79, 87040
    s_add_u32 s73, s77, s85
    buffer_load_dwordx4 v4, s[40:43], s73 offen lds
    s_waitcnt vmcnt(11) lgkmcnt(0)
    s_barrier
    s_add_u32 s72, s71, 12
    s_and_b32 s72, s72, 15
    s_lshl_b32 s76, s72, 7
    s_mul_i32 s77, s72, 393216
    s_add_u32 m0, s78, 0
    s_add_u32 s73, s76, 0
    buffer_load_dwordx4 v2, s[36:39], s73 offen lds
    s_add_u32 m0, s78, 1024
    s_add_u32 s73, s76, 16384
    buffer_load_dwordx4 v3, s[36:39], s73 offen lds
    s_add_u32 m0, s78, 2048
    s_add_u32 s73, s76, 32768
    buffer_load_dwordx4 v2, s[36:39], s73 offen lds
    s_add_u32 m0, s78, 3072
    s_add_u32 s73, s76, 49152
    buffer_load_dwordx4 v3, s[36:39], s73 offen lds
    s_add_u32 m0, s79, 0
    s_add_u32 s73, s77, s80
    buffer_load_dwordx4 v4, s[40:43], s73 offen lds
    s_add_u32 m0, s79, 1024
    s_add_u32 s73, s77, s81
    buffer_load_dwordx4 v4, s[40:43], s73 offen lds
    s_add_u32 m0, s79, 2048
    s_add_u32 s73, s77, s82
    buffer_load_dwordx4 v4, s[40:43], s73 offen lds
    s_add_u32 m0, s79, 3072
    s_add_u32 s73, s77, s83
    buffer_load_dwordx4 v4, s[40:43], s73 offen lds
    s_add_u32 m0, s79, 4096
    s_add_u32 s73, s77, s84
    buffer_load_dwordx4 v4, s[40:43], s73 offen lds
    s_add_u32 m0, s79, 5120
    s_add_u32 s73, s77, s85
    buffer_load_dwordx4 v4, s[40:43], s73 offen lds
    s_waitcnt vmcnt(10) lgkmcnt(0)
    s_barrier
    s_add_u32 s72, s71, 13
    s_and_b32 s72, s72, 15
    s_lshl_b32 s76, s72, 7
    s_mul_i32 s77, s72, 393216
    s_add_u32 m0, s78, 40960
    s_add_u32 s73, s76, 0
    buffer_load_dwordx4 v2, s[36:39], s73 offen lds
    s_add_u32 m0, s78, 41984
    s_add_u32 s73, s76, 16384
    buffer_load_dwordx4 v3, s[36:39], s73 offen lds
    s_add_u32 m0, s78, 43008
    s_add_u32 s73, s76, 32768
    buffer_load_dwordx4 v2, s[36:39], s73 offen lds
    s_add_u32 m0, s78, 44032
    s_add_u32 s73, s76, 49152
    buffer_load_dwordx4 v3, s[36:39], s73 offen lds
    s_add_u32 m0, s79, 40960
    s_add_u32 s73, s77, s80
    buffer_load_dwordx4 v4, s[40:43], s73 offen lds
    s_add_u32 m0, s79, 41984
    s_add_u32 s73, s77, s81
    buffer_load_dwordx4 v4, s[40:43], s73 offen lds
    s_add_u32 m0, s79, 43008
    s_add_u32 s73, s77, s82
    buffer_load_dwordx4 v4, s[40:43], s73 offen lds
    s_add_u32 m0, s79, 44032
    s_add_u32 s73, s77, s83
    buffer_load_dwordx4 v4, s[40:43], s73 offen lds
    s_add_u32 m0, s79, 45056
    s_add_u32 s73, s77, s84
    buffer_load_dwordx4 v4, s[40:43], s73 offen lds
    s_add_u32 m0, s79, 46080
    s_add_u32 s73, s77, s85
    buffer_load_dwordx4 v4, s[40:43], s73 offen lds
    v_cmp_gt_u32 vcc, 1, v16
    s_nop 1
    s_cbranch_vccz Lclrok_45
    s_mov_b32 s88, 0
Lpoll_46:
    buffer_load_dword v16, v245, s[60:63], 0 offen sc1
    s_add_u32 s88, s88, 1
    s_waitcnt vmcnt(0)
    v_cmp_gt_u32 vcc, 1, v16
    s_cmp_ge_u32 s88, 262144
    s_cbranch_scc1 Lpdone_47
    s_cbranch_vccz Lpdone_47
    s_branch Lpoll_46
Lpdone_47:
Lclrok_45:
    s_waitcnt vmcnt(10) lgkmcnt(0)
    s_barrier
    s_add_u32 s72, s71, 14
    s_and_b32 s72, s72, 15
    s_lshl_b32 s76, s72, 7
    s_mul_i32 s77, s72, 393216
    s_add_u32 m0, s78, 81920
    s_add_u32 s73, s76, 0
    buffer_load_dwordx4 v2, s[36:39], s73 offen lds
    s_add_u32 m0, s78, 82944
    s_add_u32 s73, s76, 16384
    buffer_load_dwordx4 v3, s[36:39], s73 offen lds
    s_add_u32 m0, s78, 83968
    s_add_u32 s73, s76, 32768
    buffer_load_dwordx4 v2, s[36:39], s73 offen lds
    s_add_u32 m0, s78, 84992
    s_add_u32 s73, s76, 49152
    buffer_load_dwordx4 v3, s[36:39], s73 offen lds
    s_add_u32 m0, s79, 81920
    s_add_u32 s73, s77, s80
    buffer_load_dwordx4 v4, s[40:43], s73 offen lds
    s_add_u32 m0, s79, 82944
    s_add_u32 s73, s77, s81
    buffer_load_dwordx4 v4, s[40:43], s73 offen lds
    s_add_u32 m0, s79, 83968
    s_add_u32 s73, s77, s82
    buffer_load_dwordx4 v4, s[40:43], s73 offen lds
    s_add_u32 m0, s79, 84992
    s_add_u32 s73, s77, s83
    buffer_load_dwordx4 v4, s[40:43], s73 offen lds
    s_add_u32 m0, s79, 86016
    s_add_u32 s73, s77, s84
    buffer_load_dwordx4 v4, s[40:43], s73 offen lds
    s_add_u32 m0, s79, 87040
    s_add_u32 s73, s77, s85
    buffer_load_dwordx4 v4, s[40:43], s73 offen lds
    s_waitcnt vmcnt(10) lgkmcnt(0)
    s_barrier
    s_add_u32 s72, s71, 15
    s_and_b32 s72, s72, 15
    s_lshl_b32 s76, s72, 7
    s_mul_i32 s77, s72, 393216
    s_add_u32 m0, s78, 0
    s_add_u32 s73, s76, 0
    buffer_load_dwordx4 v2, s[36:39], s73 offen lds
    s_add_u32 m0, s78, 1024
    s_add_u32 s73, s76, 16384
    buffer_load_dwordx4 v3, s[36:39], s73 offen lds
    s_add_u32 m0, s78, 2048
    s_add_u32 s73, s76, 32768
    buffer_load_dwordx4 v2, s[36:39], s73 offen lds
    s_add_u32 m0, s78, 3072
    s_add_u32 s73, s76, 49152
    buffer_load_dwordx4 v3, s[36:39], s73 offen lds
    s_add_u32 m0, s79, 0
    s_add_u32 s73, s77, s80
    buffer_load_dwordx4 v4, s[40:43], s73 offen lds
    s_add_u32 m0, s79, 1024
    s_add_u32 s73, s77, s81
    buffer_load_dwordx4 v4, s[40:43], s73 offen lds
    s_add_u32 m0, s79, 2048
    s_add_u32 s73, s77, s82
    buffer_load_dwordx4 v4, s[40:43], s73 offen lds
    s_add_u32 m0, s79, 3072
    s_add_u32 s73, s77, s83
    buffer_load_dwordx4 v4, s[40:43], s73 offen lds
    s_add_u32 m0, s79, 4096
    s_add_u32 s73, s77, s84
    buffer_load_dwordx4 v4, s[40:43], s73 offen lds
    s_add_u32 m0, s79, 5120
    s_add_u32 s73, s77, s85
    buffer_load_dwordx4 v4, s[40:43], s73 offen lds
    s_add_u32 m0, s96, 0
    s_mov_b32 s73, 0
    buffer_load_dwordx4 v12, s[56:59], s73 offen nt lds
    s_add_u32 m0, s96, 1024
    s_mov_b32 s73, 16384
    buffer_load_dwordx4 v12, s[56:59], s73 offen nt lds
    s_add_u32 m0, s96, 2048
    s_mov_b32 s73, 32768
    buffer_load_dwordx4 v12, s[56:59], s73 offen nt lds
    s_add_u32 m0, s96, 3072
    s_mov_b32 s73, 49152
    buffer_load_dwordx4 v12, s[56:59], s73 offen nt lds
    buffer_load_dword v249, v248, s[52:55], 0 offen
    s_waitcnt vmcnt(15) lgkmcnt(0)
    s_barrier
    ds_write_b128 v160, v[168:171]
    ds_write_b128 v160, v[168:171] offset:1024
    ds_write_b128 v160, v[168:171] offset:2048
    s_mov_b64 exec, 0x1fff
    ds_write_b128 v160, v[168:171] offset:3072
    s_mov_b64 exec, -1
    v_perm_b32 v172, v22, v22, s98
    v_perm_b32 v174, v23, v23, s98
    v_alignbit_b32 v177, v22, v22, 16
    v_alignbit_b32 v179, v23, v23, 16
    v_perm_b32 v180, v24, v24, s98
    v_perm_b32 v181, v23, v23, s99
    v_mov_b32 v183, 0xffff
    v_bfi_b32 v173, v183, v23, v22
    v_alignbit_b32 v182, v20, v21, 16
    v_mov_b32 v176, v172
    v_mov_b32 v178, v174
    s_mov_b32 exec_hi, 0
    ds_write_b16 v161, v22 offset:0
    ds_write2_b32 v161, v172, v173 offset0:1 offset1:2
    ds_write_b32 v161, v174 offset:12
    ds_write_b16_d16_hi v161, v23 offset:18
    v_add_u32 v184, 1216, v161
    ds_write2_b32 v184, v176, v177 offset0:0 offset1:1
    ds_write2_b32 v184, v178, v179 offset0:2 offset1:3
    ds_write_b16 v164, v24 offset:0
    ds_write_b16_d16_hi v164, v24 offset:32
    ds_write_b16 v164, v25 offset:64
    ds_write_b16_d16_hi v164, v25 offset:96
    s_mov_b64 exec, -1
    ds_write_b64 v163, v[20:21] offset:8
    ds_write_b16_d16_hi v163, v20 offset:1220
    ds_write_b32 v163, v182 offset:1224
    ds_write_b16 v163, v21 offset:1230
    s_mov_b32 exec_lo, 0
    ds_write2_b32 v162, v22, v23 offset0:0 offset1:16
    s_mov_b32 exec_hi, 1
    ds_write_b16 v165, v24 offset:1052
    ds_write_b32 v165, v180 offset:1056
    ds_write_b16 v165, v24 offset:1062
    ds_write_b32 v165, v180 offset:2268
    ds_write_b32 v165, v180 offset:2272
    s_mov_b32 exec_hi, 0x80000000
    ds_write_b16_d16_hi v165, v23 offset:1156
    ds_write_b16_d16_hi v165, v23 offset:1162
    ds_write_b32 v165, v181 offset:2372
    s_mov_b64 exec, -1
    s_waitcnt vmcnt(5)
    ds_write_b32 v59, v244 offset:176
    s_barrier
    s_add_u32 s72, s69, 5
    s_and_b32 s72, s72, 3
    s_add_u32 s72, s72, 4
    s_lshl_b32 s72, s72, 17
    s_add_u32 m0, s75, 40960
    s_add_u32 s73, s72, 0
    buffer_load_dwordx4 v5, s[52:55], s73 offen lds
    s_add_u32 m0, s75, 41984
    s_add_u32 s73, s72, 16384
    buffer_load_dwordx4 v5, s[52:55], s73 offen lds
    s_add_u32 s72, s69, 6
    s_and_b32 s72, s72, 3
    s_add_u32 s72, s72, 4
    s_lshl_b32 s72, s72, 17
    s_add_u32 m0, s75, 49152
    s_add_u32 s73, s72, 0
    buffer_load_dwordx4 v5, s[52:55], s73 offen lds
    s_add_u32 m0, s75, 50176
    s_add_u32 s73, s72, 16384
    buffer_load_dwordx4 v5, s[52:55], s73 offen lds
    s_add_u32 s72, s69, 7
    s_and_b32 s72, s72, 3
    s_add_u32 s72, s72, 4
    s_lshl_b32 s72, s72, 17
    s_add_u32 m0, s75, 57344
    s_add_u32 s73, s72, 0
    buffer_load_dwordx4 v5, s[52:55], s73 offen lds
    s_add_u32 m0, s75, 58368
    s_add_u32 s73, s72, 16384
    buffer_load_dwordx4 v5, s[52:55], s73 offen lds
    s_add_u32 s72, s69, 8
    s_and_b32 s72, s72, 3
    s_add_u32 s72, s72, 8
    s_lshl_b32 s72, s72, 17
    s_add_u32 m0, s75, 65536
    s_add_u32 s73, s72, 0
    buffer_load_dwordx4 v5, s[52:55], s73 offen lds
    s_add_u32 m0, s75, 66560
    s_add_u32 s73, s72, 16384
    buffer_load_dwordx4 v5, s[52:55], s73 offen lds
    s_waitcnt vmcnt(9)
    ds_read_b64_tr_b16 v[224:225], v14 offset:0
    ds_read_b64_tr_b16 v[226:227], v14 offset:512
    ds_read_b64_tr_b16 v[228:229], v14 offset:32
    ds_read_b64_tr_b16 v[230:231], v14 offset:544
    ds_read_b64_tr_b16 v[232:233], v14 offset:64
    ds_read_b64_tr_b16 v[234:235], v14 offset:576
    ds_read_b64_tr_b16 v[236:237], v14 offset:96
    ds_read_b64_tr_b16 v[238:239], v14 offset:608
    s_waitcnt lgkmcnt(6)
    buffer_store_dwordx4 v[224:227], v15, s[44:47], 0 offen offset:0 sc1
    s_waitcnt lgkmcnt(4)
    buffer_store_dwordx4 v[228:231], v15, s[44:47], 0 offen offset:1024 sc1
    s_waitcnt lgkmcnt(2)
    buffer_store_dwordx4 v[232:235], v15, s[44:47], 0 offen offset:2048 sc1
    s_waitcnt lgkmcnt(0)
    buffer_store_dwordx4 v[236:239], v15, s[44:47], 0 offen offset:3072 sc1
    s_add_u32 s72, s69, 9
    s_and_b32 s72, s72, 3
    s_add_u32 s72, s72, 8
    s_lshl_b32 s72, s72, 17
    s_add_u32 m0, s75, 73728
    s_add_u32 s73, s72, 0
    buffer_load_dwordx4 v5, s[52:55], s73 offen lds
    s_add_u32 m0, s75, 74752
    s_add_u32 s73, s72, 16384
    buffer_load_dwordx4 v5, s[52:55], s73 offen lds
    s_add_u32 s72, s69, 10
    s_and_b32 s72, s72, 3
    s_add_u32 s72, s72, 8
    s_lshl_b32 s72, s72, 17
    s_add_u32 m0, s75, 81920
    s_add_u32 s73, s72, 0
    buffer_load_dwordx4 v5, s[52:55], s73 offen lds
    s_add_u32 m0, s75, 82944
    s_add_u32 s73, s72, 16384
    buffer_load_dwordx4 v5, s[52:55], s73 offen lds
    s_add_u32 s72, s69, 11
    s_and_b32 s72, s72, 3
    s_add_u32 s72, s72, 8
    s_lshl_b32 s72, s72, 17
    s_add_u32 m0, s75, 90112
    s_add_u32 s73, s72, 0
    buffer_load_dwordx4 v5, s[52:55], s73 offen lds
    s_add_u32 m0, s75, 91136
    s_add_u32 s73, s72, 16384
    buffer_load_dwordx4 v5, s[52:55], s73 offen lds
    s_add_u32 s72, s69, 12
    s_and_b32 s72, s72, 3
    s_add_u32 s72, s72, 12
    s_lshl_b32 s72, s72, 17
    s_add_u32 m0, s75, 98304
    s_add_u32 s73, s72, 0
    buffer_load_dwordx4 v5, s[52:55], s73 offen lds
    s_add_u32 m0, s75, 99328
    s_add_u32 s73, s72, 16384
    buffer_load_dwordx4 v5, s[52:55], s73 offen lds
    s_waitcnt vmcnt(8)
    buffer_atomic_add v244, v240, s[44:47], 0 offen sc1
    v_add_u32 v57, 163584, v245
    s_mov_b32 s88, 0
Lpair_48:
    ds_read_b32 v58, v57 offset:144
    s_add_u32 s88, s88, 1
    s_cmp_ge_u32 s88, 2097152
    s_waitcnt lgkmcnt(0)
    v_cmp_eq_u32 vcc, 0, v58
    s_cbranch_scc1 Lpaird_49
    s_nop 0
    s_cbranch_vccz Lpaird_49
    s_sleep 1
    s_branch Lpair_48
Lpaird_49:
    s_add_u32 s72, s69, 0
    s_and_b32 s72, s72, 3
    s_add_u32 s72, s72, 0
    s_lshl_b32 s72, s72, 17
    s_add_u32 m0, s75, 0
    s_add_u32 s73, s72, 0
    buffer_load_dwordx4 v5, s[52:55], s73 offen lds
    s_add_u32 m0, s75, 1024
    s_add_u32 s73, s72, 16384
    buffer_load_dwordx4 v5, s[52:55], s73 offen lds
    s_add_u32 s72, s69, 1
    s_and_b32 s72, s72, 3
    s_add_u32 s72, s72, 0
    s_lshl_b32 s72, s72, 17
    s_add_u32 m0, s75, 8192
    s_add_u32 s73, s72, 0
    buffer_load_dwordx4 v5, s[52:55], s73 offen lds
    s_add_u32 m0, s75, 9216
    s_add_u32 s73, s72, 16384
    buffer_load_dwordx4 v5, s[52:55], s73 offen lds
    s_add_u32 s72, s69, 2
    s_and_b32 s72, s72, 3
    s_add_u32 s72, s72, 0
    s_lshl_b32 s72, s72, 17
    s_add_u32 m0, s75, 16384
    s_add_u32 s73, s72, 0
    buffer_load_dwordx4 v5, s[52:55], s73 offen lds
    s_add_u32 m0, s75, 17408
    s_add_u32 s73, s72, 16384
    buffer_load_dwordx4 v5, s[52:55], s73 offen lds
    s_add_u32 s72, s69, 3
    s_and_b32 s72, s72, 3
    s_add_u32 s72, s72, 0
    s_lshl_b32 s72, s72, 17
    s_add_u32 m0, s75, 24576
    s_add_u32 s73, s72, 0
    buffer_load_dwordx4 v5, s[52:55], s73 offen lds
    s_add_u32 m0, s75, 25600
    s_add_u32 s73, s72, 16384
    buffer_load_dwordx4 v5, s[52:55], s73 offen lds
    s_add_u32 s72, s69, 4
    s_and_b32 s72, s72, 3
    s_add_u32 s72, s72, 4
    s_lshl_b32 s72, s72, 17
    s_add_u32 m0, s75, 32768
    s_add_u32 s73, s72, 0
    buffer_load_dwordx4 v5, s[52:55], s73 offen lds
    s_add_u32 m0, s75, 33792
    s_add_u32 s73, s72, 16384
    buffer_load_dwordx4 v5, s[52:55], s73 offen lds
    v_mov_b32 v60, 163584
    v_mov_b32 v61, 1
    s_cmp_eq_u32 s74, 0
    s_cbranch_scc0 Lupoll_50
    s_mov_b64 exec, 15
    s_mov_b32 s88, 0
Lpoll_51:
    v_mov_b32 v12, 0
    buffer_atomic_add v12, v241, s[44:47], 0 offen sc0 sc1
    s_add_u32 s88, s88, 1
    s_waitcnt vmcnt(0)
    v_cmp_gt_u32 vcc, 16, v12
    s_cmp_ge_u32 s88, 262144
    s_cbranch_scc1 Lpdone_52
    s_cbranch_vccz Lpdone_52
    s_sleep 2
    s_branch Lpoll_51
Lpdone_52:
    s_mov_b64 exec, -1
    ds_write_b32 v60, v61 offset:80
Lupoll_50:
    s_mov_b32 s88, 0
Lpair_53:
    ds_read_b32 v58, v60 offset:80
    s_add_u32 s88, s88, 1
    s_cmp_ge_u32 s88, 2097152
    s_waitcnt lgkmcnt(0)
    v_cmp_eq_u32 vcc, 0, v58
    s_cbranch_scc1 Lpaird_54
    s_nop 0
    s_cbranch_vccz Lpaird_54
    s_sleep 1
    s_branch Lpair_53
Lpaird_54:
    s_mov_b32 s73, 0
    buffer_load_dwordx4 v[224:227], v246, s[44:47], s73 offen sc1
    s_mov_b32 s73, 65536
    buffer_load_dwordx4 v[228:231], v246, s[44:47], s73 offen sc1
    s_mov_b32 s73, 131072
    buffer_load_dwordx4 v[232:235], v246, s[44:47], s73 offen sc1
    s_mov_b32 s73, 196608
    buffer_load_dwordx4 v[236:239], v246, s[44:47], s73 offen sc1
    s_waitcnt vmcnt(3)
    ds_write_b128 v247, v[224:227] offset:0
    s_waitcnt vmcnt(2)
    ds_write_b128 v247, v[228:231] offset:1024
    s_waitcnt vmcnt(1)
    ds_write_b128 v247, v[232:235] offset:2048
    s_waitcnt vmcnt(0)
    ds_write_b128 v247, v[236:239] offset:3072
    s_mov_b32 s88, 0
Lpair_55:
    ds_read_b32 v58, v57 offset:128
    s_add_u32 s88, s88, 1
    s_cmp_ge_u32 s88, 2097152
    s_waitcnt lgkmcnt(0)
    v_cmp_eq_u32 vcc, 0, v58
    s_cbranch_scc1 Lpaird_56
    s_nop 0
    s_cbranch_vccz Lpaird_56
    s_sleep 1
    s_branch Lpair_55
Lpaird_56:
    s_add_u32 s72, s69, 13
    s_and_b32 s72, s72, 3
    s_add_u32 s72, s72, 12
    s_lshl_b32 s72, s72, 17
    s_add_u32 m0, s75, 106496
    s_add_u32 s73, s72, 0
    buffer_load_dwordx4 v5, s[52:55], s73 offen lds
    s_add_u32 m0, s75, 107520
    s_add_u32 s73, s72, 16384
    buffer_load_dwordx4 v5, s[52:55], s73 offen lds
    s_add_u32 s72, s69, 14
    s_and_b32 s72, s72, 3
    s_add_u32 s72, s72, 12
    s_lshl_b32 s72, s72, 17
    s_add_u32 m0, s75, 114688
    s_add_u32 s73, s72, 0
    buffer_load_dwordx4 v5, s[52:55], s73 offen lds
    s_add_u32 m0, s75, 115712
    s_add_u32 s73, s72, 16384
    buffer_load_dwordx4 v5, s[52:55], s73 offen lds
    v_lshlrev_b32 v26, 16, v26
    s_mov_b32 s88, 0
Lpair_57:
    ds_read_b32 v58, v59 offset:32
    s_add_u32 s88, s88, 1
    s_cmp_ge_u32 s88, 2097152
    s_waitcnt lgkmcnt(0)
    v_cmp_eq_u32 vcc, 0, v58
    s_cbranch_scc1 Lpaird_58
    s_nop 0
    s_cbranch_vccz Lpaird_58
    s_sleep 2
    s_branch Lpair_57
Lpaird_58:
    s_setprio 1
    ds_read2_b32 v[192:193], v30 offset0:27 offset1:26
    ds_read2_b32 v[194:195], v30 offset0:25 offset1:24
    v_add_u32 v34, 416, v28
    v_max_u32 v34, v34, v29
    ds_read_b128 v[160:163], v34
    ds_read_b128 v[164:167], v28 offset:928
    ds_read2_b32 v[196:197], v30 offset0:155 offset1:154
    ds_read2_b32 v[198:199], v30 offset0:153 offset1:152
    ds_read_b128 v[168:171], v28 offset:1440
    ds_read_b128 v[172:175], v28 offset:1952
    ds_read_b128 v[176:179], v28 offset:2464
    ds_read_b128 v[180:183], v28 offset:2976
    ds_read_b128 v[184:187], v28 offset:3488
    ds_read_b128 v[188:191], v28 offset:4000
    s_waitcnt lgkmcnt(0)
    v_mfma_f32_16x16x32_bf16 v[96:99], v[192:195], v[160:163], v[96:99]
    ds_read2_b32 v[232:233], v30 offset0:43 offset1:42
    v_mfma_f32_16x16x32_bf16 v[100:103], v[192:195], v[164:167], v[100:103]
    ds_read2_b32 v[234:235], v30 offset0:41 offset1:40
    v_mfma_f32_16x16x32_bf16 v[100:103], v[196:199], v[160:163], v[100:103]
    v_add_u32 v35, 352, v28
    v_mfma_f32_16x16x32_bf16 v[104:107], v[192:195], v[168:171], v[104:107]
    v_max_u32 v35, v35, v29
    v_mfma_f32_16x16x32_bf16 v[104:107], v[196:199], v[164:167], v[104:107]
    ds_read_b128 v[200:203], v35
    v_mfma_f32_16x16x32_bf16 v[108:111], v[192:195], v[172:175], v[108:111]
    ds_read_b128 v[204:207], v28 offset:864
    v_mfma_f32_16x16x32_bf16 v[108:111], v[196:199], v[168:171], v[108:111]
    ds_read2_b32 v[236:237], v30 offset0:171 offset1:170
    v_mfma_f32_16x16x32_bf16 v[112:115], v[192:195], v[176:179], v[112:115]
    ds_read2_b32 v[238:239], v30 offset0:169 offset1:168
    v_mfma_f32_16x16x32_bf16 v[112:115], v[196:199], v[172:175], v[112:115]
    ds_read_b128 v[208:211], v28 offset:1376
    v_mfma_f32_16x16x32_bf16 v[116:119], v[192:195], v[180:183], v[116:119]
    ds_read_b128 v[212:215], v28 offset:1888
    v_mfma_f32_16x16x32_bf16 v[116:119], v[196:199], v[176:179], v[116:119]
    ds_read_b128 v[216:219], v28 offset:2400
    v_mfma_f32_16x16x32_bf16 v[120:123], v[192:195], v[184:187], v[120:123]
    ds_read_b128 v[220:223], v28 offset:2912
    v_mfma_f32_16x16x32_bf16 v[120:123], v[196:199], v[180:183], v[120:123]
    ds_read_b128 v[224:227], v28 offset:3424
    v_mfma_f32_16x16x32_bf16 v[124:127], v[192:195], v[188:191], v[124:127]
    ds_read_b128 v[228:231], v28 offset:3936
    v_mfma_f32_16x16x32_bf16 v[124:127], v[196:199], v[184:187], v[124:127]
    s_waitcnt lgkmcnt(0)
    v_mfma_f32_16x16x32_bf16 v[96:99], v[232:235], v[200:203], v[96:99]
    ds_read2_b32 v[192:193], v30 offset0:59 offset1:58
    v_mfma_f32_16x16x32_bf16 v[100:103], v[232:235], v[204:207], v[100:103]
    ds_read2_b32 v[194:195], v30 offset0:57 offset1:56
    v_mfma_f32_16x16x32_bf16 v[100:103], v[236:239], v[200:203], v[100:103]
    v_add_u32 v34, 288, v28
    v_mfma_f32_16x16x32_bf16 v[104:107], v[232:235], v[208:211], v[104:107]
    v_max_u32 v34, v34, v29
    v_mfma_f32_16x16x32_bf16 v[104:107], v[236:239], v[204:207], v[104:107]
    ds_read_b128 v[160:163], v34
    v_mfma_f32_16x16x32_bf16 v[108:111], v[232:235], v[212:215], v[108:111]
    ds_read_b128 v[164:167], v28 offset:800
    v_mfma_f32_16x16x32_bf16 v[108:111], v[236:239], v[208:211], v[108:111]
    ds_read2_b32 v[196:197], v30 offset0:187 offset1:186
    v_mfma_f32_16x16x32_bf16 v[112:115], v[232:235], v[216:219], v[112:115]
    ds_read2_b32 v[198:199], v30 offset0:185 offset1:184
    v_mfma_f32_16x16x32_bf16 v[112:115], v[236:239], v[212:215], v[112:115]
    ds_read_b128 v[168:171], v28 offset:1312
    v_mfma_f32_16x16x32_bf16 v[116:119], v[232:235], v[220:223], v[116:119]
    ds_read_b128 v[172:175], v28 offset:1824
    v_mfma_f32_16x16x32_bf16 v[116:119], v[236:239], v[216:219], v[116:119]
    ds_read_b128 v[176:179], v28 offset:2336
    v_mfma_f32_16x16x32_bf16 v[120:123], v[232:235], v[224:227], v[120:123]
    ds_read_b128 v[180:183], v28 offset:2848
    v_mfma_f32_16x16x32_bf16 v[120:123], v[236:239], v[220:223], v[120:123]
    ds_read_b128 v[184:187], v28 offset:3360
    v_mfma_f32_16x16x32_bf16 v[124:127], v[232:235], v[228:231], v[124:127]
    ds_read_b128 v[188:191], v28 offset:3872
    v_mfma_f32_16x16x32_bf16 v[124:127], v[236:239], v[224:227], v[124:127]
    s_waitcnt lgkmcnt(0)
    v_mfma_f32_16x16x32_bf16 v[96:99], v[192:195], v[160:163], v[96:99]
    ds_read2_b32 v[232:233], v30 offset0:75 offset1:74
    v_mfma_f32_16x16x32_bf16 v[100:103], v[192:195], v[164:167], v[100:103]
    ds_read2_b32 v[234:235], v30 offset0:73 offset1:72
    v_mfma_f32_16x16x32_bf16 v[100:103], v[196:199], v[160:163], v[100:103]
    v_add_u32 v35, 224, v28
    v_mfma_f32_16x16x32_bf16 v[104:107], v[192:195], v[168:171], v[104:107]
    v_max_u32 v35, v35, v29
    v_mfma_f32_16x16x32_bf16 v[104:107], v[196:199], v[164:167], v[104:107]
    ds_read_b128 v[200:203], v35
    v_mfma_f32_16x16x32_bf16 v[108:111], v[192:195], v[172:175], v[108:111]
    ds_read_b128 v[204:207], v28 offset:736
    v_mfma_f32_16x16x32_bf16 v[108:111], v[196:199], v[168:171], v[108:111]
    ds_read2_b32 v[236:237], v30 offset0:203 offset1:202
    v_mfma_f32_16x16x32_bf16 v[112:115], v[192:195], v[176:179], v[112:115]
    ds_read2_b32 v[238:239], v30 offset0:201 offset1:200
    v_mfma_f32_16x16x32_bf16 v[112:115], v[196:199], v[172:175], v[112:115]
    ds_read_b128 v[208:211], v28 offset:1248
    v_mfma_f32_16x16x32_bf16 v[116:119], v[192:195], v[180:183], v[116:119]
    ds_read_b128 v[212:215], v28 offset:1760
    v_mfma_f32_16x16x32_bf16 v[116:119], v[196:199], v[176:179], v[116:119]
    ds_read_b128 v[216:219], v28 offset:2272
    v_mfma_f32_16x16x32_bf16 v[120:123], v[192:195], v[184:187], v[120:123]
    ds_read_b128 v[220:223], v28 offset:2784
    v_mfma_f32_16x16x32_bf16 v[120:123], v[196:199], v[180:183], v[120:123]
    ds_read_b128 v[224:227], v28 offset:3296
    v_mfma_f32_16x16x32_bf16 v[124:127], v[192:195], v[188:191], v[124:127]
    ds_read_b128 v[228:231], v28 offset:3808
    v_mfma_f32_16x16x32_bf16 v[124:127], v[196:199], v[184:187], v[124:127]
    s_waitcnt lgkmcnt(0)
    v_mfma_f32_16x16x32_bf16 v[96:99], v[232:235], v[200:203], v[96:99]
    ds_read2_b32 v[192:193], v30 offset0:91 offset1:90
    v_mfma_f32_16x16x32_bf16 v[100:103], v[232:235], v[204:207], v[100:103]
    ds_read2_b32 v[194:195], v30 offset0:89 offset1:88
    v_mfma_f32_16x16x32_bf16 v[100:103], v[236:239], v[200:203], v[100:103]
    v_add_u32 v34, 160, v28
    v_mfma_f32_16x16x32_bf16 v[104:107], v[232:235], v[208:211], v[104:107]
    v_max_u32 v34, v34, v29
    v_mfma_f32_16x16x32_bf16 v[104:107], v[236:239], v[204:207], v[104:107]
    ds_read_b128 v[160:163], v34
    v_mfma_f32_16x16x32_bf16 v[108:111], v[232:235], v[212:215], v[108:111]
    ds_read_b128 v[164:167], v28 offset:672
    v_mfma_f32_16x16x32_bf16 v[108:111], v[236:239], v[208:211], v[108:111]
    ds_read2_b32 v[196:197], v30 offset0:219 offset1:218
    v_mfma_f32_16x16x32_bf16 v[112:115], v[232:235], v[216:219], v[112:115]
    ds_read2_b32 v[198:199], v30 offset0:217 offset1:216
    v_mfma_f32_16x16x32_bf16 v[112:115], v[236:239], v[212:215], v[112:115]
    ds_read_b128 v[168:171], v28 offset:1184
    v_mfma_f32_16x16x32_bf16 v[116:119], v[232:235], v[220:223], v[116:119]
    ds_read_b128 v[172:175], v28 offset:1696
    v_mfma_f32_16x16x32_bf16 v[116:119], v[236:239], v[216:219], v[116:119]
    ds_read_b128 v[176:179], v28 offset:2208
    v_mfma_f32_16x16x32_bf16 v[120:123], v[232:235], v[224:227], v[120:123]
    ds_read_b128 v[180:183], v28 offset:2720
    v_mfma_f32_16x16x32_bf16 v[120:123], v[236:239], v[220:223], v[120:123]
    ds_read_b128 v[184:187], v28 offset:3232
    v_mfma_f32_16x16x32_bf16 v[124:127], v[232:235], v[228:231], v[124:127]
    ds_read_b128 v[188:191], v28 offset:3744
    v_mfma_f32_16x16x32_bf16 v[124:127], v[236:239], v[224:227], v[124:127]
    s_waitcnt vmcnt(0)
    ds_write_b32 v59, v244 offset:112
    s_waitcnt lgkmcnt(0)
    v_mfma_f32_16x16x32_bf16 v[96:99], v[192:195], v[160:163], v[96:99]
    ds_read2_b32 v[232:233], v30 offset0:107 offset1:106
    v_mfma_f32_16x16x32_bf16 v[100:103], v[192:195], v[164:167], v[100:103]
    ds_read2_b32 v[234:235], v30 offset0:105 offset1:104
    v_mfma_f32_16x16x32_bf16 v[100:103], v[196:199], v[160:163], v[100:103]
    v_add_u32 v35, 96, v28
    v_mfma_f32_16x16x32_bf16 v[104:107], v[192:195], v[168:171], v[104:107]
    v_max_u32 v35, v35, v29
    v_mfma_f32_16x16x32_bf16 v[104:107], v[196:199], v[164:167], v[104:107]
    ds_read_b128 v[200:203], v35
    v_mfma_f32_16x16x32_bf16 v[108:111], v[192:195], v[172:175], v[108:111]
    ds_read_b128 v[204:207], v28 offset:608
    v_mfma_f32_16x16x32_bf16 v[108:111], v[196:199], v[168:171], v[108:111]
    ds_read2_b32 v[236:237], v30 offset0:235 offset1:234
    v_mfma_f32_16x16x32_bf16 v[112:115], v[192:195], v[176:179], v[112:115]
    ds_read2_b32 v[238:239], v30 offset0:233 offset1:232
    v_mfma_f32_16x16x32_bf16 v[112:115], v[196:199], v[172:175], v[112:115]
    ds_read_b128 v[208:211], v28 offset:1120
    v_mfma_f32_16x16x32_bf16 v[116:119], v[192:195], v[180:183], v[116:119]
    ds_read_b128 v[212:215], v28 offset:1632
    v_mfma_f32_16x16x32_bf16 v[116:119], v[196:199], v[176:179], v[116:119]
    ds_read_b128 v[216:219], v28 offset:2144
    v_mfma_f32_16x16x32_bf16 v[120:123], v[192:195], v[184:187], v[120:123]
    ds_read_b128 v[220:223], v28 offset:2656
    v_mfma_f32_16x16x32_bf16 v[120:123], v[196:199], v[180:183], v[120:123]
    ds_read_b128 v[224:227], v28 offset:3168
    v_mfma_f32_16x16x32_bf16 v[124:127], v[192:195], v[188:191], v[124:127]
    ds_read_b128 v[228:231], v28 offset:3680
    v_mfma_f32_16x16x32_bf16 v[124:127], v[196:199], v[184:187], v[124:127]
    s_waitcnt lgkmcnt(0)
    v_mfma_f32_16x16x32_bf16 v[96:99], v[232:235], v[200:203], v[96:99]
    ds_read2_b32 v[192:193], v30 offset0:123 offset1:122
    v_mfma_f32_16x16x32_bf16 v[100:103], v[232:235], v[204:207], v[100:103]
    ds_read2_b32 v[194:195], v30 offset0:121 offset1:120
    v_mfma_f32_16x16x32_bf16 v[100:103], v[236:239], v[200:203], v[100:103]
    v_add_u32 v34, 32, v28
    v_mfma_f32_16x16x32_bf16 v[104:107], v[232:235], v[208:211], v[104:107]
    v_max_u32 v34, v34, v29
    v_mfma_f32_16x16x32_bf16 v[104:107], v[236:239], v[204:207], v[104:107]
    ds_read_b128 v[160:163], v34
    v_mfma_f32_16x16x32_bf16 v[108:111], v[232:235], v[212:215], v[108:111]
    ds_read_b128 v[164:167], v28 offset:544
    v_mfma_f32_16x16x32_bf16 v[108:111], v[236:239], v[208:211], v[108:111]
    ds_read2_b32 v[196:197], v30 offset0:251 offset1:250
    v_mfma_f32_16x16x32_bf16 v[112:115], v[232:235], v[216:219], v[112:115]
    ds_read2_b32 v[198:199], v30 offset0:249 offset1:248
    v_mfma_f32_16x16x32_bf16 v[112:115], v[236:239], v[212:215], v[112:115]
    ds_read_b128 v[168:171], v28 offset:1056
    v_mfma_f32_16x16x32_bf16 v[116:119], v[232:235], v[220:223], v[116:119]
    ds_read_b128 v[172:175], v28 offset:1568
    v_mfma_f32_16x16x32_bf16 v[116:119], v[236:239], v[216:219], v[116:119]
    ds_read_b128 v[176:179], v28 offset:2080
    v_mfma_f32_16x16x32_bf16 v[120:123], v[232:235], v[224:227], v[120:123]
    ds_read_b128 v[180:183], v28 offset:2592
    v_mfma_f32_16x16x32_bf16 v[120:123], v[236:239], v[220:223], v[120:123]
    ds_read_b128 v[184:187], v28 offset:3104
    v_mfma_f32_16x16x32_bf16 v[124:127], v[232:235], v[228:231], v[124:127]
    ds_read_b128 v[188:191], v28 offset:3616
    v_mfma_f32_16x16x32_bf16 v[124:127], v[236:239], v[224:227], v[124:127]
    s_waitcnt lgkmcnt(0)
    v_mfma_f32_16x16x32_bf16 v[96:99], v[192:195], v[160:163], v[96:99]
    ds_read2_b32 v[232:233], v30 offset0:11 offset1:10
    v_mfma_f32_16x16x32_bf16 v[100:103], v[192:195], v[164:167], v[100:103]
    ds_read2_b32 v[234:235], v30 offset0:9 offset1:8
    v_mfma_f32_16x16x32_bf16 v[100:103], v[196:199], v[160:163], v[100:103]
    v_add_u32 v35, 480, v28
    v_mfma_f32_16x16x32_bf16 v[104:107], v[192:195], v[168:171], v[104:107]
    v_max_u32 v35, v35, v29
    v_mfma_f32_16x16x32_bf16 v[104:107], v[196:199], v[164:167], v[104:107]
    ds_read_b128 v[200:203], v35
    v_mfma_f32_16x16x32_bf16 v[108:111], v[192:195], v[172:175], v[108:111]
    ds_read_b128 v[204:207], v28 offset:992
    v_mfma_f32_16x16x32_bf16 v[108:111], v[196:199], v[168:171], v[108:111]
    ds_read2_b32 v[236:237], v30 offset0:139 offset1:138
    v_mfma_f32_16x16x32_bf16 v[112:115], v[192:195], v[176:179], v[112:115]
    ds_read2_b32 v[238:239], v30 offset0:137 offset1:136
    v_mfma_f32_16x16x32_bf16 v[112:115], v[196:199], v[172:175], v[112:115]
    ds_read_b128 v[208:211], v28 offset:1504
    v_mfma_f32_16x16x32_bf16 v[116:119], v[192:195], v[180:183], v[116:119]
    ds_read_b128 v[212:215], v28 offset:2016
    v_mfma_f32_16x16x32_bf16 v[116:119], v[196:199], v[176:179], v[116:119]
    ds_read_b128 v[216:219], v28 offset:2528
    v_mfma_f32_16x16x32_bf16 v[120:123], v[192:195], v[184:187], v[120:123]
    ds_read_b128 v[220:223], v28 offset:3040
    v_mfma_f32_16x16x32_bf16 v[120:123], v[196:199], v[180:183], v[120:123]
    ds_read_b128 v[224:227], v28 offset:3552
    v_mfma_f32_16x16x32_bf16 v[124:127], v[192:195], v[188:191], v[124:127]
    ds_read_b128 v[228:231], v28 offset:4064
    v_mfma_f32_16x16x32_bf16 v[124:127], v[196:199], v[184:187], v[124:127]
    s_waitcnt lgkmcnt(0)
    v_mfma_f32_16x16x32_bf16 v[96:99], v[232:235], v[200:203], v[96:99]
    v_mfma_f32_16x16x32_bf16 v[100:103], v[232:235], v[204:207], v[100:103]
    v_mfma_f32_16x16x32_bf16 v[100:103], v[236:239], v[200:203], v[100:103]
    v_mfma_f32_16x16x32_bf16 v[104:107], v[232:235], v[208:211], v[104:107]
    v_mfma_f32_16x16x32_bf16 v[104:107], v[236:239], v[204:207], v[104:107]
    v_mfma_f32_16x16x32_bf16 v[108:111], v[232:235], v[212:215], v[108:111]
    v_mfma_f32_16x16x32_bf16 v[108:111], v[236:239], v[208:211], v[108:111]
    v_mfma_f32_16x16x32_bf16 v[112:115], v[232:235], v[216:219], v[112:115]
    v_mfma_f32_16x16x32_bf16 v[112:115], v[236:239], v[212:215], v[112:115]
    v_mfma_f32_16x16x32_bf16 v[116:119], v[232:235], v[220:223], v[116:119]
    v_mfma_f32_16x16x32_bf16 v[116:119], v[236:239], v[216:219], v[116:119]
    v_mfma_f32_16x16x32_bf16 v[120:123], v[232:235], v[224:227], v[120:123]
    v_mfma_f32_16x16x32_bf16 v[120:123], v[236:239], v[220:223], v[120:123]
    v_mfma_f32_16x16x32_bf16 v[124:127], v[232:235], v[228:231], v[124:127]
    v_mfma_f32_16x16x32_bf16 v[124:127], v[236:239], v[224:227], v[124:127]
    ds_read2_b32 v[184:185], v31 offset0:11 offset1:10
    ds_read2_b32 v[186:187], v31 offset0:9 offset1:8
    ds_read2_b32 v[188:189], v31 offset0:35 offset1:34
    ds_read2_b32 v[190:191], v31 offset0:33 offset1:32
    v_add_u32 v36, 464, v28
    v_max_u32 v36, v36, v29
    ds_read_b128 v[160:163], v36
    ds_read_b128 v[164:167], v28 offset:976
    ds_read_b128 v[168:171], v28 offset:1488
    ds_read_b128 v[172:175], v28 offset:2000
    ds_read_b128 v[176:179], v28 offset:2512
    ds_read_b128 v[180:183], v28 offset:3024
    ds_read2_b32 v[40:41], v32 offset0:6 offset1:4
    ds_read2_b32 v[42:43], v32 offset0:2 offset1:0
    ds_read2_b32 v[44:45], v32 offset0:38 offset1:36
    ds_read2_b32 v[46:47], v32 offset0:34 offset1:32
    ds_read2_b32 v[48:49], v32 offset0:70 offset1:68
    ds_read2_b32 v[50:51], v32 offset0:66 offset1:64
    ds_read2_b32 v[52:53], v32 offset0:7 offset1:5
    ds_read2_b32 v[54:55], v32 offset0:3 offset1:1
    ds_read2_b32 v[56:57], v32 offset0:39 offset1:37
    ds_read2_b32 v[58:59], v32 offset0:35 offset1:33
    ds_read2_b32 v[60:61], v32 offset0:71 offset1:69
    ds_read2_b32 v[62:63], v32 offset0:67 offset1:65
    s_waitcnt lgkmcnt(12)
    v_mfma_f32_16x16x32_bf16 v[104:107], v[184:187], v[200:203], v[104:107]
    v_mfma_f32_16x16x32_bf16 v[108:111], v[184:187], v[204:207], v[108:111]
    v_mfma_f32_16x16x32_bf16 v[112:115], v[184:187], v[208:211], v[112:115]
    v_mfma_f32_16x16x32_bf16 v[116:119], v[184:187], v[212:215], v[116:119]
    v_mfma_f32_16x16x32_bf16 v[120:123], v[184:187], v[216:219], v[120:123]
    v_mfma_f32_16x16x32_bf16 v[124:127], v[184:187], v[220:223], v[124:127]
    ds_read2_b32 v[64:65], v33 offset0:3 offset1:2
    ds_read2_b32 v[66:67], v33 offset0:1 offset1:0
    ds_read2_b32 v[68:69], v33 offset0:19 offset1:18
    ds_read2_b32 v[70:71], v33 offset0:17 offset1:16
    ds_read2_b32 v[72:73], v33 offset0:35 offset1:34
    ds_read2_b32 v[74:75], v33 offset0:33 offset1:32
    ds_read2_b32 v[76:77], v33 offset0:51 offset1:50
    ds_read2_b32 v[78:79], v33 offset0:49 offset1:48
    v_mfma_f32_16x16x32_bf16 v[112:115], v[188:191], v[200:203], v[112:115]
    v_mfma_f32_16x16x32_bf16 v[116:119], v[188:191], v[204:207], v[116:119]
    v_mfma_f32_16x16x32_bf16 v[120:123], v[188:191], v[208:211], v[120:123]
    v_mfma_f32_16x16x32_bf16 v[124:127], v[188:191], v[212:215], v[124:127]
    s_waitcnt lgkmcnt(0)
    v_mfma_f32_16x16x32_bf16 v[152:155], v[200:203], v[128:131], 0
    v_mfma_f32_16x16x32_bf16 v[156:159], v[200:203], v[132:135], 0
    v_mfma_f32_16x16x32_bf16 v[192:195], v[160:163], v[136:139], 0
    v_mfma_f32_16x16x32_bf16 v[196:199], v[160:163], v[140:143], 0
    s_nop 5
    v_cvt_pk_bf16_f32 v184, v152, v156
    v_cvt_pk_bf16_f32 v185, v153, v157
    v_cvt_pk_bf16_f32 v186, v154, v158
    v_cvt_pk_bf16_f32 v187, v155, v159
    v_mfma_f32_16x16x32_bf16 v[152:155], v[200:203], v[144:147], 0
    v_mfma_f32_16x16x32_bf16 v[156:159], v[160:163], v[148:151], 0
    v_mfma_f32_16x16x32_bf16 v[104:107], v[184:187], v[40:43], v[104:107]
    v_mfma_f32_16x16x32_bf16 v[108:111], v[184:187], v[44:47], v[108:111]
    v_mfma_f32_16x16x32_bf16 v[112:115], v[184:187], v[48:51], v[112:115]
    v_cvt_pk_bf16_f32 v188, v192, v196
    v_cvt_pk_bf16_f32 v189, v193, v197
    v_cvt_pk_bf16_f32 v190, v194, v198
    v_cvt_pk_bf16_f32 v191, v195, v199
    v_mfma_f32_16x16x32_bf16 v[192:195], v[204:207], v[128:131], 0
    v_mfma_f32_16x16x32_bf16 v[196:199], v[204:207], v[132:135], 0
    v_mfma_f32_16x16x32_bf16 v[104:107], v[188:191], v[52:55], v[104:107]
    v_mfma_f32_16x16x32_bf16 v[108:111], v[188:191], v[56:59], v[108:111]
    v_mfma_f32_16x16x32_bf16 v[112:115], v[188:191], v[60:63], v[112:115]
    v_cvt_pk_bf16_f32 v184, v152, v156
    v_cvt_pk_bf16_f32 v185, v153, v157
    v_cvt_pk_bf16_f32 v186, v154, v158
    v_cvt_pk_bf16_f32 v187, v155, v159
    v_mfma_f32_16x16x32_bf16 v[152:155], v[164:167], v[136:139], 0
    v_mfma_f32_16x16x32_bf16 v[156:159], v[164:167], v[140:143], 0
    v_mfma_f32_16x16x32_bf16 v[112:115], v[184:187], v[64:67], v[112:115]
    v_mfma_f32_16x16x32_bf16 v[116:119], v[184:187], v[68:71], v[116:119]
    v_mfma_f32_16x16x32_bf16 v[120:123], v[184:187], v[72:75], v[120:123]
    v_mfma_f32_16x16x32_bf16 v[124:127], v[184:187], v[76:79], v[124:127]
    v_cvt_pk_bf16_f32 v188, v192, v196
    v_cvt_pk_bf16_f32 v189, v193, v197
    v_cvt_pk_bf16_f32 v190, v194, v198
    v_cvt_pk_bf16_f32 v191, v195, v199
    v_mfma_f32_16x16x32_bf16 v[192:195], v[204:207], v[144:147], 0
    v_mfma_f32_16x16x32_bf16 v[196:199], v[164:167], v[148:151], 0
    v_mfma_f32_16x16x32_bf16 v[108:111], v[188:191], v[40:43], v[108:111]
    v_mfma_f32_16x16x32_bf16 v[112:115], v[188:191], v[44:47], v[112:115]
    v_mfma_f32_16x16x32_bf16 v[116:119], v[188:191], v[48:51], v[116:119]
    v_cvt_pk_bf16_f32 v184, v152, v156
    v_cvt_pk_bf16_f32 v185, v153, v157
    v_cvt_pk_bf16_f32 v186, v154, v158
    v_cvt_pk_bf16_f32 v187, v155, v159
    v_mfma_f32_16x16x32_bf16 v[152:155], v[208:211], v[128:131], 0
    v_mfma_f32_16x16x32_bf16 v[156:159], v[208:211], v[132:135], 0
    v_mfma_f32_16x16x32_bf16 v[108:111], v[184:187], v[52:55], v[108:111]
    v_mfma_f32_16x16x32_bf16 v[112:115], v[184:187], v[56:59], v[112:115]
    v_mfma_f32_16x16x32_bf16 v[116:119], v[184:187], v[60:63], v[116:119]
    v_cvt_pk_bf16_f32 v188, v192, v196
    v_cvt_pk_bf16_f32 v189, v193, v197
    v_cvt_pk_bf16_f32 v190, v194, v198
    v_cvt_pk_bf16_f32 v191, v195, v199
    v_mfma_f32_16x16x32_bf16 v[192:195], v[168:171], v[136:139], 0
    v_mfma_f32_16x16x32_bf16 v[196:199], v[168:171], v[140:143], 0
    v_mfma_f32_16x16x32_bf16 v[116:119], v[188:191], v[64:67], v[116:119]
    v_mfma_f32_16x16x32_bf16 v[120:123], v[188:191], v[68:71], v[120:123]
    v_mfma_f32_16x16x32_bf16 v[124:127], v[188:191], v[72:75], v[124:127]
    v_cvt_pk_bf16_f32 v184, v152, v156
    v_cvt_pk_bf16_f32 v185, v153, v157
    v_cvt_pk_bf16_f32 v186, v154, v158
    v_cvt_pk_bf16_f32 v187, v155, v159
    v_mfma_f32_16x16x32_bf16 v[152:155], v[208:211], v[144:147], 0
    v_mfma_f32_16x16x32_bf16 v[156:159], v[168:171], v[148:151], 0
    v_mfma_f32_16x16x32_bf16 v[112:115], v[184:187], v[40:43], v[112:115]
    v_mfma_f32_16x16x32_bf16 v[116:119], v[184:187], v[44:47], v[116:119]
    v_mfma_f32_16x16x32_bf16 v[120:123], v[184:187], v[48:51], v[120:123]
    v_cvt_pk_bf16_f32 v188, v192, v196
    v_cvt_pk_bf16_f32 v189, v193, v197
    v_cvt_pk_bf16_f32 v190, v194, v198
    v_cvt_pk_bf16_f32 v191, v195, v199
    v_mfma_f32_16x16x32_bf16 v[192:195], v[212:215], v[128:131], 0
    v_mfma_f32_16x16x32_bf16 v[196:199], v[212:215], v[132:135], 0
    v_mfma_f32_16x16x32_bf16 v[112:115], v[188:191], v[52:55], v[112:115]
    v_mfma_f32_16x16x32_bf16 v[116:119], v[188:191], v[56:59], v[116:119]
    v_mfma_f32_16x16x32_bf16 v[120:123], v[188:191], v[60:63], v[120:123]
    v_cvt_pk_bf16_f32 v184, v152, v156
    v_cvt_pk_bf16_f32 v185, v153, v157
    v_cvt_pk_bf16_f32 v186, v154, v158
    v_cvt_pk_bf16_f32 v187, v155, v159
    v_mfma_f32_16x16x32_bf16 v[152:155], v[172:175], v[136:139], 0
    v_mfma_f32_16x16x32_bf16 v[156:159], v[172:175], v[140:143], 0
    v_mfma_f32_16x16x32_bf16 v[120:123], v[184:187], v[64:67], v[120:123]
    v_mfma_f32_16x16x32_bf16 v[124:127], v[184:187], v[68:71], v[124:127]
    v_cvt_pk_bf16_f32 v188, v192, v196
    v_cvt_pk_bf16_f32 v189, v193, v197
    v_cvt_pk_bf16_f32 v190, v194, v198
    v_cvt_pk_bf16_f32 v191, v195, v199
    v_mfma_f32_16x16x32_bf16 v[192:195], v[212:215], v[144:147], 0
    v_mfma_f32_16x16x32_bf16 v[196:199], v[172:175], v[148:151], 0
    v_mfma_f32_16x16x32_bf16 v[116:119], v[188:191], v[40:43], v[116:119]
    v_mfma_f32_16x16x32_bf16 v[120:123], v[188:191], v[44:47], v[120:123]
    v_mfma_f32_16x16x32_bf16 v[124:127], v[188:191], v[48:51], v[124:127]
    v_cvt_pk_bf16_f32 v184, v152, v156
    v_cvt_pk_bf16_f32 v185, v153, v157
    v_cvt_pk_bf16_f32 v186, v154, v158
    v_cvt_pk_bf16_f32 v187, v155, v159
    v_mfma_f32_16x16x32_bf16 v[152:155], v[216:219], v[128:131], 0
    v_mfma_f32_16x16x32_bf16 v[156:159], v[216:219], v[132:135], 0
    v_mfma_f32_16x16x32_bf16 v[116:119], v[184:187], v[52:55], v[116:119]
    v_mfma_f32_16x16x32_bf16 v[120:123], v[184:187], v[56:59], v[120:123]
    v_mfma_f32_16x16x32_bf16 v[124:127], v[184:187], v[60:63], v[124:127]
    v_cvt_pk_bf16_f32 v188, v192, v196
    v_cvt_pk_bf16_f32 v189, v193, v197
    v_cvt_pk_bf16_f32 v190, v194, v198
    v_cvt_pk_bf16_f32 v191, v195, v199
    v_mfma_f32_16x16x32_bf16 v[192:195], v[176:179], v[136:139], 0
    v_mfma_f32_16x16x32_bf16 v[196:199], v[176:179], v[140:143], 0
    v_mfma_f32_16x16x32_bf16 v[124:127], v[188:191], v[64:67], v[124:127]
    v_cvt_pk_bf16_f32 v184, v152, v156
    v_cvt_pk_bf16_f32 v185, v153, v157
    v_cvt_pk_bf16_f32 v186, v154, v158
    v_cvt_pk_bf16_f32 v187, v155, v159
    v_mfma_f32_16x16x32_bf16 v[152:155], v[220:223], v[128:131], 0
    v_mfma_f32_16x16x32_bf16 v[156:159], v[220:223], v[132:135], 0
    v_mfma_f32_16x16x32_bf16 v[120:123], v[184:187], v[40:43], v[120:123]
    v_mfma_f32_16x16x32_bf16 v[124:127], v[184:187], v[44:47], v[124:127]
    v_cvt_pk_bf16_f32 v188, v192, v196
    v_cvt_pk_bf16_f32 v189, v193, v197
    v_cvt_pk_bf16_f32 v190, v194, v198
    v_cvt_pk_bf16_f32 v191, v195, v199
    v_mfma_f32_16x16x32_bf16 v[192:195], v[180:183], v[136:139], 0
    v_mfma_f32_16x16x32_bf16 v[196:199], v[180:183], v[140:143], 0
    v_mfma_f32_16x16x32_bf16 v[120:123], v[188:191], v[52:55], v[120:123]
    v_mfma_f32_16x16x32_bf16 v[124:127], v[188:191], v[56:59], v[124:127]
    v_cvt_pk_bf16_f32 v184, v152, v156
    v_cvt_pk_bf16_f32 v185, v153, v157
    v_cvt_pk_bf16_f32 v186, v154, v158
    v_cvt_pk_bf16_f32 v187, v155, v159
    s_nop 1
    v_mfma_f32_16x16x32_bf16 v[124:127], v[184:187], v[40:43], v[124:127]
    v_cvt_pk_bf16_f32 v188, v192, v196
    v_cvt_pk_bf16_f32 v189, v193, v197
    v_cvt_pk_bf16_f32 v190, v194, v198
    v_cvt_pk_bf16_f32 v191, v195, v199
    s_nop 1
    v_mfma_f32_16x16x32_bf16 v[124:127], v[188:191], v[52:55], v[124:127]
    v_lshrrev_b32 v41, 4, v1
    v_lshlrev_b32 v41, 3, v41
    v_sub_u32 v40, v28, v41
    ds_read_b64 v[160:161], v40 offset:512
    ds_read_b64 v[162:163], v40 offset:1024
    ds_read_b64 v[164:165], v40 offset:1536
    ds_read_b64 v[166:167], v40 offset:2048
    ds_read_b64 v[168:169], v40 offset:2560
    ds_read_b64 v[170:171], v40 offset:3072
    ds_read_b64 v[172:173], v40 offset:3584
    ds_read_b64 v[174:175], v40 offset:4096
    s_lshl_b32 s72, s86, 12
    s_add_u32 s72, s72, 4194304
    v_and_b32 v42, 15, v1
    v_lshlrev_b32 v42, 5, v42
    v_bfe_u32 v43, v1, 5, 1
    v_lshl_add_u32 v42, v43, 4, v42
    v_bfe_u32 v43, v1, 4, 1
    v_lshl_add_u32 v42, v43, 9, v42
    s_waitcnt lgkmcnt(7)
    v_lshlrev_b32 v44, 16, v160
    v_and_b32 v45, 0xffff0000, v160
    v_lshlrev_b32 v46, 16, v161
    v_and_b32 v47, 0xffff0000, v161
    v_fmac_f32 v96, v44, v26
    v_fmac_f32 v97, v45, v26
    v_fmac_f32 v98, v46, v26
    v_fmac_f32 v99, v47, v26
    v_cvt_pk_bf16_f32 v176, v96, v97
    v_cvt_pk_bf16_f32 v177, v98, v99
    s_waitcnt lgkmcnt(6)
    v_lshlrev_b32 v44, 16, v162
    v_and_b32 v45, 0xffff0000, v162
    v_lshlrev_b32 v46, 16, v163
    v_and_b32 v47, 0xffff0000, v163
    v_fmac_f32 v100, v44, v26
    v_fmac_f32 v101, v45, v26
    v_fmac_f32 v102, v46, v26
    v_fmac_f32 v103, v47, v26
    v_cvt_pk_bf16_f32 v178, v100, v101
    v_cvt_pk_bf16_f32 v179, v102, v103
    s_waitcnt lgkmcnt(5)
    v_lshlrev_b32 v44, 16, v164
    v_and_b32 v45, 0xffff0000, v164
    v_lshlrev_b32 v46, 16, v165
    v_and_b32 v47, 0xffff0000, v165
    v_fmac_f32 v104, v44, v26
    v_fmac_f32 v105, v45, v26
    v_fmac_f32 v106, v46, v26
    v_fmac_f32 v107, v47, v26
    v_cvt_pk_bf16_f32 v180, v104, v105
    v_cvt_pk_bf16_f32 v181, v106, v107
    s_waitcnt lgkmcnt(4)
    v_lshlrev_b32 v44, 16, v166
    v_and_b32 v45, 0xffff0000, v166
    v_lshlrev_b32 v46, 16, v167
    v_and_b32 v47, 0xffff0000, v167
    v_fmac_f32 v108, v44, v26
    v_fmac_f32 v109, v45, v26
    v_fmac_f32 v110, v46, v26
    v_fmac_f32 v111, v47, v26
    v_cvt_pk_bf16_f32 v182, v108, v109
    v_cvt_pk_bf16_f32 v183, v110, v111
    s_waitcnt lgkmcnt(3)
    v_lshlrev_b32 v44, 16, v168
    v_and_b32 v45, 0xffff0000, v168
    v_lshlrev_b32 v46, 16, v169
    v_and_b32 v47, 0xffff0000, v169
    v_fmac_f32 v112, v44, v26
    v_fmac_f32 v113, v45, v26
    v_fmac_f32 v114, v46, v26
    v_fmac_f32 v115, v47, v26
    v_cvt_pk_bf16_f32 v184, v112, v113
    v_cvt_pk_bf16_f32 v185, v114, v115
    s_waitcnt lgkmcnt(2)
    v_lshlrev_b32 v44, 16, v170
    v_and_b32 v45, 0xffff0000, v170
    v_lshlrev_b32 v46, 16, v171
    v_and_b32 v47, 0xffff0000, v171
    v_fmac_f32 v116, v44, v26
    v_fmac_f32 v117, v45, v26
    v_fmac_f32 v118, v46, v26
    v_fmac_f32 v119, v47, v26
    v_cvt_pk_bf16_f32 v186, v116, v117
    v_cvt_pk_bf16_f32 v187, v118, v119
    s_waitcnt lgkmcnt(1)
    v_lshlrev_b32 v44, 16, v172
    v_and_b32 v45, 0xffff0000, v172
    v_lshlrev_b32 v46, 16, v173
    v_and_b32 v47, 0xffff0000, v173
    v_fmac_f32 v120, v44, v26
    v_fmac_f32 v121, v45, v26
    v_fmac_f32 v122, v46, v26
    v_fmac_f32 v123, v47, v26
    v_cvt_pk_bf16_f32 v188, v120, v121
    v_cvt_pk_bf16_f32 v189, v122, v123
    s_waitcnt lgkmcnt(0)
    v_lshlrev_b32 v44, 16, v174
    v_and_b32 v45, 0xffff0000, v174
    v_lshlrev_b32 v46, 16, v175
    v_and_b32 v47, 0xffff0000, v175
    v_fmac_f32 v124, v44, v26
    v_fmac_f32 v125, v45, v26
    v_fmac_f32 v126, v46, v26
    v_fmac_f32 v127, v47, v26
    v_cvt_pk_bf16_f32 v190, v124, v125
    v_cvt_pk_bf16_f32 v191, v126, v127
    v_permlane16_swap_b32 v176, v178
    v_permlane16_swap_b32 v177, v179
    buffer_store_dwordx4 v[176:179], v42, s[44:47], s72 offen offset:0 sc1
    v_permlane16_swap_b32 v180, v182
    v_permlane16_swap_b32 v181, v183
    buffer_store_dwordx4 v[180:183], v42, s[44:47], s72 offen offset:1024 sc1
    v_permlane16_swap_b32 v184, v186
    v_permlane16_swap_b32 v185, v187
    buffer_store_dwordx4 v[184:187], v42, s[44:47], s72 offen offset:2048 sc1
    v_permlane16_swap_b32 v188, v190
    v_permlane16_swap_b32 v189, v191
    buffer_store_dwordx4 v[188:191], v42, s[44:47], s72 offen offset:3072 sc1
    s_mul_i32 s75, s74, 7424
    s_add_u32 s72, s69, 15
    s_and_b32 s72, s72, 3
    s_add_u32 s72, s72, 12
    s_lshl_b32 s72, s72, 17
    s_add_u32 m0, s75, 122880
    s_add_u32 s73, s72, 0
    buffer_load_dwordx4 v5, s[52:55], s73 offen lds
    s_add_u32 m0, s75, 123904
    s_add_u32 s73, s72, 16384
    buffer_load_dwordx4 v5, s[52:55], s73 offen lds
    s_waitcnt vmcnt(2)
    buffer_atomic_add v244, v242, s[44:47], 0 offen sc1
    s_lshl_b32 s72, s67, 10
    s_add_u32 s72, s72, 16809984
    v_lshl_add_u32 v13, v1, 8, s72
    v_lshrrev_b32 v12, 2, v1
    s_lshl_b32 s72, s67, 6
    v_add_u32 v12, s72, v12
    v_lshlrev_b32 v12, 12, v12
    v_and_b32 v14, 3, v1
    v_lshl_add_u32 v12, v14, 4, v12
    s_lshl_b32 s72, s66, 8
    s_lshl_b32 s73, s74, 6
    s_add_u32 s72, s72, s73
    v_add_u32 v12, s72, v12
    s_add_u32 s72, s75, 126160
    v_lshlrev_b32 v14, 4, v1
    v_add_u32 v14, s72, v14
    v_bfe_u32 v15, v1, 2, 2
    v_lshl_add_u32 v15, v8, 4, v15
    v_bfe_u32 v11, v1, 1, 1
    v_lshl_add_u32 v15, v11, 3, v15
    v_lshlrev_b32 v15, 6, v15
    v_and_b32 v11, 1, v1
    v_lshl_add_u32 v15, v11, 3, v15
    v_add_u32 v15, s72, v15
    s_lshl_b32 s72, s66, 7
    s_lshl_b32 s73, s74, 5
    s_add_u32 s72, s72, s73
    v_add_u32 v11, s72, v7
    v_lshlrev_b32 v11, 12, v11
    v_lshl_add_u32 v11, v6, 4, v11
    s_lshl_b32 s72, s67, 7
    s_add_u32 s72, s72, 2048
    v_add_u32 v11, s72, v11
    s_lshl_b32 s72, s74, 2
    s_add_u32 s72, s72, 163584
    v_mov_b32 v59, s72
    v_mov_b32 v61, 1
    s_waitcnt vmcnt(1)
    ds_write_b32 v59, v61 offset:160
    s_mov_b32 s88, 0
Lpair_59:
    ds_read_b32 v58, v59 offset:48
    s_add_u32 s88, s88, 1
    s_cmp_ge_u32 s88, 2097152
    s_waitcnt lgkmcnt(0)
    v_cmp_eq_u32 vcc, 0, v58
    s_cbranch_scc1 Lpaird_60
    s_nop 0
    s_cbranch_vccz Lpaird_60
    s_sleep 4
    s_branch Lpair_59
Lpaird_60:
    s_mov_b64 exec, 15
    buffer_load_dword v16, v13, s[44:47], 0 offen sc1
    s_waitcnt vmcnt(0)
    v_cmp_gt_u32 vcc, 16, v16
    s_mov_b64 exec, -1
    s_nop 0
    s_cbranch_vccz Lyok_61
    s_mov_b64 exec, 15
    s_mov_b32 s88, 0
Lpoll_62:
    v_mov_b32 v16, 0
    buffer_atomic_add v16, v13, s[44:47], 0 offen sc0 sc1
    s_add_u32 s88, s88, 1
    s_waitcnt vmcnt(0)
    v_cmp_gt_u32 vcc, 16, v16
    s_cmp_ge_u32 s88, 262144
    s_cbranch_scc1 Lpdone_63
    s_cbranch_vccz Lpdone_63
    s_sleep 12
    s_branch Lpoll_62
Lpdone_63:
    s_mov_b64 exec, -1
Lyok_61:
    s_mov_b32 s88, 0
Lpair_64:
    ds_read_b32 v58, v59 offset:64
    s_add_u32 s88, s88, 1
    s_cmp_ge_u32 s88, 2097152
    s_waitcnt lgkmcnt(0)
    v_cmp_eq_u32 vcc, 0, v58
    s_cbranch_scc1 Lpaird_65
    s_nop 0
    s_cbranch_vccz Lpaird_65
    s_sleep 1
    s_branch Lpair_64
Lpaird_65:
    s_mov_b32 s73, 4194304
    buffer_load_dwordx4 v[16:19], v12, s[44:47], s73 offen sc1
    s_mov_b32 s73, 4259840
    buffer_load_dwordx4 v[20:23], v12, s[44:47], s73 offen sc1
    s_mov_b32 s73, 4325376
    buffer_load_dwordx4 v[24:27], v12, s[44:47], s73 offen sc1
    s_mov_b32 s73, 4390912
    buffer_load_dwordx4 v[28:31], v12, s[44:47], s73 offen sc1
    s_waitcnt vmcnt(3)
    ds_write_b128 v14, v[16:19] offset:0
    s_waitcnt vmcnt(2)
    ds_write_b128 v14, v[20:23] offset:1024
    s_waitcnt vmcnt(1)
    ds_write_b128 v14, v[24:27] offset:2048
    s_waitcnt vmcnt(0)
    ds_write_b128 v14, v[28:31] offset:3072
    ds_read_b64_tr_b16 v[32:33], v15 offset:0
    ds_read_b64_tr_b16 v[34:35], v15 offset:256
    ds_read_b64_tr_b16 v[36:37], v15 offset:16
    ds_read_b64_tr_b16 v[38:39], v15 offset:272
    ds_read_b64_tr_b16 v[40:41], v15 offset:32
    ds_read_b64_tr_b16 v[42:43], v15 offset:288
    ds_read_b64_tr_b16 v[44:45], v15 offset:48
    ds_read_b64_tr_b16 v[46:47], v15 offset:304
    s_waitcnt lgkmcnt(6)
    s_mov_b32 s73, 0
    buffer_store_dwordx4 v[32:35], v11, s[48:51], s73 offen sc1
    s_waitcnt lgkmcnt(4)
    s_mov_b32 s73, 32768
    buffer_store_dwordx4 v[36:39], v11, s[48:51], s73 offen sc1
    s_waitcnt lgkmcnt(2)
    s_mov_b32 s73, 65536
    buffer_store_dwordx4 v[40:43], v11, s[48:51], s73 offen sc1
    s_waitcnt lgkmcnt(0)
    s_mov_b32 s73, 98304
    buffer_store_dwordx4 v[44:47], v11, s[48:51], s73 offen sc1
    s_endpgm
.p2align 6
L_box:
.long 0x0, 0x0, 0x0, 0x0
.long 0x0, 0x0, 0x0, 0x0
.long 0x0, 0x0, 0x0, 0x0
.long 0x0, 0x0, 0x0, 0x0
.long 0x0, 0x0, 0x0, 0x0
.long 0x0, 0x0, 0x0, 0x0
.long 0x0, 0x0, 0x0, 0x0
.long 0x0, 0x0, 0x0, 0x0
.long 0x0, 0x0, 0x0, 0x0
.long 0x0, 0x0, 0x0, 0x0
.long 0x0, 0x0, 0x0, 0x0
.long 0x0, 0x0, 0x0, 0x0
.long 0x0, 0x0, 0x0, 0x0
.long 0x0, 0x0, 0x0, 0x0
.long 0x0, 0x0, 0x0, 0x0
.long 0x0, 0x0, 0x0, 0x0
.long 0x0, 0x3f800000, 0x3f803f80, 0x0
.long 0x0, 0x0, 0x3f803f80, 0x3f80
.long 0x0, 0x0, 0x3f800000, 0x3f803f80
.long 0x0, 0x0, 0x0, 0x3f803f80
.long 0x0, 0x0, 0x0, 0x3f800000
.long 0x0, 0x0, 0x0, 0x0
.long 0x0, 0x0, 0x0, 0x0
.long 0x0, 0x0, 0x0, 0x0
.long 0x0, 0x0, 0x0, 0x0
.long 0x0, 0x0, 0x0, 0x0
.long 0x0, 0x0, 0x0, 0x0
.long 0x0, 0x0, 0x0, 0x0
.long 0x0, 0x0, 0x0, 0x0
.long 0x0, 0x0, 0x0, 0x0
.long 0x0, 0x0, 0x0, 0x0
.long 0x0, 0x0, 0x0, 0x0
.long 0x0, 0x0, 0x0, 0x0
.long 0x0, 0x0, 0x0, 0x0
.long 0x0, 0x0, 0x0, 0x0
.long 0x3f80, 0x0, 0x0, 0x0
.long 0x3f803f80, 0x0, 0x0, 0x0
.long 0x3f803f80, 0x3f80, 0x0, 0x0
.long 0x3f800000, 0x3f803f80, 0x0, 0x0
.long 0x0, 0x3f803f80, 0x3f80, 0x0
.long 0x0, 0x3f800000, 0x3f803f80, 0x0
.long 0x0, 0x0, 0x3f803f80, 0x3f80
.long 0x0, 0x0, 0x3f800000, 0x3f803f80
.long 0x0, 0x0, 0x0, 0x3f803f80
.long 0x0, 0x0, 0x0, 0x3f800000
.long 0x0, 0x0, 0x0, 0x0
.long 0x0, 0x0, 0x0, 0x0
.long 0x0, 0x0, 0x0, 0x0
.long 0x0, 0x0, 0x0, 0x0
.long 0x0, 0x0, 0x0, 0x0
.long 0x0, 0x0, 0x0, 0x0
.long 0x0, 0x0, 0x0, 0x0
.long 0x0, 0x0, 0x0, 0x0
.long 0x0, 0x0, 0x0, 0x0
.long 0x0, 0x0, 0x0, 0x0
.long 0x0, 0x0, 0x0, 0x0
.long 0x0, 0x0, 0x0, 0x0
.long 0x0, 0x0, 0x0, 0x0
.long 0x0, 0x0, 0x0, 0x0
.long 0x3f80, 0x0, 0x0, 0x0
.long 0x3f803f80, 0x0, 0x0, 0x0
.long 0x3f803f80, 0x3f80, 0x0, 0x0
.long 0x3f800000, 0x3f803f80, 0x0, 0x0
.long 0x0, 0x3f803f80, 0x3f80, 0x0
.long 0x0, 0x0, 0x0, 0x3f803f80
.long 0x0, 0x0, 0x0, 0x3f800000
.long 0x0, 0x0, 0x0, 0x0
.long 0x0, 0x0, 0x0, 0x0
.long 0x0, 0x0, 0x0, 0x0
.long 0x0, 0x0, 0x0, 0x0
.long 0x0, 0x0, 0x0, 0x0
.long 0x0, 0x0, 0x0, 0x0
.long 0x0, 0x0, 0x0, 0x0
.long 0x0, 0x0, 0x0, 0x0
.long 0x0, 0x0, 0x0, 0x0
.long 0x0, 0x0, 0x0, 0x0
.long 0x0, 0x0, 0x0, 0x0
.long 0x0, 0x0, 0x0, 0x0
.long 0x0, 0x0, 0x0, 0x0
.long 0x0, 0x0, 0x0, 0x0
.long 0x3f803f80, 0x3f80, 0x0, 0x0
.long 0x3f803f80, 0x3f803f80, 0x0, 0x0
.long 0x3f803f80, 0x3f803f80, 0x3f80, 0x0
.long 0x3f800000, 0x3f803f80, 0x3f803f80, 0x0
.long 0x0, 0x3f803f80, 0x3f803f80, 0x3f80
.long 0x0, 0x3f800000, 0x3f803f80, 0x3f803f80
.long 0x0, 0x0, 0x3f803f80, 0x3f803f80
.long 0x0, 0x0, 0x3f800000, 0x3f803f80
.long 0x0, 0x0, 0x0, 0x3f803f80
.long 0x0, 0x0, 0x0, 0x3f800000
.long 0x0, 0x0, 0x0, 0x0
.long 0x0, 0x0, 0x0, 0x0
.long 0x0, 0x0, 0x0, 0x0
.long 0x0, 0x0, 0x0, 0x0
.long 0x0, 0x0, 0x0, 0x0
.long 0x0, 0x0, 0x0, 0x0
.long 0x0, 0x0, 0x0, 0x0
.long 0x0, 0x0, 0x0, 0x0
.long 0x0, 0x0, 0x0, 0x0
.long 0x0, 0x0, 0x0, 0x0
.long 0x0, 0x0, 0x0, 0x0
.long 0x0, 0x0, 0x0, 0x0
.long 0x3f80, 0x0, 0x0, 0x0
.long 0x3f803f80, 0x0, 0x0, 0x0
.long 0x3f803f80, 0x3f80, 0x0, 0x0
.long 0x3f803f80, 0x3f803f80, 0x0, 0x0
.long 0x3f803f80, 0x3f803f80, 0x3f80, 0x0
.long 0x3f800000, 0x3f803f80, 0x3f803f80, 0x0
.long 0x0, 0x3f803f80, 0x3f803f80, 0x3f80
.long 0x0, 0x3f800000, 0x3f803f80, 0x3f803f80
.long 0x0, 0x0, 0x3f803f80, 0x3f803f80
.long 0x0, 0x0, 0x3f800000, 0x3f803f80
.long 0x0, 0x0, 0x0, 0x0
.long 0x0, 0x0, 0x0, 0x0
.long 0x0, 0x0, 0x0, 0x0
.long 0x0, 0x0, 0x0, 0x0
.long 0x0, 0x0, 0x0, 0x0
.long 0x0, 0x0, 0x0, 0x0
.long 0x0, 0x0, 0x0, 0x0
.long 0x0, 0x0, 0x0, 0x0
.long 0x0, 0x0, 0x0, 0x0
.long 0x0, 0x0, 0x0, 0x0
.long 0x0, 0x0, 0x0, 0x0
.long 0x0, 0x0, 0x0, 0x0
.long 0x0, 0x0, 0x0, 0x0
.long 0x0, 0x0, 0x0, 0x0
.long 0x3f80, 0x0, 0x0, 0x0
.long 0x3f803f80, 0x0, 0x0, 0x0
.long 0x0, 0x0, 0x0, 0x0
.long 0x0, 0x0, 0x0, 0x0
.long 0x0, 0x0, 0x0, 0x0
.long 0x0, 0x0, 0x0, 0x0
.long 0x0, 0x0, 0x0, 0x0
.long 0x0, 0x0, 0x0, 0x0
.long 0x0, 0x0, 0x0, 0x0
.long 0x0, 0x0, 0x0, 0x0
.long 0x0, 0x0, 0x0, 0x0
.long 0x0, 0x0, 0x0, 0x0
.long 0x0, 0x0, 0x0, 0x0
.long 0x0, 0x0, 0x0, 0x0
.long 0x0, 0x0, 0x0, 0x0
.long 0x0, 0x0, 0x0, 0x0
.long 0x0, 0x0, 0x0, 0x0
.long 0x0, 0x0, 0x0, 0x0
.long 0x0, 0x3f800000, 0x3f803f80, 0x0
.long 0x0, 0x0, 0x3f803f80, 0x3f80
.long 0x0, 0x0, 0x3f800000, 0x3f803f80
.long 0x0, 0x0, 0x0, 0x3f803f80
.long 0x0, 0x0, 0x0, 0x3f800000
.long 0x0, 0x0, 0x0, 0x0
.long 0x0, 0x0, 0x0, 0x0
.long 0x0, 0x0, 0x0, 0x0
.long 0x0, 0x0, 0x0, 0x0
.long 0x0, 0x0, 0x0, 0x0
.long 0x0, 0x0, 0x0, 0x0
.long 0x0, 0x0, 0x0, 0x0
.long 0x0, 0x0, 0x0, 0x0
.long 0x0, 0x0, 0x0, 0x0
.long 0x0, 0x0, 0x0, 0x0
.long 0x0, 0x0, 0x0, 0x0
.long 0x0, 0x0, 0x0, 0x0
.long 0x0, 0x0, 0x0, 0x0
.long 0x0, 0x0, 0x0, 0x0
.long 0x3f80, 0x0, 0x0, 0x0
.long 0x3f803f80, 0x0, 0x0, 0x0
.long 0x3f803f80, 0x3f80, 0x0, 0x0
.long 0x3f800000, 0x3f803f80, 0x0, 0x0
.long 0x0, 0x3f803f80, 0x3f80, 0x0
.long 0x0, 0x3f800000, 0x3f803f80, 0x0
.long 0x0, 0x0, 0x3f803f80, 0x3f80
.long 0x0, 0x0, 0x3f800000, 0x3f803f80
.long 0x0, 0x0, 0x0, 0x3f803f80
.long 0x0, 0x0, 0x0, 0x3f800000
.long 0x0, 0x0, 0x0, 0x0
.long 0x0, 0x0, 0x0, 0x0
.long 0x0, 0x0, 0x0, 0x0
.long 0x0, 0x0, 0x0, 0x0
.long 0x0, 0x0, 0x0, 0x0
.long 0x0, 0x0, 0x0, 0x0
.long 0x0, 0x0, 0x0, 0x0
.long 0x0, 0x0, 0x0, 0x0
.long 0x0, 0x0, 0x0, 0x0
.long 0x0, 0x0, 0x0, 0x0
.long 0x0, 0x0, 0x0, 0x0
.long 0x0, 0x0, 0x0, 0x0
.long 0x0, 0x0, 0x0, 0x0
.long 0x0, 0x0, 0x0, 0x0
.long 0x3f80, 0x0, 0x0, 0x0
.long 0x3f803f80, 0x0, 0x0, 0x0
.long 0x3f803f80, 0x3f80, 0x0, 0x0
.long 0x3f800000, 0x3f803f80, 0x0, 0x0
.long 0x0, 0x3f803f80, 0x3f80, 0x0
.long 0x0, 0x0, 0x0, 0x3f803f80
.long 0x0, 0x0, 0x0, 0x3f800000
.long 0x0, 0x0, 0x0, 0x0
.long 0x0, 0x0, 0x0, 0x0
.long 0x0, 0x0, 0x0, 0x0
.long 0x0, 0x0, 0x0, 0x0
.long 0x0, 0x0, 0x0, 0x0
.long 0x0, 0x0, 0x0, 0x0
.long 0x0, 0x0, 0x0, 0x0
.long 0x0, 0x0, 0x0, 0x0
.long 0x0, 0x0, 0x0, 0x0
.long 0x0, 0x0, 0x0, 0x0
.long 0x0, 0x0, 0x0, 0x0
.long 0x0, 0x0, 0x0, 0x0
.long 0x0, 0x0, 0x0, 0x0
.long 0x0, 0x0, 0x0, 0x0
.long 0x3f803f80, 0x3f80, 0x0, 0x0
.long 0x3f803f80, 0x3f803f80, 0x0, 0x0
.long 0x3f803f80, 0x3f803f80, 0x3f80, 0x0
.long 0x3f800000, 0x3f803f80, 0x3f803f80, 0x0
.long 0x0, 0x3f803f80, 0x3f803f80, 0x3f80
.long 0x0, 0x3f800000, 0x3f803f80, 0x3f803f80
.long 0x0, 0x0, 0x3f803f80, 0x3f803f80
.long 0x0, 0x0, 0x3f800000, 0x3f803f80
.long 0x0, 0x0, 0x0, 0x3f803f80
.long 0x0, 0x0, 0x0, 0x3f800000
.long 0x0, 0x0, 0x0, 0x0
.long 0x0, 0x0, 0x0, 0x0
.long 0x0, 0x0, 0x0, 0x0
.long 0x0, 0x0, 0x0, 0x0
.long 0x0, 0x0, 0x0, 0x0
.long 0x0, 0x0, 0x0, 0x0
.long 0x0, 0x0, 0x0, 0x0
.long 0x0, 0x0, 0x0, 0x0
.long 0x0, 0x0, 0x0, 0x0
.long 0x0, 0x0, 0x0, 0x0
.long 0x0, 0x0, 0x0, 0x0
.long 0x0, 0x0, 0x0, 0x0
.long 0x3f80, 0x0, 0x0, 0x0
.long 0x3f803f80, 0x0, 0x0, 0x0
.long 0x3f803f80, 0x3f80, 0x0, 0x0
.long 0x3f803f80, 0x3f803f80, 0x0, 0x0
.long 0x3f803f80, 0x3f803f80, 0x3f80, 0x0
.long 0x3f800000, 0x3f803f80, 0x3f803f80, 0x0
.long 0x0, 0x3f803f80, 0x3f803f80, 0x3f80
.long 0x0, 0x3f800000, 0x3f803f80, 0x3f803f80
.long 0x0, 0x0, 0x3f803f80, 0x3f803f80
.long 0x0, 0x0, 0x3f800000, 0x3f803f80
.long 0x0, 0x0, 0x0, 0x0
.long 0x0, 0x0, 0x0, 0x0
.long 0x0, 0x0, 0x0, 0x0
.long 0x0, 0x0, 0x0, 0x0
.long 0x0, 0x0, 0x0, 0x0
.long 0x0, 0x0, 0x0, 0x0
.long 0x0, 0x0, 0x0, 0x0
.long 0x0, 0x0, 0x0, 0x0
.long 0x0, 0x0, 0x0, 0x0
.long 0x0, 0x0, 0x0, 0x0
.long 0x0, 0x0, 0x0, 0x0
.long 0x0, 0x0, 0x0, 0x0
.long 0x0, 0x0, 0x0, 0x0
.long 0x0, 0x0, 0x0, 0x0
.long 0x3f80, 0x0, 0x0, 0x0
.long 0x3f803f80, 0x0, 0x0, 0x0
.long 0x0, 0x0, 0x3f800000, 0x3f803f80
.long 0x0, 0x0, 0x0, 0x3f803f80
.long 0x0, 0x0, 0x0, 0x3f800000
.long 0x0, 0x0, 0x0, 0x0
.long 0x0, 0x0, 0x0, 0x0
.long 0x0, 0x0, 0x0, 0x0
.long 0x0, 0x0, 0x0, 0x0
.long 0x0, 0x0, 0x0, 0x0
.long 0x0, 0x0, 0x0, 0x0
.long 0x0, 0x0, 0x0, 0x0
.long 0x0, 0x0, 0x0, 0x0
.long 0x0, 0x0, 0x0, 0x0
.long 0x0, 0x0, 0x0, 0x0
.long 0x0, 0x0, 0x0, 0x0
.long 0x0, 0x0, 0x0, 0x0
.long 0x0, 0x0, 0x0, 0x0
.long 0x3f803f80, 0x3f803f80, 0x0, 0x0
.long 0x3f803f80, 0x3f803f80, 0x3f80, 0x0
.long 0x3f803f80, 0x3f803f80, 0x3f803f80, 0x0
.long 0x3f803f80, 0x3f803f80, 0x3f803f80, 0x3f80
.long 0x3f800000, 0x3f803f80, 0x3f803f80, 0x3f803f80
.long 0x0, 0x3f803f80, 0x3f803f80, 0x3f803f80
.long 0x0, 0x3f800000, 0x3f803f80, 0x3f803f80
.long 0x0, 0x0, 0x3f803f80, 0x3f803f80
.long 0x0, 0x0, 0x3f800000, 0x3f803f80
.long 0x0, 0x0, 0x0, 0x3f803f80
.long 0x0, 0x0, 0x0, 0x3f800000
.long 0x0, 0x0, 0x0, 0x0
.long 0x0, 0x0, 0x0, 0x0
.long 0x0, 0x0, 0x0, 0x0
.long 0x0, 0x0, 0x0, 0x0
.long 0x0, 0x0, 0x0, 0x0
.long 0x0, 0x0, 0x0, 0x0
.long 0x0, 0x0, 0x0, 0x0
.long 0x0, 0x0, 0x0, 0x0
.long 0x0, 0x0, 0x0, 0x0
.long 0x0, 0x0, 0x0, 0x0
.long 0x3f80, 0x0, 0x0, 0x0
.long 0x3f803f80, 0x0, 0x0, 0x0
.long 0x3f803f80, 0x3f80, 0x0, 0x0
.long 0x3f803f80, 0x3f803f80, 0x0, 0x0
.long 0x3f803f80, 0x3f803f80, 0x3f80, 0x0
.long 0x3f803f80, 0x3f803f80, 0x3f803f80, 0x0
.long 0x3f803f80, 0x3f803f80, 0x3f803f80, 0x3f80
.long 0x3f800000, 0x3f803f80, 0x3f803f80, 0x3f803f80
.long 0x0, 0x3f803f80, 0x3f803f80, 0x3f803f80
.long 0x0, 0x3f800000, 0x3f803f80, 0x3f803f80
.long 0x0, 0x0, 0x3f803f80, 0x3f803f80
.long 0x0, 0x0, 0x0, 0x0
.long 0x0, 0x0, 0x0, 0x0
.long 0x0, 0x0, 0x0, 0x0
.long 0x0, 0x0, 0x0, 0x0
.long 0x0, 0x0, 0x0, 0x0
.long 0x0, 0x0, 0x0, 0x0
.long 0x0, 0x0, 0x0, 0x0
.long 0x0, 0x0, 0x0, 0x0
.long 0x0, 0x0, 0x0, 0x0
.long 0x0, 0x0, 0x0, 0x0
.long 0x0, 0x0, 0x0, 0x0
.long 0x0, 0x0, 0x0, 0x0
.long 0x0, 0x0, 0x0, 0x0
.long 0x3f80, 0x0, 0x0, 0x0
.long 0x3f803f80, 0x0, 0x0, 0x0
.long 0x3f803f80, 0x3f80, 0x0, 0x0
.long 0x0, 0x0, 0x3f803f80, 0x3f803f80
.long 0x0, 0x0, 0x3f800000, 0x3f803f80
.long 0x0, 0x0, 0x0, 0x3f803f80
.long 0x0, 0x0, 0x0, 0x3f800000
.long 0x0, 0x0, 0x0, 0x0
.long 0x0, 0x0, 0x0, 0x0
.long 0x0, 0x0, 0x0, 0x0
.long 0x0, 0x0, 0x0, 0x0
.long 0x0, 0x0, 0x0, 0x0
.long 0x0, 0x0, 0x0, 0x0
.long 0x0, 0x0, 0x0, 0x0
.long 0x0, 0x0, 0x0, 0x0
.long 0x0, 0x0, 0x0, 0x0
.long 0x0, 0x0, 0x0, 0x0
.long 0x0, 0x0, 0x0, 0x0
.long 0x0, 0x0, 0x0, 0x0
.long 0x3f803f80, 0x3f803f80, 0x3f80, 0x0
.long 0x3f803f80, 0x3f803f80, 0x3f803f80, 0x0
.long 0x3f803f80, 0x3f803f80, 0x3f803f80, 0x3f80
.long 0x3f803f80, 0x3f803f80, 0x3f803f80, 0x3f803f80
.long 0x3f803f80, 0x3f803f80, 0x3f803f80, 0x3f803f80
.long 0x3f800000, 0x3f803f80, 0x3f803f80, 0x3f803f80
.long 0x0, 0x3f803f80, 0x3f803f80, 0x3f803f80
.long 0x0, 0x3f800000, 0x3f803f80, 0x3f803f80
.long 0x0, 0x0, 0x3f803f80, 0x3f803f80
.long 0x0, 0x0, 0x3f800000, 0x3f803f80
.long 0x0, 0x0, 0x0, 0x3f803f80
.long 0x0, 0x0, 0x0, 0x3f800000
.long 0x0, 0x0, 0x0, 0x0
.long 0x0, 0x0, 0x0, 0x0
.long 0x0, 0x0, 0x0, 0x0
.long 0x0, 0x0, 0x0, 0x0
.long 0x0, 0x0, 0x0, 0x0
.long 0x0, 0x0, 0x0, 0x0
.long 0x0, 0x0, 0x0, 0x0
.long 0x0, 0x0, 0x0, 0x0
.long 0x3f80, 0x0, 0x0, 0x0
.long 0x3f803f80, 0x0, 0x0, 0x0
.long 0x3f803f80, 0x3f80, 0x0, 0x0
.long 0x3f803f80, 0x3f803f80, 0x0, 0x0
.long 0x3f803f80, 0x3f803f80, 0x3f80, 0x0
.long 0x3f803f80, 0x3f803f80, 0x3f803f80, 0x0
.long 0x3f803f80, 0x3f803f80, 0x3f803f80, 0x3f80
.long 0x3f803f80, 0x3f803f80, 0x3f803f80, 0x3f803f80
.long 0x3f803f80, 0x3f803f80, 0x3f803f80, 0x3f803f80
.long 0x3f800000, 0x3f803f80, 0x3f803f80, 0x3f803f80
.long 0x0, 0x3f803f80, 0x3f803f80, 0x3f803f80
.long 0x0, 0x3f800000, 0x3f803f80, 0x3f803f80
.long 0x0, 0x0, 0x0, 0x0
.long 0x0, 0x0, 0x0, 0x0
.long 0x0, 0x0, 0x0, 0x0
.long 0x0, 0x0, 0x0, 0x0
.long 0x0, 0x0, 0x0, 0x0
.long 0x0, 0x0, 0x0, 0x0
.long 0x0, 0x0, 0x0, 0x0
.long 0x0, 0x0, 0x0, 0x0
.long 0x0, 0x0, 0x0, 0x0
.long 0x0, 0x0, 0x0, 0x0
.long 0x0, 0x0, 0x0, 0x0
.long 0x0, 0x0, 0x0, 0x0
.long 0x3f80, 0x0, 0x0, 0x0
.long 0x3f803f80, 0x0, 0x0, 0x0
.long 0x3f803f80, 0x3f80, 0x0, 0x0
.long 0x3f803f80, 0x3f803f80, 0x0, 0x0
.section .rodata,"a"
.p2align 6
.amdhsa_kernel concat_heads__linear_kernel_hedgehog__ssm_conv_s4__prompt_kernel
  .amdhsa_next_free_vgpr 256
  .amdhsa_next_free_sgpr 102
  .amdhsa_accum_offset 256
  .amdhsa_group_segment_fixed_size 0
  .amdhsa_kernarg_size 128
  .amdhsa_user_sgpr_count 2
  .amdhsa_user_sgpr_kernarg_segment_ptr 1
  .amdhsa_system_sgpr_workgroup_id_x 1
.end_amdhsa_kernel
```
